```python
import torch

def _softmax(x, axis=-1):
    return torch.softmax(x, dim=axis)
def _gelu(x):
    return torch.nn.functional.gelu(x, approximate="tanh")
def _silu(x):
    return torch.nn.functional.silu(x)
def _sigmoid(x):
    return torch.sigmoid(x)
def _layernorm(x, axis=-1, eps=1e-5):
    m = x.mean(dim=axis, keepdim=True)
    v = x.var(dim=axis, keepdim=True, unbiased=False)
    return (x - m) / torch.sqrt(v + eps)
def _scatter_add(tgt, idx, src, axis=0):
    return tgt.clone().index_add_(axis, idx, src)
def _segment_sum(src, seg, n):
    out = torch.zeros((n,) + src.shape[1:], dtype=src.dtype)
    return out.index_add_(0, seg, src)
def _pad(x, pw):
    flat = tuple(v for pair in reversed(pw) for v in pair)
    return torch.nn.functional.pad(x, flat)

kernel_name = 'concat_heads__linear_kernel_hedgehog__linear_attn_block__prompt'

def setup_inputs():

    _w = (lambda a: (lambda t: t.to(torch.bfloat16) if t.is_floating_point() else t)(torch.as_tensor(a)))
    def _A_setup():
        B, S, D, H = 1, 2048, 640, 32
        Dh = D // H
        return {
            "x": _w((lambda *s: torch.randn(*s, dtype=torch.bfloat16) * 0.4)(B, S, D)),
            "wqkv": _w((lambda *s: torch.randn(*s, dtype=torch.bfloat16) * 0.4)(D, 3 * D)),
            "w_phi": _w((lambda *s: torch.randn(*s, dtype=torch.bfloat16) * 0.4)(H, Dh, Dh) * (Dh ** -0.5)),
            "wo": _w((lambda *s: torch.randn(*s, dtype=torch.bfloat16) * 0.05)(D, D)),
        }
    _A_in = _A_setup()

    def _B_setup():
        B, S, D = 1, 2048, 640
        return {
            "x": _w((lambda *s: torch.randn(*s, dtype=torch.bfloat16) * 0.05)(B, S, D)),
            "wqkv": _w((lambda *s: torch.randn(*s, dtype=torch.bfloat16) * 0.8)(D, 3 * D)),
            "wo": _w((lambda *s: torch.randn(*s, dtype=torch.bfloat16) * 0.4)(D, D)),
        }
    _B_in = _B_setup()

    return {
        "A_x": _A_in["x"],
        "A_wqkv": _A_in["wqkv"],
        "A_w_phi": _A_in["w_phi"],
        "A_wo": _A_in["wo"],
        "B_x": _B_in["x"],
        "B_wqkv": _B_in["wqkv"],
        "B_wo": _B_in["wo"],
    }

def reference(A_x, A_wqkv, A_w_phi, A_wo, B_x, B_wqkv, B_wo):
    def _A_ref(x, wqkv, w_phi, wo):
        B, S, D = x.shape
        H = 32; Dh = D // H
        qkv = (lambda x, *d: x.permute(*d))((x @ wqkv).reshape(B, S, 3, H, Dh), 2, 0, 3, 1, 4)
        q, k, v = qkv[0], qkv[1], qkv[2]
        pq = torch.einsum("bhsd,hdf->bhsf", q, w_phi)
        pk = torch.einsum("bhsd,hdf->bhsf", k, w_phi)
        phi_q = torch.concatenate([_softmax(pq, axis=-1), _softmax(-pq, axis=-1)], axis=-1)
        phi_k = torch.concatenate([_softmax(pk, axis=-1), _softmax(-pk, axis=-1)], axis=-1)
        kv = torch.einsum("bhsf,bhsd->bhfd", phi_k, v)
        z  = torch.einsum("bhsf->bhf", phi_k)
        num = torch.einsum("bhqf,bhfd->bhqd", phi_q, kv)
        den = torch.einsum("bhqf,bhf->bhq", phi_q, z)[..., None] + 1e-6
        o = num / den
        return (lambda x, *d: x.permute(*d))(o, 0, 2, 1, 3).reshape(B, S, D) @ wo

    def _B_ref(x, wqkv, wo):
        B, S, D = x.shape
        H = 32; Dh = D // H
        qkv = (lambda x, *d: x.permute(*d))((x @ wqkv).reshape(B, S, 3, H, Dh), 2, 0, 3, 1, 4)
        q, k, v = qkv[0], qkv[1], qkv[2]
        phi = lambda t: torch.where(t > 0, t + 1, torch.exp(t)) + 1e-6
        pq, pk = phi(q), phi(k)
        kv = torch.einsum("bhsd,bhse->bhde", pk, v)
        z = torch.einsum("bhsd->bhd", pk)
        num = torch.einsum("bhqd,bhde->bhqe", pq, kv)
        den = torch.einsum("bhqd,bhd->bhq", pq, z)[..., None] + 1e-6
        o = num / den
        return (lambda x, *d: x.permute(*d))(o, 0, 2, 1, 3).reshape(B, S, D) @ wo

    a = _A_ref(A_x, A_wqkv, A_w_phi, A_wo)
    b = _B_ref(B_x, B_wqkv, B_wo)
    return torch.concatenate([a, b], axis=-1)
```

```asm
; @launch grid=(256,1,1) block=(256,1,1) lds=163840
.amdgcn_target "amdgcn-amd-amdhsa--gfx950"
.text
.globl concat_heads__linear_kernel_hedgehog__linear_attn_block__prompt_kernel
.p2align 12
.p2align 8
.type concat_heads__linear_kernel_hedgehog__linear_attn_block__prompt_kernel,@function
concat_heads__linear_kernel_hedgehog__linear_attn_block__prompt_kernel:
    s_cmp_ge_u32 s2, 256
    s_cbranch_scc1 L_exit
    s_andn2_b32 s42, 1, s2
    s_lshl_b32 s42, s42, 5
    s_load_dwordx8 s[76:83], s[0:1], s42
    s_load_dwordx2 s[84:85], s[0:1], 56
    s_load_dwordx2 s[86:87], s[0:1], 72
    s_getpc_b64 s[60:61]
L_pc:
    s_bfe_u32 s5, s2, 0x30003
    v_and_b32 v1, 63, v0
    v_lshrrev_b32 v112, 6, v0
    s_bitcmp0_b32 s2, 0
    s_cselect_b32 s43, L_setupB-L_setupA, 0
    s_lshl_b32 s42, s5, 12
    v_lshlrev_b32 v253, 7, v1
    v_readfirstlane_b32 s7, v112
    s_add_u32 s42, s42, s43
    s_add_u32 s42, s42, L_setupA-L_pc
    s_add_u32 s60, s60, s42
    s_addc_u32 s61, s61, 0
    v_lshl_add_u32 v113, v112, 10, v253
    s_mov_b64 exec, 0xff
    global_load_dword v251, v113, s[60:61]
    s_mov_b64 exec, -1
    s_and_b32 s4, s2, 6
    s_lshl_b32 s4, s4, 1
    s_lshr_b32 s42, s2, 6
    s_add_u32 s4, s4, s42
    s_mul_i32 s42, s5, 10
    s_mul_i32 s43, s4, 10
    s_add_u32 s42, s42, s43
    s_lshr_b32 s42, s42, 2
    s_mul_i32 s43, s42, 6554
    s_lshr_b32 s43, s43, 16
    s_mul_i32 s43, s43, 10
    s_sub_u32 s45, s42, s43
    s_lshl_b32 s39, s45, 7
    s_lshl_b32 s42, s4, 2
    s_add_u32 s42, s42, s7
    s_mul_i32 s38, s42, 40960
    s_mul_i32 s40, s7, 5120
    s_mul_i32 s41, s7, 15360
    s_add_u32 s41, s41, 102400
    v_lshrrev_b32 v112, 3, v1
    v_mul_u32_u24 v112, 1280, v112
    v_lshrrev_b32 v113, 4, v1
    v_xor_b32 v113, v113, v1
    v_and_b32 v113, 7, v113
    v_lshl_add_u32 v17, v113, 4, v112
    v_xor_b32 v114, 64, v17
    v_add_u32 v18, 9216, v114
    v_add_u32 v19, 18432, v17
    v_add_u32 v20, 27648, v114
    s_lshr_b32 s42, s7, 1
    s_add_u32 s42, s42, s45
    s_and_b32 s43, s7, 1
    s_mul_i32 s43, s43, 122880
    s_mul_i32 s44, s5, 160
    s_add_u32 s43, s43, s44
    s_mov_b32 s10, 2621440
    s_mov_b32 s11, 0x20000
    s_mov_b32 s14, 2457600
    s_mov_b32 s15, 0x20000
    s_cmp_ge_u32 s42, 10
    s_cselect_b32 s44, 10, 0
    s_sub_u32 s42, s42, s44
    s_mul_i32 s44, s42, 245760
    s_add_u32 s33, s44, s43
    s_add_u32 s42, s42, 2
    v_add_u32 v112, 0, v1
    v_mul_u32_u24 v126, 6554, v112
    v_lshrrev_b32 v126, 16, v126
    v_mul_u32_u24 v114, 10, v126
    v_sub_u32 v125, v112, v114
    v_bfe_u32 v122, v126, 2, 2
    v_lshrrev_b32 v123, 4, v126
    v_and_b32 v124, 3, v126
    v_lshl_add_u32 v112, v122, 1, v123
    v_lshl_add_u32 v112, v112, 2, v124
    v_mul_u32_u24 v112, 3840, v112
    v_lshl_add_u32 v2, v125, 4, v112
    v_add_u32 v112, 64, v1
    v_mul_u32_u24 v131, 6554, v112
    v_lshrrev_b32 v131, 16, v131
    v_mul_u32_u24 v114, 10, v131
    v_sub_u32 v130, v112, v114
    v_bfe_u32 v127, v131, 2, 2
    v_lshrrev_b32 v128, 4, v131
    v_and_b32 v129, 3, v131
    v_lshl_add_u32 v112, v127, 1, v128
    v_lshl_add_u32 v112, v112, 2, v129
    v_mul_u32_u24 v112, 3840, v112
    v_lshl_add_u32 v3, v130, 4, v112
    v_subrev_u32 v3, 1024, v3
    s_waitcnt lgkmcnt(0)
    s_mov_b32 s8, s76
    s_mov_b32 s9, s77
    s_mov_b32 s12, s78
    s_mov_b32 s13, s79
    s_add_u32 m0, s41, 0
    s_add_u32 s58, s39, s38
    buffer_load_dwordx4 v17, s[8:11], s58 offen lds
    s_add_u32 s39, s39, 128
    buffer_load_dwordx4 v18, s[8:11], s58 offen offset:1024 lds
    s_cmp_eq_u32 s39, 1280
    s_cselect_b32 s39, 0, s39
    buffer_load_dwordx4 v19, s[8:11], s58 offen offset:2048 lds
    buffer_load_dwordx4 v20, s[8:11], s58 offen offset:3072 lds
    s_add_u32 m0, s40, 0
    s_add_u32 s57, s33, 1280
    buffer_load_dwordx4 v2, s[12:15], s57 offen lds
    buffer_load_dwordx4 v3, s[12:15], s57 offen offset:1024 lds
    v_add_u32 v112, 128, v1
    v_mul_u32_u24 v136, 6554, v112
    v_lshrrev_b32 v136, 16, v136
    v_mul_u32_u24 v114, 10, v136
    v_sub_u32 v135, v112, v114
    v_bfe_u32 v132, v136, 2, 2
    v_lshrrev_b32 v133, 4, v136
    v_and_b32 v134, 3, v136
    v_lshl_add_u32 v112, v132, 1, v133
    v_lshl_add_u32 v112, v112, 2, v134
    v_mul_u32_u24 v112, 3840, v112
    v_lshl_add_u32 v4, v135, 4, v112
    v_subrev_u32 v4, 2048, v4
    buffer_load_dwordx4 v4, s[12:15], s57 offen offset:2048 lds
    v_add_u32 v112, 192, v1
    v_mul_u32_u24 v141, 6554, v112
    v_lshrrev_b32 v141, 16, v141
    v_mul_u32_u24 v114, 10, v141
    v_sub_u32 v140, v112, v114
    v_bfe_u32 v137, v141, 2, 2
    v_lshrrev_b32 v138, 4, v141
    v_and_b32 v139, 3, v141
    v_lshl_add_u32 v112, v137, 1, v138
    v_lshl_add_u32 v112, v112, 2, v139
    v_mul_u32_u24 v112, 3840, v112
    v_lshl_add_u32 v5, v140, 4, v112
    v_subrev_u32 v5, 3072, v5
    buffer_load_dwordx4 v5, s[12:15], s57 offen offset:3072 lds
    s_add_u32 m0, s40, 4096
    v_add_u32 v112, 256, v1
    v_mul_u32_u24 v146, 6554, v112
    v_lshrrev_b32 v146, 16, v146
    v_mul_u32_u24 v114, 10, v146
    v_sub_u32 v145, v112, v114
    v_bfe_u32 v142, v146, 2, 2
    v_lshrrev_b32 v143, 4, v146
    v_and_b32 v144, 3, v146
    v_lshl_add_u32 v112, v142, 1, v143
    v_lshl_add_u32 v112, v112, 2, v144
    v_mul_u32_u24 v112, 3840, v112
    v_lshl_add_u32 v6, v145, 4, v112
    buffer_load_dwordx4 v6, s[12:15], s57 offen lds
    s_bitcmp0_b32 s2, 0
    s_cbranch_scc1 L_setupB
L_setupA:
    s_load_dword s32, s[86:87], 0
    s_cmp_ge_u32 s42, 10
    s_cselect_b32 s44, 10, 0
    s_sub_u32 s42, s42, s44
    s_mul_i32 s44, s42, 245760
    s_add_u32 s34, s44, s43
    s_add_u32 s42, s42, 2
    s_cmp_ge_u32 s42, 10
    s_cselect_b32 s44, 10, 0
    s_sub_u32 s42, s42, s44
    s_mul_i32 s44, s42, 245760
    s_add_u32 s35, s44, s43
    s_add_u32 s42, s42, 2
    s_cmp_ge_u32 s42, 10
    s_cselect_b32 s44, 10, 0
    s_sub_u32 s42, s42, s44
    s_mul_i32 s44, s42, 245760
    s_add_u32 s36, s44, s43
    s_add_u32 s42, s42, 2
    s_cmp_ge_u32 s42, 10
    s_cselect_b32 s44, 10, 0
    s_sub_u32 s42, s42, s44
    s_mul_i32 s44, s42, 245760
    s_add_u32 s37, s44, s43
    s_add_u32 s42, s42, 2
    s_mov_b32 s20, s86
    s_mov_b32 s21, s87
    s_mov_b32 s22, 33554432
    s_mov_b32 s23, 0x20000
    s_mov_b32 s24, s84
    s_mov_b32 s25, s85
    s_mov_b32 s26, 5242880
    s_mov_b32 s27, 0x20000
    s_lshl_b32 s51, s5, 2
    s_add_u32 s51, s51, s7
    v_lshlrev_b32 v25, 4, v1
    s_mov_b32 s28, s80
    s_mov_b32 s29, s81
    s_mov_b32 s30, 25600
    s_mov_b32 s31, 0x20000
    v_lshrrev_b32 v112, 4, v1
    v_and_b32 v113, 15, v1
    v_bfe_u32 v114, v1, 2, 2
    v_and_b32 v115, 3, v1
    v_lshrrev_b32 v116, 1, v113
    v_xor_b32 v116, v116, v112
    v_lshlrev_b32 v117, 7, v113
    v_lshl_add_u32 v116, v116, 4, v117
    v_add_u32 v21, s41, v116
    v_xor_b32 v116, 64, v116
    v_add_u32 v22, s41, v116
    v_lshrrev_b32 v116, 2, v1
    v_mul_u32_u24 v117, 160, v116
    v_mul_u32_u24 v118, 40, v115
    v_add_u32 v23, v117, v118
    v_add_u32 v24, 51200, v23
    v_mul_u32_u24 v117, 120, v113
    v_mul_u32_u24 v118, 3840, v112
    v_add3_u32 v26, v117, v118, s41
    v_mul_u32_u24 v118, 40, v112
    v_mul_u32_u24 v119, 160, v113
    v_lshrrev_b32 v120, 3, v113
    v_lshl_add_u32 v119, v120, 4, v119
    s_mul_i32 s44, s7, 2592
    s_add_u32 s44, s44, 153088
    v_add3_u32 v239, v119, v118, s44
    v_and_b32 v117, 7, v116
    v_lshrrev_b32 v118, 5, v1
    v_lshlrev_b32 v118, 1, v118
    v_lshl_add_u32 v117, v117, 2, v118
    v_mul_u32_u24 v117, 120, v117
    s_mul_i32 s42, s7, 3840
    s_add_u32 s42, s42, 102400
    v_add_u32 v30, s42, v117
    v_lshl_add_u32 v28, v115, 3, v30
    s_mov_b32 s54, 0x3fb8aa3b
    s_mov_b32 s55, 0xbfb8aa3b
    s_mov_b32 s75, 0x07060302
    s_and_b32 s45, s5, 1
    v_lshrrev_b32 v117, 3, v126
    v_min_u32 v117, 1, v117
    v_and_b32 v118, 63, v1
    v_add_lshl_u32 v117, v117, v118, 4
    v_add_u32 v117, 0, v117
    v_add_u32 v240, s44, v117
    v_mul_u32_u24 v117, 2560, v126
    v_lshl_add_u32 v245, v125, 4, v117
    v_lshrrev_b32 v117, 3, v131
    v_min_u32 v117, 1, v117
    v_and_b32 v118, 63, v1
    v_add_lshl_u32 v117, v117, v118, 4
    v_add_u32 v117, 1024, v117
    v_add_u32 v241, s44, v117
    v_mul_u32_u24 v117, 2560, v131
    v_lshl_add_u32 v246, v130, 4, v117
    v_lshrrev_b32 v117, 3, v136
    v_min_u32 v117, 1, v117
    v_and_b32 v118, 31, v1
    v_add_lshl_u32 v117, v117, v118, 4
    v_add_u32 v117, 2048, v117
    s_add_u32 m0, s41, 4096
    s_add_u32 s58, s39, s38
    buffer_load_dwordx4 v17, s[8:11], s58 offen lds
    s_add_u32 s39, s39, 128
    v_add_u32 v242, s44, v117
    v_mul_u32_u24 v117, 2560, v136
    v_lshl_add_u32 v247, v135, 4, v117
    v_lshrrev_b32 v117, 5, v1
    v_lshl_or_b32 v247, v117, 30, v247
    v_mov_b32 v117, 2304
    v_cmp_gt_u32 vcc, 16, v1
    v_mov_b32 v118, 1024
    s_nop 0
    v_cndmask_b32 v117, v117, v118, vcc
    v_add_u32 v8, v117, v25
    v_mov_b32 v7, v25
    v_add_u32 v9, 40960, v25
    v_add_u32 v10, 40960, v8
    v_lshrrev_b32 v116, 5, v1
    v_mul_u32_u24 v116, 40448, v116
    v_add_u32 v117, 3328, v25
    v_add_u32 v11, v116, v117
    v_add_u32 v12, 51200, v25
    v_add_u32 v226, 112128, v25
    v_min_u32 v13, 39, v1
    v_lshlrev_b32 v13, 3, v13
    v_and_b32 v116, 1, v126
    v_mul_u32_u24 v116, 2560, v116
    v_lshrrev_b32 v117, 1, v126
    v_mul_u32_u24 v117, 40960, v117
    v_lshlrev_b32 v118, 7, v125
    v_add3_u32 v253, v116, v117, v118
    s_lshl_b32 s42, s45, 1
    s_xor_b32 s42, s42, s7
    s_mul_i32 s42, s42, 5120
    s_mul_i32 s44, s5, 102400
    s_add_u32 s44, s44, 6291456
    s_add_u32 s42, s42, s44
    s_lshr_b32 s52, s5, 1
    s_add_u32 s43, s52, s7
    s_and_b32 s43, s43, 3
    s_add_u32 s43, s43, 16
    s_mul_i32 s43, s43, 5120
    s_add_u32 s50, s43, s44
    s_lshr_b32 s91, s5, 2
    s_lshl_b32 s91, s91, 9
    s_add_u32 s91, s91, 49152
    s_mul_i32 s44, s5, 160
    s_lshl_b32 s73, s38, 1
    s_add_u32 s73, s73, s44
    s_add_u32 s73, s73, 0
    s_lshl_b32 s56, s38, 1
    s_add_u32 s56, s56, 0
    s_add_u32 s43, s52, 0
    s_and_b32 s43, s43, 3
    s_mul_i32 s44, s43, 20480
    s_add_u32 s46, s44, s42
    s_lshl_b32 s43, s43, 1
    s_add_u32 s43, s43, s45
    s_mul_i32 s44, s43, 5120
    s_add_u32 s60, s44, s56
    s_xor_b32 s43, s43, 1
    s_mul_i32 s44, s43, 5120
    s_add_u32 s61, s44, s56
    s_add_u32 s43, s52, 1
    buffer_load_dwordx4 v18, s[8:11], s58 offen offset:1024 lds
    s_cmp_eq_u32 s39, 1280
    s_cselect_b32 s39, 0, s39
    s_and_b32 s43, s43, 3
    s_mul_i32 s44, s43, 20480
    s_add_u32 s47, s44, s42
    s_lshl_b32 s43, s43, 1
    s_add_u32 s43, s43, s45
    s_mul_i32 s44, s43, 5120
    s_add_u32 s62, s44, s56
    s_xor_b32 s43, s43, 1
    s_mul_i32 s44, s43, 5120
    s_add_u32 s63, s44, s56
    s_add_u32 s43, s52, 2
    s_and_b32 s43, s43, 3
    s_mul_i32 s44, s43, 20480
    s_add_u32 s48, s44, s42
    s_lshl_b32 s43, s43, 1
    s_add_u32 s43, s43, s45
    s_mul_i32 s44, s43, 5120
    s_add_u32 s64, s44, s56
    s_xor_b32 s43, s43, 1
    s_mul_i32 s44, s43, 5120
    s_add_u32 s65, s44, s56
    s_add_u32 s43, s52, 3
    s_and_b32 s43, s43, 3
    s_mul_i32 s44, s43, 20480
    s_add_u32 s49, s44, s42
    s_lshl_b32 s43, s43, 1
    s_add_u32 s43, s43, s45
    s_mul_i32 s44, s43, 5120
    s_add_u32 s66, s44, s56
    s_xor_b32 s43, s43, 1
    s_mul_i32 s44, s43, 5120
    s_add_u32 s67, s44, s56
    s_lshl_b32 s42, s4, 2
    s_add_u32 s42, s42, s7
    s_lshl_b32 s59, s42, 7
    s_add_u32 s59, s59, 4096
    s_lshl_b32 s42, s51, 16
    s_add_u32 s42, s42, 1048576
    s_lshl_b32 s43, s4, 12
    s_add_u32 s68, s42, s43
    s_min_u32 s43, s4, 14
    s_lshl_b32 s43, s43, 8
    s_add_u32 s69, s42, s43
    s_lshl_b32 s42, s51, 12
    s_add_u32 s71, s42, 5242880
    s_add_u32 s70, s71, s43
    s_lshr_b32 s43, s4, 2
    s_lshl_b32 s43, s43, 18
    s_add_u32 s71, s71, s43
    v_mul_u32_u24 v116, 40, v112
    v_add_lshl_u32 v228, v116, v113, 4
    v_mul_u32_u24 v116, 40, v112
    v_add_lshl_u32 v117, v116, v113, 4
    v_lshrrev_b32 v116, 3, v113
    v_lshl_or_b32 v14, v116, 28, v117
    v_lshrrev_b32 v116, 1, v112
    v_lshl_or_b32 v15, v116, 30, v228
    v_lshl_or_b32 v16, v116, 30, v14
    v_cmp_gt_u32 vcc, 4, v113
    s_nop 1
    v_cndmask_b32 v237, 0, -1, vcc
    buffer_load_dwordx4 v19, s[8:11], s58 offen offset:2048 lds
    v_mov_b32 v116, 0x3f803f80
    v_cmp_eq_u32 vcc, 4, v113
    s_nop 1
    v_cndmask_b32 v238, 0, v116, vcc
    v_and_b32 v116, 7, v1
    v_lshlrev_b32 v250, 2, v116
    s_lshl_b32 s42, s5, 2
    v_min_u32 v255, 1, v1
    v_lshlrev_b32 v255, 30, v255
    v_or_b32 v255, s42, v255
    v_lshlrev_b32 v252, 3, v0
    v_add_u32 v252, 110080, v252
    v_lshlrev_b32 v117, 12, v112
    v_lshl_add_u32 v229, v113, 4, v117
    v_lshlrev_b32 v230, 2, v1
    s_mul_i32 s42, s7, 1920
    s_add_u32 s42, s42, 102400
    v_add_u32 v116, 0, v1
    v_lshrrev_b32 v117, 4, v116
    v_and_b32 v118, 3, v116
    v_lshl_add_u32 v117, v117, 2, v118
    v_bfe_u32 v118, v116, 2, 2
    v_mul_u32_u24 v119, 6554, v117
    v_lshrrev_b32 v119, 16, v119
    v_mul_u32_u24 v120, 10, v119
    v_sub_u32 v117, v117, v120
    v_lshl_add_u32 v119, v119, 2, v118
    v_mul_u32_u24 v119, 80, v119
    v_lshl_add_u32 v119, v117, 3, v119
    v_add_u32 v232, s42, v119
    v_add_u32 v116, 64, v1
    v_lshrrev_b32 v117, 4, v116
    v_and_b32 v118, 3, v116
    v_lshl_add_u32 v117, v117, 2, v118
    v_bfe_u32 v118, v116, 2, 2
    v_mul_u32_u24 v119, 6554, v117
    v_lshrrev_b32 v119, 16, v119
    v_mul_u32_u24 v120, 10, v119
    v_sub_u32 v117, v117, v120
    v_lshl_add_u32 v119, v119, 2, v118
    v_mul_u32_u24 v119, 80, v119
    v_lshl_add_u32 v119, v117, 3, v119
    v_add_u32 v233, s42, v119
    v_add_u32 v116, 128, v1
    v_lshrrev_b32 v117, 4, v116
    v_and_b32 v118, 3, v116
    v_lshl_add_u32 v117, v117, 2, v118
    v_bfe_u32 v118, v116, 2, 2
    v_mul_u32_u24 v119, 6554, v117
    v_lshrrev_b32 v119, 16, v119
    v_mul_u32_u24 v120, 10, v119
    v_sub_u32 v117, v117, v120
    v_lshl_add_u32 v119, v119, 2, v118
    v_mul_u32_u24 v119, 80, v119
    v_lshl_add_u32 v119, v117, 3, v119
    v_add_u32 v234, s42, v119
    v_add_u32 v116, 192, v1
    v_subrev_u32 v117, 64, v116
    v_cmp_gt_u32 vcc, 240, v116
    s_nop 1
    v_cndmask_b32 v116, v117, v116, vcc
    v_lshlrev_b32 v231, 4, v116
    buffer_load_dwordx4 v20, s[8:11], s58 offen offset:3072 lds
    v_lshrrev_b32 v117, 4, v116
    v_and_b32 v118, 3, v116
    v_lshl_add_u32 v117, v117, 2, v118
    v_bfe_u32 v118, v116, 2, 2
    v_mul_u32_u24 v119, 6554, v117
    v_lshrrev_b32 v119, 16, v119
    v_mul_u32_u24 v120, 10, v119
    v_sub_u32 v117, v117, v120
    v_lshl_add_u32 v119, v119, 2, v118
    v_mul_u32_u24 v119, 80, v119
    v_lshl_add_u32 v119, v117, 3, v119
    v_add_u32 v235, s42, v119
    v_cmp_eq_u32 vcc, v112, v114
    v_mul_u32_u24 v116, 1920, v112
    v_mul_u32_u24 v117, 80, v115
    v_add_u32 v116, v116, v117
    v_add_u32 v116, 102400, v116
    v_mov_b32 v117, 110144
    v_cndmask_b32 v236, v117, v116, vcc
    v_mov_b32 v148, 0
    v_mov_b32 v149, 0
    v_mov_b32 v150, 0
    v_mov_b32 v151, 0
    v_add_u32 v212, s41, v25
    ds_write_b128 v212, v[148:151] offset:13312
    v_mul_u32_u24 v116, 15360, v112
    v_mul_u32_u24 v117, 40, v114
    v_add_u32 v116, v116, v117
    v_add_u32 v116, 114688, v116
    s_add_u32 s42, s41, 13312
    v_mov_b32 v117, s42
    v_cmp_eq_u32 vcc, v115, v112
    s_nop 1
    v_cndmask_b32 v31, v117, v116, vcc
    v_accvgpr_write_b32 a170, 0
    v_accvgpr_write_b32 a171, 0
    v_accvgpr_write_b32 a182, 0
    v_accvgpr_write_b32 a183, 0
    v_accvgpr_write_b32 a194, 0
    v_accvgpr_write_b32 a195, 0
    v_accvgpr_write_b32 a206, 0
    v_accvgpr_write_b32 a207, 0
    v_accvgpr_write_b32 a218, 0
    v_accvgpr_write_b32 a219, 0
    s_mov_b64 exec, 0
    s_cmp_eq_u32 s7, 0
    s_cbranch_scc1 L_hop0A
    s_cmp_eq_u32 s7, 1
    s_cbranch_scc1 L_hop1A
    s_cmp_eq_u32 s7, 2
    s_cbranch_scc1 L_hop2A
    s_branch L_hop3A
L_hopretA:
    s_mov_b64 exec, -1
    s_mul_i32 s57, s51, 800
    buffer_load_dwordx4 v[208:211], v25, s[28:31], s57 offen
    s_add_u32 m0, s40, 20480
    s_add_u32 s57, s34, 1280
    buffer_load_dwordx4 v2, s[12:15], s57 offen lds
    buffer_load_dwordx4 v3, s[12:15], s57 offen offset:1024 lds
    buffer_load_dwordx4 v4, s[12:15], s57 offen offset:2048 lds
    buffer_load_dwordx4 v5, s[12:15], s57 offen offset:3072 lds
    s_add_u32 m0, s40, 24576
    s_nop 0
    buffer_load_dwordx4 v6, s[12:15], s57 offen lds
    s_getreg_b32 s42, hwreg(HW_REG_XCC_ID, 0, 4)
    s_waitcnt lgkmcnt(0)
    s_add_u32 s32, s32, 0x9e3779b1
    s_lshl_b32 s42, s42, 28
    s_xor_b32 s74, s42, s32
    v_mov_b32 v254, s32
    v_and_b32 v27, 1, v1
    v_lshlrev_b32 v27, 4, v27
    v_lshrrev_b32 v27, v27, v254
    v_mov_b32 v29, s74
    s_add_u32 s93, s59, 28672
    s_branch L_mainA
.p2align 12
L_mainA:
L_hop0A:
    s_cbranch_execz L_hop4A
    s_waitcnt vmcnt(10)
    s_barrier
    ds_read_b128 a[0:3], v21 offset:0
    ds_read_b128 a[4:7], v21 offset:2048
    ds_read_b128 a[8:11], v22 offset:0
    ds_read_b128 a[12:15], v22 offset:2048
    ds_read_b64_tr_b16 a[220:221], v23 offset:0
    ds_read_b64_tr_b16 a[222:223], v23 offset:2560
    ds_read_b64_tr_b16 a[224:225], v23 offset:8
    ds_read_b64_tr_b16 a[226:227], v23 offset:2568
    ds_read_b64_tr_b16 a[228:229], v23 offset:16
    ds_read_b64_tr_b16 a[230:231], v23 offset:2576
    ds_read_b64_tr_b16 a[232:233], v23 offset:24
    ds_read_b64_tr_b16 a[234:235], v23 offset:2584
    ds_read_b64_tr_b16 a[236:237], v23 offset:32
    ds_read_b64_tr_b16 a[238:239], v23 offset:2592
    s_waitcnt lgkmcnt(8)
    v_mfma_f32_16x16x32_bf16 v[32:35], a[220:223], a[0:3], 0
    s_waitcnt lgkmcnt(6)
    ds_read_b64_tr_b16 a[240:241], v23 offset:5120
    ds_read_b64_tr_b16 a[242:243], v23 offset:7680
    v_mfma_f32_16x16x32_bf16 v[52:55], a[220:223], a[4:7], 0
    s_add_u32 m0, s41, 8192
    s_add_u32 s58, s39, s38
    buffer_load_dwordx4 v17, s[8:11], s58 offen lds
    s_add_u32 s39, s39, 128
    v_mfma_f32_16x16x32_bf16 v[36:39], a[224:227], a[0:3], 0
    s_waitcnt lgkmcnt(6)
    ds_read_b64_tr_b16 a[220:221], v23 offset:5128
    ds_read_b64_tr_b16 a[222:223], v23 offset:7688
    v_mfma_f32_16x16x32_bf16 v[56:59], a[224:227], a[4:7], 0
    buffer_load_dwordx4 v18, s[8:11], s58 offen offset:1024 lds
    s_cmp_eq_u32 s39, 1280
    s_cselect_b32 s39, 0, s39
    v_mfma_f32_16x16x32_bf16 v[40:43], a[228:231], a[0:3], 0
    s_waitcnt lgkmcnt(6)
    ds_read_b64_tr_b16 a[224:225], v23 offset:5136
    ds_read_b64_tr_b16 a[226:227], v23 offset:7696
    v_mfma_f32_16x16x32_bf16 v[60:63], a[228:231], a[4:7], 0
    v_mfma_f32_16x16x32_bf16 v[44:47], a[232:235], a[0:3], 0
    s_waitcnt lgkmcnt(6)
    ds_read_b64_tr_b16 a[228:229], v23 offset:5144
    ds_read_b64_tr_b16 a[230:231], v23 offset:7704
    v_mfma_f32_16x16x32_bf16 v[64:67], a[232:235], a[4:7], 0
    buffer_load_dwordx4 v19, s[8:11], s58 offen offset:2048 lds
    v_mfma_f32_16x16x32_bf16 v[48:51], a[236:239], a[0:3], 0
    s_waitcnt lgkmcnt(6)
    ds_read_b64_tr_b16 a[232:233], v23 offset:5152
    ds_read_b64_tr_b16 a[234:235], v23 offset:7712
    v_mfma_f32_16x16x32_bf16 v[68:71], a[236:239], a[4:7], 0
    buffer_load_dwordx4 v20, s[8:11], s58 offen offset:3072 lds
    v_mfma_f32_16x16x32_bf16 v[32:35], a[240:243], a[8:11], v[32:35]
    s_waitcnt lgkmcnt(6)
    ds_read_b64_tr_b16 a[236:237], v23 offset:10240
    ds_read_b64_tr_b16 a[238:239], v23 offset:12800
    v_mfma_f32_16x16x32_bf16 v[52:55], a[240:243], a[12:15], v[52:55]
    s_waitcnt vmcnt(10)
    ds_read_b128 a[16:19], v21 offset:4096
    ds_read_b128 a[20:23], v21 offset:6144
    v_mfma_f32_16x16x32_bf16 v[36:39], a[220:223], a[8:11], v[36:39]
    s_waitcnt lgkmcnt(8)
    ds_read_b64_tr_b16 a[240:241], v23 offset:10248
    ds_read_b64_tr_b16 a[242:243], v23 offset:12808
    v_mfma_f32_16x16x32_bf16 v[56:59], a[220:223], a[12:15], v[56:59]
    s_add_u32 m0, s41, 0
    s_add_u32 s58, s39, s38
    buffer_load_dwordx4 v17, s[8:11], s58 offen lds
    s_add_u32 s39, s39, 128
    ds_read_b128 a[24:27], v22 offset:4096
    ds_read_b128 a[28:31], v22 offset:6144
    v_mfma_f32_16x16x32_bf16 v[40:43], a[224:227], a[8:11], v[40:43]
    s_waitcnt lgkmcnt(10)
    ds_read_b64_tr_b16 a[220:221], v23 offset:10256
    ds_read_b64_tr_b16 a[222:223], v23 offset:12816
    v_mfma_f32_16x16x32_bf16 v[60:63], a[224:227], a[12:15], v[60:63]
    buffer_load_dwordx4 v18, s[8:11], s58 offen offset:1024 lds
    s_cmp_eq_u32 s39, 1280
    s_cselect_b32 s39, 0, s39
    v_mfma_f32_16x16x32_bf16 v[44:47], a[228:231], a[8:11], v[44:47]
    s_waitcnt lgkmcnt(10)
    ds_read_b64_tr_b16 a[224:225], v23 offset:10264
    ds_read_b64_tr_b16 a[226:227], v23 offset:12824
    v_mfma_f32_16x16x32_bf16 v[64:67], a[228:231], a[12:15], v[64:67]
    s_waitcnt vmcnt(11)
    v_lshlrev_b32 v214, 16, v208
    v_and_b32 v215, 0xffff0000, v208
    v_mul_f32 v214, s54, v214
    v_mul_f32 v215, s54, v215
    v_cvt_pk_bf16_f32 v208, v214, v215
    v_lshlrev_b32 v214, 16, v209
    v_and_b32 v215, 0xffff0000, v209
    v_mul_f32 v214, s54, v214
    v_mul_f32 v215, s54, v215
    v_cvt_pk_bf16_f32 v209, v214, v215
    v_lshlrev_b32 v214, 16, v210
    v_and_b32 v215, 0xffff0000, v210
    v_mul_f32 v214, s54, v214
    v_mul_f32 v215, s54, v215
    v_cvt_pk_bf16_f32 v210, v214, v215
    v_lshlrev_b32 v214, 16, v211
    v_and_b32 v215, 0xffff0000, v211
    v_mul_f32 v214, s54, v214
    v_mul_f32 v215, s54, v215
    v_cvt_pk_bf16_f32 v211, v214, v215
    ds_write_b128 v212, v[208:211] offset:12288
    v_mfma_f32_16x16x32_bf16 v[48:51], a[232:235], a[8:11], v[48:51]
    s_waitcnt lgkmcnt(5)
    ds_read_b64_tr_b16 a[228:229], v23 offset:10272
    ds_read_b64_tr_b16 a[230:231], v23 offset:12832
    v_mfma_f32_16x16x32_bf16 v[68:71], a[232:235], a[12:15], v[68:71]
    buffer_load_dwordx4 v19, s[8:11], s58 offen offset:2048 lds
    v_mfma_f32_16x16x32_bf16 v[32:35], a[236:239], a[16:19], v[32:35]
    s_nop 0
    ds_read_b64_tr_b16 a[232:233], v23 offset:15360
    ds_read_b64_tr_b16 a[234:235], v23 offset:17920
    v_mfma_f32_16x16x32_bf16 v[52:55], a[236:239], a[20:23], v[52:55]
    buffer_load_dwordx4 v20, s[8:11], s58 offen offset:3072 lds
    v_mfma_f32_16x16x32_bf16 v[36:39], a[240:243], a[16:19], v[36:39]
    s_waitcnt lgkmcnt(7)
    ds_read_b64_tr_b16 a[236:237], v23 offset:15368
    ds_read_b64_tr_b16 a[238:239], v23 offset:17928
    v_mfma_f32_16x16x32_bf16 v[56:59], a[240:243], a[20:23], v[56:59]
    v_mfma_f32_16x16x32_bf16 v[40:43], a[220:223], a[16:19], v[40:43]
    s_waitcnt lgkmcnt(7)
    ds_read_b64_tr_b16 a[240:241], v23 offset:15376
    ds_read_b64_tr_b16 a[242:243], v23 offset:17936
    v_mfma_f32_16x16x32_bf16 v[60:63], a[220:223], a[20:23], v[60:63]
    s_add_u32 m0, s40, 40960
    s_add_u32 s57, s35, 1280
    buffer_load_dwordx4 v2, s[12:15], s57 offen lds
    v_mfma_f32_16x16x32_bf16 v[44:47], a[224:227], a[16:19], v[44:47]
    s_waitcnt lgkmcnt(6)
    ds_read_b64_tr_b16 a[220:221], v23 offset:15384
    ds_read_b64_tr_b16 a[222:223], v23 offset:17944
    v_mfma_f32_16x16x32_bf16 v[64:67], a[224:227], a[20:23], v[64:67]
    buffer_load_dwordx4 v3, s[12:15], s57 offen offset:1024 lds
    v_mfma_f32_16x16x32_bf16 v[48:51], a[228:231], a[16:19], v[48:51]
    s_waitcnt lgkmcnt(6)
    ds_read_b64_tr_b16 a[224:225], v23 offset:15392
    ds_read_b64_tr_b16 a[226:227], v23 offset:17952
    v_mfma_f32_16x16x32_bf16 v[68:71], a[228:231], a[20:23], v[68:71]
    v_mfma_f32_16x16x32_bf16 v[32:35], a[232:235], a[24:27], v[32:35]
    s_waitcnt lgkmcnt(6)
    s_waitcnt vmcnt(10)
    s_barrier
    ds_read_b64_tr_b16 a[228:229], v23 offset:20480
    ds_read_b64_tr_b16 a[230:231], v23 offset:23040
    v_mfma_f32_16x16x32_bf16 v[52:55], a[232:235], a[28:31], v[52:55]
    buffer_load_dwordx4 v4, s[12:15], s57 offen offset:2048 lds
    s_waitcnt vmcnt(7)
    ds_read_b128 a[32:35], v21 offset:8192
    ds_read_b128 a[36:39], v21 offset:10240
    v_mfma_f32_16x16x32_bf16 v[36:39], a[236:239], a[24:27], v[36:39]
    s_waitcnt lgkmcnt(8)
    ds_read_b64_tr_b16 a[232:233], v23 offset:20488
    ds_read_b64_tr_b16 a[234:235], v23 offset:23048
    v_mfma_f32_16x16x32_bf16 v[56:59], a[236:239], a[28:31], v[56:59]
    buffer_load_dwordx4 v5, s[12:15], s57 offen offset:3072 lds
    s_add_u32 m0, s40, 45056
    ds_read_b128 a[40:43], v22 offset:8192
    ds_read_b128 a[44:47], v22 offset:10240
    v_mfma_f32_16x16x32_bf16 v[40:43], a[240:243], a[24:27], v[40:43]
    s_waitcnt lgkmcnt(10)
    ds_read_b64_tr_b16 a[236:237], v23 offset:20496
    ds_read_b64_tr_b16 a[238:239], v23 offset:23056
    v_mfma_f32_16x16x32_bf16 v[60:63], a[240:243], a[28:31], v[60:63]
    v_mfma_f32_16x16x32_bf16 v[44:47], a[220:223], a[24:27], v[44:47]
    s_waitcnt lgkmcnt(10)
    ds_read_b64_tr_b16 a[240:241], v23 offset:20504
    ds_read_b64_tr_b16 a[242:243], v23 offset:23064
    v_mfma_f32_16x16x32_bf16 v[64:67], a[220:223], a[28:31], v[64:67]
    buffer_load_dwordx4 v6, s[12:15], s57 offen lds
    v_mfma_f32_16x16x32_bf16 v[48:51], a[224:227], a[24:27], v[48:51]
    s_waitcnt lgkmcnt(4)
    ds_read_b64_tr_b16 a[220:221], v23 offset:20512
    ds_read_b64_tr_b16 a[222:223], v23 offset:23072
    v_mfma_f32_16x16x32_bf16 v[68:71], a[224:227], a[28:31], v[68:71]
    s_add_u32 m0, s41, 4096
    s_add_u32 s58, s39, s38
    buffer_load_dwordx4 v17, s[8:11], s58 offen lds
    s_add_u32 s39, s39, 128
    v_mfma_f32_16x16x32_bf16 v[32:35], a[228:231], a[32:35], v[32:35]
    s_nop 0
    ds_read_b64_tr_b16 a[224:225], v23 offset:25600
    ds_read_b64_tr_b16 a[226:227], v23 offset:28160
    v_mfma_f32_16x16x32_bf16 v[52:55], a[228:231], a[36:39], v[52:55]
    v_mfma_f32_16x16x32_bf16 v[36:39], a[232:235], a[32:35], v[36:39]
    s_waitcnt lgkmcnt(6)
    ds_read_b64_tr_b16 a[228:229], v23 offset:25608
    ds_read_b64_tr_b16 a[230:231], v23 offset:28168
    v_mfma_f32_16x16x32_bf16 v[56:59], a[232:235], a[36:39], v[56:59]
    buffer_load_dwordx4 v18, s[8:11], s58 offen offset:1024 lds
    s_cmp_eq_u32 s39, 1280
    s_cselect_b32 s39, 0, s39
    ds_read_b64_tr_b16 a[160:161], v31 offset:0
    v_mfma_f32_16x16x32_bf16 v[40:43], a[236:239], a[32:35], v[40:43]
    s_waitcnt lgkmcnt(7)
    ds_read_b64_tr_b16 a[232:233], v23 offset:25616
    ds_read_b64_tr_b16 a[234:235], v23 offset:28176
    v_mfma_f32_16x16x32_bf16 v[60:63], a[236:239], a[36:39], v[60:63]
    buffer_load_dwordx4 v19, s[8:11], s58 offen offset:2048 lds
    ds_read_b64_tr_b16 a[162:163], v31 offset:160
    v_mfma_f32_16x16x32_bf16 v[44:47], a[240:243], a[32:35], v[44:47]
    s_waitcnt lgkmcnt(8)
    ds_read_b64_tr_b16 a[236:237], v23 offset:25624
    ds_read_b64_tr_b16 a[238:239], v23 offset:28184
    v_mfma_f32_16x16x32_bf16 v[64:67], a[240:243], a[36:39], v[64:67]
    ds_read_b64_tr_b16 a[164:165], v31 offset:320
    v_mfma_f32_16x16x32_bf16 v[48:51], a[220:223], a[32:35], v[48:51]
    s_waitcnt lgkmcnt(9)
    ds_read_b64_tr_b16 a[240:241], v23 offset:25632
    ds_read_b64_tr_b16 a[242:243], v23 offset:28192
    v_mfma_f32_16x16x32_bf16 v[68:71], a[220:223], a[36:39], v[68:71]
    buffer_load_dwordx4 v20, s[8:11], s58 offen offset:3072 lds
    v_mfma_f32_16x16x32_bf16 v[32:35], a[224:227], a[40:43], v[32:35]
    s_waitcnt lgkmcnt(9)
    ds_read_b64_tr_b16 a[220:221], v23 offset:30720
    ds_read_b64_tr_b16 a[222:223], v23 offset:33280
    v_mfma_f32_16x16x32_bf16 v[52:55], a[224:227], a[44:47], v[52:55]
    s_add_u32 m0, s41, 8192
    s_add_u32 s58, s39, s38
    buffer_load_dwordx4 v17, s[8:11], s58 offen lds
    s_add_u32 s39, s39, 128
    s_waitcnt vmcnt(10)
    ds_read_b128 a[48:51], v21 offset:0
    ds_read_b128 a[52:55], v21 offset:2048
    v_mfma_f32_16x16x32_bf16 v[36:39], a[228:231], a[40:43], v[36:39]
    s_waitcnt lgkmcnt(10)
    ds_read_b64_tr_b16 a[224:225], v23 offset:30728
    ds_read_b64_tr_b16 a[226:227], v23 offset:33288
    v_mfma_f32_16x16x32_bf16 v[56:59], a[228:231], a[44:47], v[56:59]
    ds_read_b128 a[56:59], v22 offset:0
    ds_read_b128 a[60:63], v22 offset:2048
    v_mfma_f32_16x16x32_bf16 v[40:43], a[232:235], a[40:43], v[40:43]
    s_waitcnt lgkmcnt(11)
    ds_read_b64_tr_b16 a[228:229], v23 offset:30736
    ds_read_b64_tr_b16 a[230:231], v23 offset:33296
    v_mfma_f32_16x16x32_bf16 v[60:63], a[232:235], a[44:47], v[60:63]
    buffer_load_dwordx4 v18, s[8:11], s58 offen offset:1024 lds
    s_cmp_eq_u32 s39, 1280
    s_cselect_b32 s39, 0, s39
    v_mfma_f32_16x16x32_bf16 v[44:47], a[236:239], a[40:43], v[44:47]
    s_waitcnt lgkmcnt(10)
    ds_read_b64_tr_b16 a[232:233], v23 offset:30744
    ds_read_b64_tr_b16 a[234:235], v23 offset:33304
    v_mfma_f32_16x16x32_bf16 v[64:67], a[236:239], a[44:47], v[64:67]
    buffer_load_dwordx4 v19, s[8:11], s58 offen offset:2048 lds
    v_mfma_f32_16x16x32_bf16 v[48:51], a[240:243], a[40:43], v[48:51]
    s_waitcnt lgkmcnt(4)
    ds_read_b64_tr_b16 a[236:237], v23 offset:30752
    ds_read_b64_tr_b16 a[238:239], v23 offset:33312
    v_mfma_f32_16x16x32_bf16 v[68:71], a[240:243], a[44:47], v[68:71]
    v_mfma_f32_16x16x32_bf16 v[32:35], a[220:223], a[48:51], v[32:35]
    s_nop 0
    ds_read_b64_tr_b16 a[240:241], v23 offset:35840
    ds_read_b64_tr_b16 a[242:243], v23 offset:38400
    v_mfma_f32_16x16x32_bf16 v[52:55], a[220:223], a[52:55], v[52:55]
    buffer_load_dwordx4 v20, s[8:11], s58 offen offset:3072 lds
    ds_read_b64_tr_b16 a[166:167], v31 offset:480
    v_mfma_f32_16x16x32_bf16 v[36:39], a[224:227], a[48:51], v[36:39]
    s_waitcnt lgkmcnt(7)
    ds_read_b64_tr_b16 a[220:221], v23 offset:35848
    ds_read_b64_tr_b16 a[222:223], v23 offset:38408
    v_mfma_f32_16x16x32_bf16 v[56:59], a[224:227], a[52:55], v[56:59]
    s_add_u32 m0, s40, 61440
    s_add_u32 s57, s36, 1280
    buffer_load_dwordx4 v2, s[12:15], s57 offen lds
    ds_read_b64_tr_b16 a[168:169], v31 offset:640
    v_mfma_f32_16x16x32_bf16 v[40:43], a[228:231], a[48:51], v[40:43]
    s_waitcnt lgkmcnt(8)
    ds_read_b64_tr_b16 a[224:225], v23 offset:35856
    ds_read_b64_tr_b16 a[226:227], v23 offset:38416
    v_mfma_f32_16x16x32_bf16 v[60:63], a[228:231], a[52:55], v[60:63]
    ds_read_b64_tr_b16 a[172:173], v31 offset:8
    v_mfma_f32_16x16x32_bf16 v[44:47], a[232:235], a[48:51], v[44:47]
    s_waitcnt lgkmcnt(9)
    ds_read_b64_tr_b16 a[228:229], v23 offset:35864
    ds_read_b64_tr_b16 a[230:231], v23 offset:38424
    v_mfma_f32_16x16x32_bf16 v[64:67], a[232:235], a[52:55], v[64:67]
    buffer_load_dwordx4 v3, s[12:15], s57 offen offset:1024 lds
    ds_read_b64_tr_b16 a[174:175], v31 offset:168
    v_mfma_f32_16x16x32_bf16 v[48:51], a[236:239], a[48:51], v[48:51]
    s_waitcnt lgkmcnt(10)
    ds_read_b64_tr_b16 a[232:233], v23 offset:35872
    ds_read_b64_tr_b16 a[234:235], v23 offset:38432
    v_mfma_f32_16x16x32_bf16 v[68:71], a[236:239], a[52:55], v[68:71]
    buffer_load_dwordx4 v4, s[12:15], s57 offen offset:2048 lds
    v_mfma_f32_16x16x32_bf16 v[32:35], a[240:243], a[56:59], v[32:35]
    s_waitcnt lgkmcnt(9)
    s_waitcnt vmcnt(11)
    s_barrier
    ds_read_b64_tr_b16 a[236:237], v23 offset:40960
    ds_read_b64_tr_b16 a[238:239], v23 offset:43520
    v_mfma_f32_16x16x32_bf16 v[52:55], a[240:243], a[60:63], v[52:55]
    s_waitcnt vmcnt(7)
    ds_read_b128 a[64:67], v21 offset:4096
    ds_read_b128 a[68:71], v21 offset:6144
    v_mfma_f32_16x16x32_bf16 v[36:39], a[220:223], a[56:59], v[36:39]
    s_waitcnt lgkmcnt(10)
    ds_read_b64_tr_b16 a[240:241], v23 offset:40968
    ds_read_b64_tr_b16 a[242:243], v23 offset:43528
    v_mfma_f32_16x16x32_bf16 v[56:59], a[220:223], a[60:63], v[56:59]
    buffer_load_dwordx4 v5, s[12:15], s57 offen offset:3072 lds
    s_add_u32 m0, s40, 65536
    ds_read_b128 a[72:75], v22 offset:4096
    ds_read_b128 a[76:79], v22 offset:6144
    v_mfma_f32_16x16x32_bf16 v[40:43], a[224:227], a[56:59], v[40:43]
    s_waitcnt lgkmcnt(11)
    ds_read_b64_tr_b16 a[220:221], v23 offset:40976
    ds_read_b64_tr_b16 a[222:223], v23 offset:43536
    v_mfma_f32_16x16x32_bf16 v[60:63], a[224:227], a[60:63], v[60:63]
    buffer_load_dwordx4 v6, s[12:15], s57 offen lds
    v_mfma_f32_16x16x32_bf16 v[44:47], a[228:231], a[56:59], v[44:47]
    s_waitcnt lgkmcnt(10)
    ds_read_b64_tr_b16 a[224:225], v23 offset:40984
    ds_read_b64_tr_b16 a[226:227], v23 offset:43544
    v_mfma_f32_16x16x32_bf16 v[64:67], a[228:231], a[60:63], v[64:67]
    v_mfma_f32_16x16x32_bf16 v[48:51], a[232:235], a[56:59], v[48:51]
    s_waitcnt lgkmcnt(4)
    ds_read_b64_tr_b16 a[228:229], v23 offset:40992
    ds_read_b64_tr_b16 a[230:231], v23 offset:43552
    v_mfma_f32_16x16x32_bf16 v[68:71], a[232:235], a[60:63], v[68:71]
    s_add_u32 m0, s41, 0
    s_add_u32 s58, s39, s38
    buffer_load_dwordx4 v17, s[8:11], s58 offen lds
    s_add_u32 s39, s39, 128
    v_mfma_f32_16x16x32_bf16 v[32:35], a[236:239], a[64:67], v[32:35]
    s_nop 0
    ds_read_b64_tr_b16 a[232:233], v23 offset:46080
    ds_read_b64_tr_b16 a[234:235], v23 offset:48640
    v_mfma_f32_16x16x32_bf16 v[52:55], a[236:239], a[68:71], v[52:55]
    buffer_load_dwordx4 v18, s[8:11], s58 offen offset:1024 lds
    s_cmp_eq_u32 s39, 1280
    s_cselect_b32 s39, 0, s39
    ds_read_b64_tr_b16 a[176:177], v31 offset:328
    v_mfma_f32_16x16x32_bf16 v[36:39], a[240:243], a[64:67], v[36:39]
    s_waitcnt lgkmcnt(7)
    ds_read_b64_tr_b16 a[236:237], v23 offset:46088
    ds_read_b64_tr_b16 a[238:239], v23 offset:48648
    v_mfma_f32_16x16x32_bf16 v[56:59], a[240:243], a[68:71], v[56:59]
    ds_read_b64_tr_b16 a[178:179], v31 offset:488
    v_mfma_f32_16x16x32_bf16 v[40:43], a[220:223], a[64:67], v[40:43]
    s_waitcnt lgkmcnt(8)
    ds_read_b64_tr_b16 a[240:241], v23 offset:46096
    ds_read_b64_tr_b16 a[242:243], v23 offset:48656
    v_mfma_f32_16x16x32_bf16 v[60:63], a[220:223], a[68:71], v[60:63]
    buffer_load_dwordx4 v19, s[8:11], s58 offen offset:2048 lds
    ds_read_b64_tr_b16 a[180:181], v31 offset:648
    v_mfma_f32_16x16x32_bf16 v[44:47], a[224:227], a[64:67], v[44:47]
    s_waitcnt lgkmcnt(9)
    ds_read_b64_tr_b16 a[220:221], v23 offset:46104
    ds_read_b64_tr_b16 a[222:223], v23 offset:48664
    v_mfma_f32_16x16x32_bf16 v[64:67], a[224:227], a[68:71], v[64:67]
    buffer_load_dwordx4 v20, s[8:11], s58 offen offset:3072 lds
    ds_read_b64_tr_b16 a[184:185], v31 offset:16
    v_mfma_f32_16x16x32_bf16 v[48:51], a[228:231], a[64:67], v[48:51]
    s_waitcnt lgkmcnt(10)
    ds_read_b64_tr_b16 a[224:225], v23 offset:46112
    ds_read_b64_tr_b16 a[226:227], v23 offset:48672
    v_mfma_f32_16x16x32_bf16 v[68:71], a[228:231], a[68:71], v[68:71]
    v_mfma_f32_16x16x32_bf16 v[32:35], a[232:235], a[72:75], v[32:35]
    s_waitcnt lgkmcnt(9)
    ds_read_b64_tr_b16 a[228:229], v24 offset:0
    ds_read_b64_tr_b16 a[230:231], v24 offset:2560
    v_mfma_f32_16x16x32_bf16 v[52:55], a[232:235], a[76:79], v[52:55]
    s_add_u32 m0, s41, 4096
    s_add_u32 s58, s39, s38
    buffer_load_dwordx4 v17, s[8:11], s58 offen lds
    s_add_u32 s39, s39, 128
    s_waitcnt vmcnt(10)
    ds_read_b128 a[80:83], v21 offset:8192
    ds_read_b128 a[84:87], v21 offset:10240
    v_mfma_f32_16x16x32_bf16 v[36:39], a[236:239], a[72:75], v[36:39]
    s_waitcnt lgkmcnt(10)
    ds_read_b64_tr_b16 a[232:233], v24 offset:8
    ds_read_b64_tr_b16 a[234:235], v24 offset:2568
    v_mfma_f32_16x16x32_bf16 v[56:59], a[236:239], a[76:79], v[56:59]
    buffer_load_dwordx4 v18, s[8:11], s58 offen offset:1024 lds
    s_cmp_eq_u32 s39, 1280
    s_cselect_b32 s39, 0, s39
    ds_read_b128 a[88:91], v22 offset:8192
    ds_read_b128 a[92:95], v22 offset:10240
    v_mfma_f32_16x16x32_bf16 v[40:43], a[240:243], a[72:75], v[40:43]
    s_waitcnt lgkmcnt(11)
    ds_read_b64_tr_b16 a[236:237], v24 offset:16
    ds_read_b64_tr_b16 a[238:239], v24 offset:2576
    v_mfma_f32_16x16x32_bf16 v[60:63], a[240:243], a[76:79], v[60:63]
    v_mfma_f32_16x16x32_bf16 v[44:47], a[220:223], a[72:75], v[44:47]
    s_waitcnt lgkmcnt(10)
    ds_read_b64_tr_b16 a[240:241], v24 offset:24
    ds_read_b64_tr_b16 a[242:243], v24 offset:2584
    v_mfma_f32_16x16x32_bf16 v[64:67], a[220:223], a[76:79], v[64:67]
    buffer_load_dwordx4 v19, s[8:11], s58 offen offset:2048 lds
    v_mfma_f32_16x16x32_bf16 v[48:51], a[224:227], a[72:75], v[48:51]
    s_waitcnt lgkmcnt(4)
    ds_read_b64_tr_b16 a[220:221], v24 offset:32
    ds_read_b64_tr_b16 a[222:223], v24 offset:2592
    v_mfma_f32_16x16x32_bf16 v[68:71], a[224:227], a[76:79], v[68:71]
    buffer_load_dwordx4 v20, s[8:11], s58 offen offset:3072 lds
    v_mfma_f32_16x16x32_bf16 v[32:35], a[228:231], a[80:83], v[32:35]
    s_nop 0
    ds_read_b64_tr_b16 a[224:225], v24 offset:5120
    ds_read_b64_tr_b16 a[226:227], v24 offset:7680
    v_mfma_f32_16x16x32_bf16 v[52:55], a[228:231], a[84:87], v[52:55]
    ds_read_b64_tr_b16 a[186:187], v31 offset:176
    v_mfma_f32_16x16x32_bf16 v[36:39], a[232:235], a[80:83], v[36:39]
    s_waitcnt lgkmcnt(7)
    ds_read_b64_tr_b16 a[228:229], v24 offset:5128
    ds_read_b64_tr_b16 a[230:231], v24 offset:7688
    v_mfma_f32_16x16x32_bf16 v[56:59], a[232:235], a[84:87], v[56:59]
    s_add_u32 m0, s40, 81920
    s_add_u32 s57, s37, 1280
    buffer_load_dwordx4 v2, s[12:15], s57 offen lds
    ds_read_b64_tr_b16 a[188:189], v31 offset:336
    v_mfma_f32_16x16x32_bf16 v[40:43], a[236:239], a[80:83], v[40:43]
    s_waitcnt lgkmcnt(8)
    ds_read_b64_tr_b16 a[232:233], v24 offset:5136
    ds_read_b64_tr_b16 a[234:235], v24 offset:7696
    v_mfma_f32_16x16x32_bf16 v[60:63], a[236:239], a[84:87], v[60:63]
    buffer_load_dwordx4 v3, s[12:15], s57 offen offset:1024 lds
    ds_read_b64_tr_b16 a[190:191], v31 offset:496
    v_mfma_f32_16x16x32_bf16 v[44:47], a[240:243], a[80:83], v[44:47]
    s_waitcnt lgkmcnt(9)
    ds_read_b64_tr_b16 a[236:237], v24 offset:5144
    ds_read_b64_tr_b16 a[238:239], v24 offset:7704
    v_mfma_f32_16x16x32_bf16 v[64:67], a[240:243], a[84:87], v[64:67]
    ds_read_b64_tr_b16 a[192:193], v31 offset:656
    v_mfma_f32_16x16x32_bf16 v[48:51], a[220:223], a[80:83], v[48:51]
    s_waitcnt lgkmcnt(10)
    ds_read_b64_tr_b16 a[240:241], v24 offset:5152
    ds_read_b64_tr_b16 a[242:243], v24 offset:7712
    v_mfma_f32_16x16x32_bf16 v[68:71], a[220:223], a[84:87], v[68:71]
    buffer_load_dwordx4 v4, s[12:15], s57 offen offset:2048 lds
    v_mfma_f32_16x16x32_bf16 v[32:35], a[224:227], a[88:91], v[32:35]
    s_waitcnt lgkmcnt(9)
    s_waitcnt vmcnt(11)
    s_barrier
    ds_read_b64_tr_b16 a[220:221], v24 offset:10240
    ds_read_b64_tr_b16 a[222:223], v24 offset:12800
    v_mfma_f32_16x16x32_bf16 v[52:55], a[224:227], a[92:95], v[52:55]
    buffer_load_dwordx4 v5, s[12:15], s57 offen offset:3072 lds
    s_add_u32 m0, s40, 86016
    s_waitcnt vmcnt(8)
    ds_read_b128 a[96:99], v21 offset:0
    ds_read_b128 a[100:103], v21 offset:2048
    v_mfma_f32_16x16x32_bf16 v[36:39], a[228:231], a[88:91], v[36:39]
    s_waitcnt lgkmcnt(10)
    ds_read_b64_tr_b16 a[224:225], v24 offset:10248
    ds_read_b64_tr_b16 a[226:227], v24 offset:12808
    v_mfma_f32_16x16x32_bf16 v[56:59], a[228:231], a[92:95], v[56:59]
    ds_read_b128 a[104:107], v22 offset:0
    ds_read_b128 a[108:111], v22 offset:2048
    v_mfma_f32_16x16x32_bf16 v[40:43], a[232:235], a[88:91], v[40:43]
    s_waitcnt lgkmcnt(11)
    ds_read_b64_tr_b16 a[228:229], v24 offset:10256
    ds_read_b64_tr_b16 a[230:231], v24 offset:12816
    v_mfma_f32_16x16x32_bf16 v[60:63], a[232:235], a[92:95], v[60:63]
    buffer_load_dwordx4 v6, s[12:15], s57 offen lds
    v_mfma_f32_16x16x32_bf16 v[44:47], a[236:239], a[88:91], v[44:47]
    s_waitcnt lgkmcnt(10)
    ds_read_b64_tr_b16 a[232:233], v24 offset:10264
    ds_read_b64_tr_b16 a[234:235], v24 offset:12824
    v_mfma_f32_16x16x32_bf16 v[64:67], a[236:239], a[92:95], v[64:67]
    s_add_u32 m0, s41, 8192
    s_add_u32 s58, s39, s38
    buffer_load_dwordx4 v17, s[8:11], s58 offen lds
    s_add_u32 s39, s39, 128
    v_mfma_f32_16x16x32_bf16 v[48:51], a[240:243], a[88:91], v[48:51]
    s_waitcnt lgkmcnt(4)
    ds_read_b64_tr_b16 a[236:237], v24 offset:10272
    ds_read_b64_tr_b16 a[238:239], v24 offset:12832
    v_mfma_f32_16x16x32_bf16 v[68:71], a[240:243], a[92:95], v[68:71]
    v_mfma_f32_16x16x32_bf16 v[32:35], a[220:223], a[96:99], v[32:35]
    s_nop 0
    ds_read_b64_tr_b16 a[240:241], v24 offset:15360
    ds_read_b64_tr_b16 a[242:243], v24 offset:17920
    v_mfma_f32_16x16x32_bf16 v[52:55], a[220:223], a[100:103], v[52:55]
    buffer_load_dwordx4 v18, s[8:11], s58 offen offset:1024 lds
    s_cmp_eq_u32 s39, 1280
    s_cselect_b32 s39, 0, s39
    ds_read_b64_tr_b16 a[196:197], v31 offset:24
    v_mfma_f32_16x16x32_bf16 v[36:39], a[224:227], a[96:99], v[36:39]
    s_waitcnt lgkmcnt(7)
    ds_read_b64_tr_b16 a[220:221], v24 offset:15368
    ds_read_b64_tr_b16 a[222:223], v24 offset:17928
    v_mfma_f32_16x16x32_bf16 v[56:59], a[224:227], a[100:103], v[56:59]
    buffer_load_dwordx4 v19, s[8:11], s58 offen offset:2048 lds
    ds_read_b64_tr_b16 a[198:199], v31 offset:184
    v_mfma_f32_16x16x32_bf16 v[40:43], a[228:231], a[96:99], v[40:43]
    s_waitcnt lgkmcnt(8)
    ds_read_b64_tr_b16 a[224:225], v24 offset:15376
    ds_read_b64_tr_b16 a[226:227], v24 offset:17936
    v_mfma_f32_16x16x32_bf16 v[60:63], a[228:231], a[100:103], v[60:63]
    ds_read_b64_tr_b16 a[200:201], v31 offset:344
    v_mfma_f32_16x16x32_bf16 v[44:47], a[232:235], a[96:99], v[44:47]
    s_waitcnt lgkmcnt(9)
    ds_read_b64_tr_b16 a[228:229], v24 offset:15384
    ds_read_b64_tr_b16 a[230:231], v24 offset:17944
    v_mfma_f32_16x16x32_bf16 v[64:67], a[232:235], a[100:103], v[64:67]
    buffer_load_dwordx4 v20, s[8:11], s58 offen offset:3072 lds
    ds_read_b64_tr_b16 a[202:203], v31 offset:504
    v_mfma_f32_16x16x32_bf16 v[48:51], a[236:239], a[96:99], v[48:51]
    s_waitcnt lgkmcnt(10)
    ds_read_b64_tr_b16 a[232:233], v24 offset:15392
    ds_read_b64_tr_b16 a[234:235], v24 offset:17952
    v_mfma_f32_16x16x32_bf16 v[68:71], a[236:239], a[100:103], v[68:71]
    s_add_u32 m0, s41, 0
    s_add_u32 s58, s39, s38
    buffer_load_dwordx4 v17, s[8:11], s58 offen lds
    s_add_u32 s39, s39, 128
    v_mfma_f32_16x16x32_bf16 v[32:35], a[240:243], a[104:107], v[32:35]
    s_waitcnt lgkmcnt(9)
    ds_read_b64_tr_b16 a[236:237], v24 offset:20480
    ds_read_b64_tr_b16 a[238:239], v24 offset:23040
    v_mfma_f32_16x16x32_bf16 v[52:55], a[240:243], a[108:111], v[52:55]
    s_waitcnt vmcnt(10)
    ds_read_b128 a[112:115], v21 offset:4096
    ds_read_b128 a[116:119], v21 offset:6144
    v_mfma_f32_16x16x32_bf16 v[36:39], a[220:223], a[104:107], v[36:39]
    s_waitcnt lgkmcnt(10)
    ds_read_b64_tr_b16 a[240:241], v24 offset:20488
    ds_read_b64_tr_b16 a[242:243], v24 offset:23048
    v_mfma_f32_16x16x32_bf16 v[56:59], a[220:223], a[108:111], v[56:59]
    buffer_load_dwordx4 v18, s[8:11], s58 offen offset:1024 lds
    s_cmp_eq_u32 s39, 1280
    s_cselect_b32 s39, 0, s39
    ds_read_b128 a[120:123], v22 offset:4096
    ds_read_b128 a[124:127], v22 offset:6144
    v_mfma_f32_16x16x32_bf16 v[40:43], a[224:227], a[104:107], v[40:43]
    s_waitcnt lgkmcnt(11)
    ds_read_b64_tr_b16 a[220:221], v24 offset:20496
    ds_read_b64_tr_b16 a[222:223], v24 offset:23056
    v_mfma_f32_16x16x32_bf16 v[60:63], a[224:227], a[108:111], v[60:63]
    buffer_load_dwordx4 v19, s[8:11], s58 offen offset:2048 lds
    v_mfma_f32_16x16x32_bf16 v[44:47], a[228:231], a[104:107], v[44:47]
    s_waitcnt lgkmcnt(10)
    ds_read_b64_tr_b16 a[224:225], v24 offset:20504
    ds_read_b64_tr_b16 a[226:227], v24 offset:23064
    v_mfma_f32_16x16x32_bf16 v[64:67], a[228:231], a[108:111], v[64:67]
    v_mfma_f32_16x16x32_bf16 v[48:51], a[232:235], a[104:107], v[48:51]
    s_waitcnt lgkmcnt(4)
    ds_read_b64_tr_b16 a[228:229], v24 offset:20512
    ds_read_b64_tr_b16 a[230:231], v24 offset:23072
    v_mfma_f32_16x16x32_bf16 v[68:71], a[232:235], a[108:111], v[68:71]
    v_mfma_f32_16x16x32_bf16 v[32:35], a[236:239], a[112:115], v[32:35]
    s_nop 0
    ds_read_b64_tr_b16 a[232:233], v24 offset:25600
    ds_read_b64_tr_b16 a[234:235], v24 offset:28160
    v_mfma_f32_16x16x32_bf16 v[52:55], a[236:239], a[116:119], v[52:55]
    ds_read_b64_tr_b16 a[204:205], v31 offset:664
    v_mfma_f32_16x16x32_bf16 v[36:39], a[240:243], a[112:115], v[36:39]
    s_waitcnt lgkmcnt(7)
    ds_read_b64_tr_b16 a[236:237], v24 offset:25608
    ds_read_b64_tr_b16 a[238:239], v24 offset:28168
    v_mfma_f32_16x16x32_bf16 v[56:59], a[240:243], a[116:119], v[56:59]
    ds_read_b64_tr_b16 a[208:209], v31 offset:32
    v_mfma_f32_16x16x32_bf16 v[40:43], a[220:223], a[112:115], v[40:43]
    s_waitcnt lgkmcnt(8)
    ds_read_b64_tr_b16 a[240:241], v24 offset:25616
    ds_read_b64_tr_b16 a[242:243], v24 offset:28176
    v_mfma_f32_16x16x32_bf16 v[60:63], a[220:223], a[116:119], v[60:63]
    buffer_load_dwordx4 v20, s[8:11], s58 offen offset:3072 lds
    ds_read_b64_tr_b16 a[210:211], v31 offset:192
    v_mfma_f32_16x16x32_bf16 v[44:47], a[224:227], a[112:115], v[44:47]
    s_waitcnt lgkmcnt(9)
    ds_read_b64_tr_b16 a[220:221], v24 offset:25624
    ds_read_b64_tr_b16 a[222:223], v24 offset:28184
    v_mfma_f32_16x16x32_bf16 v[64:67], a[224:227], a[116:119], v[64:67]
    ds_read_b64_tr_b16 a[212:213], v31 offset:352
    v_mfma_f32_16x16x32_bf16 v[48:51], a[228:231], a[112:115], v[48:51]
    s_waitcnt lgkmcnt(10)
    ds_read_b64_tr_b16 a[224:225], v24 offset:25632
    ds_read_b64_tr_b16 a[226:227], v24 offset:28192
    v_mfma_f32_16x16x32_bf16 v[68:71], a[228:231], a[116:119], v[68:71]
L_hop1A:
    s_cbranch_execz L_hop5A
    v_mfma_f32_16x16x32_bf16 v[32:35], a[232:235], a[120:123], v[32:35]
    s_waitcnt lgkmcnt(9)
    s_waitcnt vmcnt(8)
    s_barrier
    ds_read_b64_tr_b16 a[228:229], v24 offset:30720
    ds_read_b64_tr_b16 a[230:231], v24 offset:33280
    v_mfma_f32_16x16x32_bf16 v[52:55], a[232:235], a[124:127], v[52:55]
    s_waitcnt vmcnt(4)
    ds_read_b128 a[128:131], v21 offset:8192
    ds_read_b128 a[132:135], v21 offset:10240
    v_mfma_f32_16x16x32_bf16 v[36:39], a[236:239], a[120:123], v[36:39]
    s_waitcnt lgkmcnt(10)
    ds_read_b64_tr_b16 a[232:233], v24 offset:30728
    ds_read_b64_tr_b16 a[234:235], v24 offset:33288
    v_mfma_f32_16x16x32_bf16 v[56:59], a[236:239], a[124:127], v[56:59]
    s_add_u32 m0, s40, 0
    s_add_u32 s57, s37, 2560
    buffer_load_dwordx4 v2, s[12:15], s57 offen lds
    ds_read_b128 a[136:139], v22 offset:8192
    ds_read_b128 a[140:143], v22 offset:10240
    v_mfma_f32_16x16x32_bf16 v[40:43], a[240:243], a[120:123], v[40:43]
    s_waitcnt lgkmcnt(11)
    ds_read_b64_tr_b16 a[236:237], v24 offset:30736
    ds_read_b64_tr_b16 a[238:239], v24 offset:33296
    v_mfma_f32_16x16x32_bf16 v[60:63], a[240:243], a[124:127], v[60:63]
    v_mfma_f32_16x16x32_bf16 v[44:47], a[220:223], a[120:123], v[44:47]
    s_waitcnt lgkmcnt(10)
    ds_read_b64_tr_b16 a[240:241], v24 offset:30744
    ds_read_b64_tr_b16 a[242:243], v24 offset:33304
    v_mfma_f32_16x16x32_bf16 v[64:67], a[220:223], a[124:127], v[64:67]
    v_mfma_f32_16x16x32_bf16 v[48:51], a[224:227], a[120:123], v[48:51]
    s_waitcnt lgkmcnt(4)
    ds_read_b64_tr_b16 a[220:221], v24 offset:30752
    ds_read_b64_tr_b16 a[222:223], v24 offset:33312
    v_mfma_f32_16x16x32_bf16 v[68:71], a[224:227], a[124:127], v[68:71]
    v_mfma_f32_16x16x32_bf16 v[32:35], a[228:231], a[128:131], v[32:35]
    s_nop 0
    ds_read_b64_tr_b16 a[224:225], v24 offset:35840
    ds_read_b64_tr_b16 a[226:227], v24 offset:38400
    v_mfma_f32_16x16x32_bf16 v[52:55], a[228:231], a[132:135], v[52:55]
    buffer_load_dwordx4 v3, s[12:15], s57 offen offset:1024 lds
    ds_read_b64_tr_b16 a[214:215], v31 offset:512
    v_mfma_f32_16x16x32_bf16 v[36:39], a[232:235], a[128:131], v[36:39]
    s_waitcnt lgkmcnt(7)
    ds_read_b64_tr_b16 a[228:229], v24 offset:35848
    ds_read_b64_tr_b16 a[230:231], v24 offset:38408
    v_mfma_f32_16x16x32_bf16 v[56:59], a[232:235], a[132:135], v[56:59]
    ds_read_b64_tr_b16 a[216:217], v31 offset:672
    v_mfma_f32_16x16x32_bf16 v[40:43], a[236:239], a[128:131], v[40:43]
    s_waitcnt lgkmcnt(8)
    ds_read_b64_tr_b16 a[232:233], v24 offset:35856
    ds_read_b64_tr_b16 a[234:235], v24 offset:38416
    v_mfma_f32_16x16x32_bf16 v[60:63], a[236:239], a[132:135], v[60:63]
    v_mov_b32 v150, 0
    v_mov_b32 v151, 0
    v_mfma_f32_16x16x32_bf16 v[44:47], a[240:243], a[128:131], v[44:47]
    s_waitcnt lgkmcnt(8)
    ds_read_b64_tr_b16 a[236:237], v24 offset:35864
    ds_read_b64_tr_b16 a[238:239], v24 offset:38424
    v_mfma_f32_16x16x32_bf16 v[64:67], a[240:243], a[132:135], v[64:67]
    v_mov_b32 v190, 0
    v_mov_b32 v191, 0
    v_mfma_f32_16x16x32_bf16 v[48:51], a[220:223], a[128:131], v[48:51]
    s_waitcnt lgkmcnt(8)
    ds_read_b64_tr_b16 a[240:241], v24 offset:35872
    ds_read_b64_tr_b16 a[242:243], v24 offset:38432
    v_mfma_f32_16x16x32_bf16 v[68:71], a[220:223], a[132:135], v[68:71]
    buffer_load_dwordx4 v4, s[12:15], s57 offen offset:2048 lds
    v_mfma_f32_16x16x32_bf16 v[32:35], a[224:227], a[136:139], v[32:35]
    s_waitcnt lgkmcnt(7)
    ds_read_b64_tr_b16 a[220:221], v24 offset:40960
    ds_read_b64_tr_b16 a[222:223], v24 offset:43520
    v_mfma_f32_16x16x32_bf16 v[52:55], a[224:227], a[140:143], v[52:55]
    s_waitcnt vmcnt(3)
    ds_read_b128 a[144:147], v21 offset:0
    ds_read_b128 a[148:151], v21 offset:2048
    v_mfma_f32_16x16x32_bf16 v[36:39], a[228:231], a[136:139], v[36:39]
    s_waitcnt lgkmcnt(8)
    ds_read_b64_tr_b16 a[224:225], v24 offset:40968
    ds_read_b64_tr_b16 a[226:227], v24 offset:43528
    v_mfma_f32_16x16x32_bf16 v[56:59], a[228:231], a[140:143], v[56:59]
    ds_read_b128 a[152:155], v22 offset:0
    ds_read_b128 a[156:159], v22 offset:2048
    v_mfma_f32_16x16x32_bf16 v[40:43], a[232:235], a[136:139], v[40:43]
    s_waitcnt lgkmcnt(10)
    ds_read_b64_tr_b16 a[228:229], v24 offset:40976
    ds_read_b64_tr_b16 a[230:231], v24 offset:43536
    v_mfma_f32_16x16x32_bf16 v[60:63], a[232:235], a[140:143], v[60:63]
    v_mfma_f32_16x16x32_bf16 v[44:47], a[236:239], a[136:139], v[44:47]
    s_waitcnt lgkmcnt(10)
    ds_read_b64_tr_b16 a[232:233], v24 offset:40984
    ds_read_b64_tr_b16 a[234:235], v24 offset:43544
    v_mfma_f32_16x16x32_bf16 v[64:67], a[236:239], a[140:143], v[64:67]
    buffer_load_dwordx4 v5, s[12:15], s57 offen offset:3072 lds
    s_add_u32 m0, s40, 4096
    v_mfma_f32_16x16x32_bf16 v[48:51], a[240:243], a[136:139], v[48:51]
    s_waitcnt lgkmcnt(4)
    ds_read_b64_tr_b16 a[236:237], v24 offset:40992
    ds_read_b64_tr_b16 a[238:239], v24 offset:43552
    v_mfma_f32_16x16x32_bf16 v[68:71], a[240:243], a[140:143], v[68:71]
    v_mfma_f32_16x16x32_bf16 v[32:35], a[220:223], a[144:147], v[32:35]
    s_nop 0
    ds_read_b64_tr_b16 a[240:241], v24 offset:46080
    ds_read_b64_tr_b16 a[242:243], v24 offset:48640
    v_mfma_f32_16x16x32_bf16 v[52:55], a[220:223], a[148:151], v[52:55]
    v_mfma_f32_16x16x32_bf16 v[36:39], a[224:227], a[144:147], v[36:39]
    s_waitcnt lgkmcnt(6)
    ds_read_b64_tr_b16 a[220:221], v24 offset:46088
    ds_read_b64_tr_b16 a[222:223], v24 offset:48648
    v_mfma_f32_16x16x32_bf16 v[56:59], a[224:227], a[148:151], v[56:59]
    v_mfma_f32_16x16x32_bf16 v[40:43], a[228:231], a[144:147], v[40:43]
    s_waitcnt lgkmcnt(6)
    ds_read_b64_tr_b16 a[224:225], v24 offset:46096
    ds_read_b64_tr_b16 a[226:227], v24 offset:48656
    v_mfma_f32_16x16x32_bf16 v[60:63], a[228:231], a[148:151], v[60:63]
    buffer_load_dwordx4 v6, s[12:15], s57 offen lds
    v_mfma_f32_16x16x32_bf16 v[44:47], a[232:235], a[144:147], v[44:47]
    s_waitcnt lgkmcnt(6)
    ds_read_b64_tr_b16 a[228:229], v24 offset:46104
    ds_read_b64_tr_b16 a[230:231], v24 offset:48664
    v_mfma_f32_16x16x32_bf16 v[64:67], a[232:235], a[148:151], v[64:67]
    v_mfma_f32_16x16x32_bf16 v[48:51], a[236:239], a[144:147], v[48:51]
    s_waitcnt lgkmcnt(6)
    ds_read_b64_tr_b16 a[232:233], v24 offset:46112
    ds_read_b64_tr_b16 a[234:235], v24 offset:48672
    v_mfma_f32_16x16x32_bf16 v[68:71], a[236:239], a[148:151], v[68:71]
    v_mfma_f32_16x16x32_bf16 v[32:35], a[240:243], a[152:155], v[32:35]
    s_waitcnt lgkmcnt(6)
    v_mfma_f32_16x16x32_bf16 v[52:55], a[240:243], a[156:159], v[52:55]
    v_mfma_f32_16x16x32_bf16 v[36:39], a[220:223], a[152:155], v[36:39]
    s_waitcnt lgkmcnt(4)
    v_mfma_f32_16x16x32_bf16 v[56:59], a[220:223], a[156:159], v[56:59]
    s_add_u32 m0, s40, 20480
    s_add_u32 s57, s36, 2560
    buffer_load_dwordx4 v2, s[12:15], s57 offen lds
    v_mfma_f32_16x16x32_bf16 v[40:43], a[224:227], a[152:155], v[40:43]
    s_waitcnt lgkmcnt(2)
    v_mfma_f32_16x16x32_bf16 v[60:63], a[224:227], a[156:159], v[60:63]
    v_cvt_pk_bf16_f32 v140, v32, v33
    v_cvt_pk_bf16_f32 v141, v34, v35
    v_mfma_f32_16x16x32_bf16 v[44:47], a[228:231], a[152:155], v[44:47]
    s_waitcnt lgkmcnt(0)
    v_cvt_pk_bf16_f32 v180, v52, v53
    v_cvt_pk_bf16_f32 v181, v54, v55
    v_mfma_f32_16x16x32_bf16 v[64:67], a[228:231], a[156:159], v[64:67]
    v_cvt_pk_bf16_f32 v142, v36, v37
    v_cvt_pk_bf16_f32 v143, v38, v39
    v_mfma_f32_16x16x32_bf16 v[48:51], a[232:235], a[152:155], v[48:51]
    v_cvt_pk_bf16_f32 v182, v56, v57
    v_cvt_pk_bf16_f32 v183, v58, v59
    v_mfma_f32_16x16x32_bf16 v[68:71], a[232:235], a[156:159], v[68:71]
    v_cvt_pk_bf16_f32 v144, v40, v41
    v_cvt_pk_bf16_f32 v145, v42, v43
    buffer_load_dwordx4 v3, s[12:15], s57 offen offset:1024 lds
    v_cvt_pk_bf16_f32 v146, v44, v45
    v_cvt_pk_bf16_f32 v147, v46, v47
    v_cvt_pk_bf16_f32 v148, v48, v49
    v_cvt_pk_bf16_f32 v149, v50, v51
    v_mfma_f32_16x16x32_bf16 v[32:35], a[160:163], v[140:143], 0
    buffer_load_dwordx4 v4, s[12:15], s57 offen offset:2048 lds
    v_mfma_f32_16x16x32_bf16 v[32:35], a[164:167], v[144:147], v[32:35]
    v_cvt_pk_bf16_f32 v184, v60, v61
    v_cvt_pk_bf16_f32 v185, v62, v63
    v_mfma_f32_16x16x32_bf16 v[32:35], a[168:171], v[148:151], v[32:35]
    v_cvt_pk_bf16_f32 v186, v64, v65
    v_cvt_pk_bf16_f32 v187, v66, v67
    v_mfma_f32_16x16x32_bf16 v[36:39], a[172:175], v[140:143], 0
    v_cvt_pk_bf16_f32 v188, v68, v69
    v_cvt_pk_bf16_f32 v189, v70, v71
    v_mfma_f32_16x16x32_bf16 v[36:39], a[176:179], v[144:147], v[36:39]
    v_mfma_f32_16x16x32_bf16 v[36:39], a[180:183], v[148:151], v[36:39]
    s_nop 0
    v_exp_f32 v112, v32
    v_mfma_f32_16x16x32_bf16 v[40:43], a[184:187], v[140:143], 0
    v_exp_f32 v113, v33
    v_mfma_f32_16x16x32_bf16 v[40:43], a[188:191], v[144:147], v[40:43]
    v_exp_f32 v114, v34
    v_mfma_f32_16x16x32_bf16 v[40:43], a[192:195], v[148:151], v[40:43]
    v_exp_f32 v115, v35
    v_mfma_f32_16x16x32_bf16 v[44:47], a[196:199], v[140:143], 0
    v_exp_f32 v116, v36
    v_mfma_f32_16x16x32_bf16 v[44:47], a[200:203], v[144:147], v[44:47]
    v_exp_f32 v117, v37
    v_mfma_f32_16x16x32_bf16 v[44:47], a[204:207], v[148:151], v[44:47]
    v_exp_f32 v118, v38
    v_mfma_f32_16x16x32_bf16 v[48:51], a[208:211], v[140:143], 0
    v_exp_f32 v119, v39
    v_mfma_f32_16x16x32_bf16 v[48:51], a[212:215], v[144:147], v[48:51]
    v_exp_f32 v120, v40
    v_mfma_f32_16x16x32_bf16 v[48:51], a[216:219], v[148:151], v[48:51]
    buffer_load_dwordx4 v5, s[12:15], s57 offen offset:3072 lds
    s_add_u32 m0, s40, 24576
    v_mfma_f32_16x16x32_bf16 v[52:55], a[160:163], v[180:183], 0
    v_exp_f32 v121, v41
    v_mfma_f32_16x16x32_bf16 v[52:55], a[164:167], v[184:187], v[52:55]
    v_exp_f32 v122, v42
    v_mfma_f32_16x16x32_bf16 v[52:55], a[168:171], v[188:191], v[52:55]
    v_exp_f32 v123, v43
    v_mfma_f32_16x16x32_bf16 v[56:59], a[172:175], v[180:183], 0
    v_exp_f32 v124, v44
    v_mfma_f32_16x16x32_bf16 v[56:59], a[176:179], v[184:187], v[56:59]
    v_exp_f32 v125, v45
    v_mfma_f32_16x16x32_bf16 v[56:59], a[180:183], v[188:191], v[56:59]
    v_exp_f32 v126, v46
    v_mfma_f32_16x16x32_bf16 v[60:63], a[184:187], v[180:183], 0
    v_exp_f32 v127, v47
    v_mfma_f32_16x16x32_bf16 v[60:63], a[188:191], v[184:187], v[60:63]
    buffer_load_dwordx4 v6, s[12:15], s57 offen lds
    v_mfma_f32_16x16x32_bf16 v[60:63], a[192:195], v[188:191], v[60:63]
    v_exp_f32 v128, v48
    v_mfma_f32_16x16x32_bf16 v[64:67], a[196:199], v[180:183], 0
    v_exp_f32 v129, v49
    v_mfma_f32_16x16x32_bf16 v[64:67], a[200:203], v[184:187], v[64:67]
    v_exp_f32 v130, v50
    v_mfma_f32_16x16x32_bf16 v[64:67], a[204:207], v[188:191], v[64:67]
    v_exp_f32 v131, v51
    v_mfma_f32_16x16x32_bf16 v[68:71], a[208:211], v[180:183], 0
    v_exp_f32 v152, v52
    v_mfma_f32_16x16x32_bf16 v[68:71], a[212:215], v[184:187], v[68:71]
    v_exp_f32 v153, v53
    v_mfma_f32_16x16x32_bf16 v[68:71], a[216:219], v[188:191], v[68:71]
    v_exp_f32 v154, v54
    v_pk_mul_f32 v[142:143], v[112:113], v[122:123]
    v_pk_mul_f32 v[144:145], v[114:115], v[124:125]
    v_pk_mul_f32 v[146:147], v[116:117], v[126:127]
    v_pk_mul_f32 v[148:149], v[118:119], v[128:129]
    v_pk_mul_f32 v[150:151], v[120:121], v[130:131]
    v_pk_add_f32 v[132:133], v[112:113], v[122:123]
    v_pk_add_f32 v[134:135], v[114:115], v[124:125]
    v_pk_add_f32 v[136:137], v[116:117], v[126:127]
    v_pk_add_f32 v[138:139], v[118:119], v[128:129]
    v_pk_add_f32 v[140:141], v[120:121], v[130:131]
    v_rcp_f32 v142, v142
    v_rcp_f32 v143, v143
    v_rcp_f32 v144, v144
    v_rcp_f32 v145, v145
    v_rcp_f32 v146, v146
    v_rcp_f32 v147, v147
    v_rcp_f32 v148, v148
    v_rcp_f32 v149, v149
    s_add_u32 m0, s40, 40960
    s_add_u32 s57, s35, 2560
    buffer_load_dwordx4 v2, s[12:15], s57 offen lds
    v_rcp_f32 v150, v150
    v_rcp_f32 v151, v151
    v_pk_add_f32 v[192:193], v[132:133], v[134:135]
    v_pk_mul_f32 v[194:195], v[132:133], v[142:143]
    v_pk_fma_f32 v[194:195], v[134:135], v[144:145], v[194:195]
    v_pk_add_f32 v[192:193], v[192:193], v[136:137]
    v_pk_fma_f32 v[194:195], v[136:137], v[146:147], v[194:195]
    v_pk_add_f32 v[192:193], v[192:193], v[138:139]
    v_pk_fma_f32 v[194:195], v[138:139], v[148:149], v[194:195]
    v_pk_add_f32 v[192:193], v[192:193], v[140:141]
    v_pk_fma_f32 v[194:195], v[140:141], v[150:151], v[194:195]
    v_add_f32 v192, v192, v193
    v_add_f32 v194, v194, v195
    v_add_f32 v193, v192, v194
    v_rcp_f32 v194, v194
    v_cmp_ngt_f32 vcc, 0x53800000, v193
    v_rcp_f32_e64 v196, v192
    v_pk_mul_f32 v[142:143], v[142:143], v[194:195] op_sel_hi:[1,0]
    v_pk_mul_f32 v[144:145], v[144:145], v[194:195] op_sel_hi:[1,0]
    v_pk_mul_f32 v[146:147], v[146:147], v[194:195] op_sel_hi:[1,0]
    v_pk_mul_f32 v[148:149], v[148:149], v[194:195] op_sel_hi:[1,0]
    v_pk_mul_f32 v[150:151], v[150:151], v[194:195] op_sel_hi:[1,0]
    v_pk_mul_f32 v[132:133], v[142:143], v[122:123]
    v_pk_mul_f32 v[134:135], v[144:145], v[124:125]
    buffer_load_dwordx4 v3, s[12:15], s57 offen offset:1024 lds
    v_pk_mul_f32 v[136:137], v[146:147], v[126:127]
    v_pk_mul_f32 v[138:139], v[148:149], v[128:129]
    v_pk_mul_f32 v[140:141], v[150:151], v[130:131]
    v_pk_mul_f32 v[142:143], v[142:143], v[112:113]
    v_pk_mul_f32 v[144:145], v[144:145], v[114:115]
    v_pk_mul_f32 v[146:147], v[146:147], v[116:117]
    v_pk_mul_f32 v[148:149], v[148:149], v[118:119]
    v_pk_mul_f32 v[150:151], v[150:151], v[120:121]
    s_cbranch_vccnz L_k0A_slow
L_k0A_back:
    s_waitcnt vmcnt(7)
    s_barrier
    ds_read_b64_tr_b16 a[236:237], v23 offset:0
    ds_read_b64_tr_b16 a[238:239], v23 offset:2560
    ds_read_b64_tr_b16 a[240:241], v23 offset:8
    ds_read_b64_tr_b16 a[242:243], v23 offset:2568
    ds_read_b64_tr_b16 a[220:221], v23 offset:16
    ds_read_b64_tr_b16 a[222:223], v23 offset:2576
    ds_read_b64_tr_b16 a[224:225], v23 offset:24
    ds_read_b64_tr_b16 a[226:227], v23 offset:2584
    ds_read_b64_tr_b16 a[228:229], v23 offset:32
    ds_read_b64_tr_b16 a[230:231], v23 offset:2592
    s_nop 0
    v_pk_mul_f32 v[112:113], v[112:113], v[196:197] op_sel_hi:[1,0]
    v_pk_mul_f32 v[114:115], v[114:115], v[196:197] op_sel_hi:[1,0]
    v_pk_mul_f32 v[116:117], v[116:117], v[196:197] op_sel_hi:[1,0]
    v_pk_mul_f32 v[118:119], v[118:119], v[196:197] op_sel_hi:[1,0]
    v_pk_mul_f32 v[120:121], v[120:121], v[196:197] op_sel_hi:[1,0]
    v_pk_mul_f32 v[122:123], v[122:123], v[196:197] op_sel_hi:[1,0]
    v_pk_mul_f32 v[124:125], v[124:125], v[196:197] op_sel_hi:[1,0]
    v_pk_mul_f32 v[126:127], v[126:127], v[196:197] op_sel_hi:[1,0]
    v_pk_mul_f32 v[128:129], v[128:129], v[196:197] op_sel_hi:[1,0]
    v_pk_mul_f32 v[130:131], v[130:131], v[196:197] op_sel_hi:[1,0]
    s_waitcnt lgkmcnt(8)
    v_mfma_f32_16x16x32_bf16 v[72:75], a[236:239], a[128:131], 0
    s_waitcnt lgkmcnt(6)
    ds_read_b64_tr_b16 a[232:233], v23 offset:5120
    ds_read_b64_tr_b16 a[234:235], v23 offset:7680
    v_mfma_f32_16x16x32_bf16 v[92:95], a[236:239], a[132:135], 0
    buffer_load_dwordx4 v4, s[12:15], s57 offen offset:2048 lds
    v_mfma_f32_16x16x32_bf16 v[76:79], a[240:243], a[128:131], 0
    s_waitcnt lgkmcnt(6)
    ds_read_b64_tr_b16 a[236:237], v23 offset:5128
    ds_read_b64_tr_b16 a[238:239], v23 offset:7688
    v_mfma_f32_16x16x32_bf16 v[96:99], a[240:243], a[132:135], 0
    v_cvt_pk_bf16_f32 v32, v112, v113
    v_cvt_pk_bf16_f32 v33, v114, v115
    v_mfma_f32_16x16x32_bf16 v[80:83], a[220:223], a[128:131], 0
    s_waitcnt lgkmcnt(6)
    ds_read_b64_tr_b16 a[240:241], v23 offset:5136
    ds_read_b64_tr_b16 a[242:243], v23 offset:7696
    v_mfma_f32_16x16x32_bf16 v[100:103], a[220:223], a[132:135], 0
    ds_write_b64 v26, v[32:33] offset:0
    v_mfma_f32_16x16x32_bf16 v[84:87], a[224:227], a[128:131], 0
    s_waitcnt lgkmcnt(7)
    ds_read_b64_tr_b16 a[220:221], v23 offset:5144
    ds_read_b64_tr_b16 a[222:223], v23 offset:7704
    v_mfma_f32_16x16x32_bf16 v[104:107], a[224:227], a[132:135], 0
    buffer_load_dwordx4 v5, s[12:15], s57 offen offset:3072 lds
    s_add_u32 m0, s40, 45056
    v_mfma_f32_16x16x32_bf16 v[88:91], a[228:231], a[128:131], 0
    s_waitcnt lgkmcnt(7)
    ds_read_b64_tr_b16 a[224:225], v23 offset:5152
    ds_read_b64_tr_b16 a[226:227], v23 offset:7712
    v_mfma_f32_16x16x32_bf16 v[108:111], a[228:231], a[132:135], 0
    v_cvt_pk_bf16_f32 v34, v116, v117
    v_cvt_pk_bf16_f32 v35, v118, v119
    v_mfma_f32_16x16x32_bf16 v[72:75], a[232:235], a[136:139], v[72:75]
    s_waitcnt lgkmcnt(7)
    ds_read_b64_tr_b16 a[228:229], v23 offset:10240
    ds_read_b64_tr_b16 a[230:231], v23 offset:12800
    v_mfma_f32_16x16x32_bf16 v[92:95], a[232:235], a[140:143], v[92:95]
    ds_write_b64 v26, v[34:35] offset:8
    v_mfma_f32_16x16x32_bf16 v[76:79], a[236:239], a[136:139], v[76:79]
    s_waitcnt lgkmcnt(8)
    ds_read_b64_tr_b16 a[232:233], v23 offset:10248
    ds_read_b64_tr_b16 a[234:235], v23 offset:12808
    v_mfma_f32_16x16x32_bf16 v[96:99], a[236:239], a[140:143], v[96:99]
    buffer_load_dwordx4 v6, s[12:15], s57 offen lds
    v_mfma_f32_16x16x32_bf16 v[80:83], a[240:243], a[136:139], v[80:83]
    s_waitcnt lgkmcnt(7)
    ds_read_b64_tr_b16 a[236:237], v23 offset:10256
    ds_read_b64_tr_b16 a[238:239], v23 offset:12816
    v_mfma_f32_16x16x32_bf16 v[100:103], a[240:243], a[140:143], v[100:103]
    v_cvt_pk_bf16_f32 v36, v120, v121
    v_cvt_pk_bf16_f32 v37, v122, v123
    v_mfma_f32_16x16x32_bf16 v[84:87], a[220:223], a[136:139], v[84:87]
    s_waitcnt lgkmcnt(7)
    ds_read_b64_tr_b16 a[240:241], v23 offset:10264
    ds_read_b64_tr_b16 a[242:243], v23 offset:12824
    v_mfma_f32_16x16x32_bf16 v[104:107], a[220:223], a[140:143], v[104:107]
    ds_write_b64 v26, v[36:37] offset:16
    v_mfma_f32_16x16x32_bf16 v[88:91], a[224:227], a[136:139], v[88:91]
    s_waitcnt lgkmcnt(8)
    ds_read_b64_tr_b16 a[220:221], v23 offset:10272
    ds_read_b64_tr_b16 a[222:223], v23 offset:12832
    v_mfma_f32_16x16x32_bf16 v[108:111], a[224:227], a[140:143], v[108:111]
    s_add_u32 m0, s40, 61440
    s_add_u32 s57, s34, 2560
    buffer_load_dwordx4 v2, s[12:15], s57 offen lds
    v_mfma_f32_16x16x32_bf16 v[72:75], a[228:231], a[144:147], v[72:75]
    s_waitcnt lgkmcnt(7)
    ds_read_b64_tr_b16 a[224:225], v23 offset:15360
    ds_read_b64_tr_b16 a[226:227], v23 offset:17920
    v_mfma_f32_16x16x32_bf16 v[92:95], a[228:231], a[148:151], v[92:95]
    v_cvt_pk_bf16_f32 v38, v124, v125
    v_cvt_pk_bf16_f32 v39, v126, v127
    v_mfma_f32_16x16x32_bf16 v[76:79], a[232:235], a[144:147], v[76:79]
    s_waitcnt lgkmcnt(7)
    ds_read_b64_tr_b16 a[228:229], v23 offset:15368
    ds_read_b64_tr_b16 a[230:231], v23 offset:17928
    v_mfma_f32_16x16x32_bf16 v[96:99], a[232:235], a[148:151], v[96:99]
    ds_write_b64 v26, v[38:39] offset:24
    v_mfma_f32_16x16x32_bf16 v[80:83], a[236:239], a[144:147], v[80:83]
    s_waitcnt lgkmcnt(8)
    ds_read_b64_tr_b16 a[232:233], v23 offset:15376
    ds_read_b64_tr_b16 a[234:235], v23 offset:17936
    v_mfma_f32_16x16x32_bf16 v[100:103], a[236:239], a[148:151], v[100:103]
    buffer_load_dwordx4 v3, s[12:15], s57 offen offset:1024 lds
    v_mfma_f32_16x16x32_bf16 v[84:87], a[240:243], a[144:147], v[84:87]
    s_waitcnt lgkmcnt(7)
    ds_read_b64_tr_b16 a[236:237], v23 offset:15384
    ds_read_b64_tr_b16 a[238:239], v23 offset:17944
    v_mfma_f32_16x16x32_bf16 v[104:107], a[240:243], a[148:151], v[104:107]
    v_cvt_pk_bf16_f32 v40, v128, v129
    v_cvt_pk_bf16_f32 v41, v130, v131
    v_mfma_f32_16x16x32_bf16 v[88:91], a[220:223], a[144:147], v[88:91]
    s_waitcnt lgkmcnt(7)
    ds_read_b64_tr_b16 a[240:241], v23 offset:15392
    ds_read_b64_tr_b16 a[242:243], v23 offset:17952
    v_mfma_f32_16x16x32_bf16 v[108:111], a[220:223], a[148:151], v[108:111]
    ds_write_b64 v26, v[40:41] offset:32
    v_mfma_f32_16x16x32_bf16 v[72:75], a[224:227], a[152:155], v[72:75]
    s_waitcnt lgkmcnt(8)
    s_waitcnt vmcnt(7)
    s_barrier
    ds_read_b64_tr_b16 a[220:221], v23 offset:20480
    ds_read_b64_tr_b16 a[222:223], v23 offset:23040
    v_mfma_f32_16x16x32_bf16 v[92:95], a[224:227], a[156:159], v[92:95]
    buffer_load_dwordx4 v4, s[12:15], s57 offen offset:2048 lds
    v_mfma_f32_16x16x32_bf16 v[76:79], a[228:231], a[152:155], v[76:79]
    s_waitcnt lgkmcnt(7)
    ds_read_b64_tr_b16 a[224:225], v23 offset:20488
    ds_read_b64_tr_b16 a[226:227], v23 offset:23048
    v_mfma_f32_16x16x32_bf16 v[96:99], a[228:231], a[156:159], v[96:99]
    v_cvt_pk_bf16_f32 v42, v132, v133
    v_cvt_pk_bf16_f32 v43, v134, v135
    v_mfma_f32_16x16x32_bf16 v[80:83], a[232:235], a[152:155], v[80:83]
    s_waitcnt lgkmcnt(7)
    ds_read_b64_tr_b16 a[228:229], v23 offset:20496
    ds_read_b64_tr_b16 a[230:231], v23 offset:23056
    v_mfma_f32_16x16x32_bf16 v[100:103], a[232:235], a[156:159], v[100:103]
    buffer_store_dword v29, v255, s[20:23], s93 offen sc1
    ds_write_b64 v26, v[42:43] offset:40
    v_mfma_f32_16x16x32_bf16 v[84:87], a[236:239], a[152:155], v[84:87]
    s_waitcnt lgkmcnt(8)
    ds_read_b64_tr_b16 a[232:233], v23 offset:20504
    ds_read_b64_tr_b16 a[234:235], v23 offset:23064
    v_mfma_f32_16x16x32_bf16 v[104:107], a[236:239], a[156:159], v[104:107]
    buffer_load_dwordx4 v5, s[12:15], s57 offen offset:3072 lds
    s_add_u32 m0, s40, 65536
    v_mfma_f32_16x16x32_bf16 v[88:91], a[240:243], a[152:155], v[88:91]
    s_waitcnt lgkmcnt(7)
    ds_read_b64_tr_b16 a[236:237], v23 offset:20512
    ds_read_b64_tr_b16 a[238:239], v23 offset:23072
    v_mfma_f32_16x16x32_bf16 v[108:111], a[240:243], a[156:159], v[108:111]
    v_cvt_pk_bf16_f32 v44, v136, v137
    v_cvt_pk_bf16_f32 v45, v138, v139
    v_mfma_f32_16x16x32_bf16 v[72:75], a[220:223], a[96:99], v[72:75]
    s_waitcnt lgkmcnt(7)
    ds_read_b64_tr_b16 a[240:241], v23 offset:25600
    ds_read_b64_tr_b16 a[242:243], v23 offset:28160
    v_mfma_f32_16x16x32_bf16 v[92:95], a[220:223], a[100:103], v[92:95]
    ds_write_b64 v26, v[44:45] offset:48
    v_mfma_f32_16x16x32_bf16 v[76:79], a[224:227], a[96:99], v[76:79]
    s_waitcnt lgkmcnt(8)
    ds_read_b64_tr_b16 a[220:221], v23 offset:25608
    ds_read_b64_tr_b16 a[222:223], v23 offset:28168
    v_mfma_f32_16x16x32_bf16 v[96:99], a[224:227], a[100:103], v[96:99]
    buffer_load_dwordx4 v6, s[12:15], s57 offen lds
    v_mfma_f32_16x16x32_bf16 v[80:83], a[228:231], a[96:99], v[80:83]
    s_waitcnt lgkmcnt(7)
    ds_read_b64_tr_b16 a[224:225], v23 offset:25616
    ds_read_b64_tr_b16 a[226:227], v23 offset:28176
    v_mfma_f32_16x16x32_bf16 v[100:103], a[228:231], a[100:103], v[100:103]
    v_cvt_pk_bf16_f32 v46, v140, v141
    v_cvt_pk_bf16_f32 v47, v142, v143
    v_mfma_f32_16x16x32_bf16 v[84:87], a[232:235], a[96:99], v[84:87]
    s_waitcnt lgkmcnt(7)
    ds_read_b64_tr_b16 a[228:229], v23 offset:25624
    ds_read_b64_tr_b16 a[230:231], v23 offset:28184
    v_mfma_f32_16x16x32_bf16 v[104:107], a[232:235], a[100:103], v[104:107]
    ds_write_b64 v26, v[46:47] offset:56
    v_mfma_f32_16x16x32_bf16 v[88:91], a[236:239], a[96:99], v[88:91]
    s_waitcnt lgkmcnt(8)
    ds_read_b64_tr_b16 a[232:233], v23 offset:25632
    ds_read_b64_tr_b16 a[234:235], v23 offset:28192
    v_mfma_f32_16x16x32_bf16 v[108:111], a[236:239], a[100:103], v[108:111]
    s_add_u32 m0, s40, 81920
    s_add_u32 s57, s33, 2560
    buffer_load_dwordx4 v2, s[12:15], s57 offen lds
    v_mfma_f32_16x16x32_bf16 v[72:75], a[240:243], a[104:107], v[72:75]
    s_waitcnt lgkmcnt(7)
    ds_read_b64_tr_b16 a[236:237], v23 offset:30720
    ds_read_b64_tr_b16 a[238:239], v23 offset:33280
    v_mfma_f32_16x16x32_bf16 v[92:95], a[240:243], a[108:111], v[92:95]
    v_cvt_pk_bf16_f32 v48, v144, v145
    v_cvt_pk_bf16_f32 v49, v146, v147
    v_mfma_f32_16x16x32_bf16 v[76:79], a[220:223], a[104:107], v[76:79]
    s_waitcnt lgkmcnt(7)
    ds_read_b64_tr_b16 a[240:241], v23 offset:30728
    ds_read_b64_tr_b16 a[242:243], v23 offset:33288
    v_mfma_f32_16x16x32_bf16 v[96:99], a[220:223], a[108:111], v[96:99]
    ds_write_b64 v26, v[48:49] offset:64
    v_mfma_f32_16x16x32_bf16 v[80:83], a[224:227], a[104:107], v[80:83]
    s_waitcnt lgkmcnt(8)
    ds_read_b64_tr_b16 a[220:221], v23 offset:30736
    ds_read_b64_tr_b16 a[222:223], v23 offset:33296
    v_mfma_f32_16x16x32_bf16 v[100:103], a[224:227], a[108:111], v[100:103]
    v_cvt_pk_bf16_f32 v50, v148, v149
    v_cvt_pk_bf16_f32 v51, v150, v151
    v_mfma_f32_16x16x32_bf16 v[84:87], a[228:231], a[104:107], v[84:87]
    s_waitcnt lgkmcnt(7)
    ds_read_b64_tr_b16 a[224:225], v23 offset:30744
    ds_read_b64_tr_b16 a[226:227], v23 offset:33304
    v_mfma_f32_16x16x32_bf16 v[104:107], a[228:231], a[108:111], v[104:107]
    buffer_load_dwordx4 v3, s[12:15], s57 offen offset:1024 lds
    v_mfma_f32_16x16x32_bf16 v[88:91], a[232:235], a[104:107], v[88:91]
    s_waitcnt lgkmcnt(7)
    ds_read_b64_tr_b16 a[228:229], v23 offset:30752
    ds_read_b64_tr_b16 a[230:231], v23 offset:33312
    v_mfma_f32_16x16x32_bf16 v[108:111], a[232:235], a[108:111], v[108:111]
    ds_write_b64 v26, v[50:51] offset:72
    v_mfma_f32_16x16x32_bf16 v[72:75], a[236:239], a[112:115], v[72:75]
    s_waitcnt lgkmcnt(8)
    ds_read_b64_tr_b16 a[232:233], v23 offset:35840
    ds_read_b64_tr_b16 a[234:235], v23 offset:38400
    v_mfma_f32_16x16x32_bf16 v[92:95], a[236:239], a[116:119], v[92:95]
    v_exp_f32 v155, v55
    v_mfma_f32_16x16x32_bf16 v[76:79], a[240:243], a[112:115], v[76:79]
    s_waitcnt lgkmcnt(7)
    ds_read_b64_tr_b16 a[236:237], v23 offset:35848
    ds_read_b64_tr_b16 a[238:239], v23 offset:38408
    v_mfma_f32_16x16x32_bf16 v[96:99], a[240:243], a[116:119], v[96:99]
    v_exp_f32 v156, v56
    v_mfma_f32_16x16x32_bf16 v[80:83], a[220:223], a[112:115], v[80:83]
    s_waitcnt lgkmcnt(7)
    ds_read_b64_tr_b16 a[240:241], v23 offset:35856
    ds_read_b64_tr_b16 a[242:243], v23 offset:38416
    v_mfma_f32_16x16x32_bf16 v[100:103], a[220:223], a[116:119], v[100:103]
    buffer_load_dwordx4 v4, s[12:15], s57 offen offset:2048 lds
    v_mfma_f32_16x16x32_bf16 v[84:87], a[224:227], a[112:115], v[84:87]
    s_waitcnt lgkmcnt(7)
    ds_read_b64_tr_b16 a[220:221], v23 offset:35864
    ds_read_b64_tr_b16 a[222:223], v23 offset:38424
    v_mfma_f32_16x16x32_bf16 v[104:107], a[224:227], a[116:119], v[104:107]
    v_exp_f32 v157, v57
    v_mfma_f32_16x16x32_bf16 v[88:91], a[228:231], a[112:115], v[88:91]
    s_waitcnt lgkmcnt(6)
    ds_read_b64_tr_b16 a[224:225], v23 offset:35872
    ds_read_b64_tr_b16 a[226:227], v23 offset:38432
    v_mfma_f32_16x16x32_bf16 v[108:111], a[228:231], a[116:119], v[108:111]
    v_exp_f32 v158, v58
    v_mfma_f32_16x16x32_bf16 v[72:75], a[232:235], a[120:123], v[72:75]
    s_waitcnt lgkmcnt(6)
    s_waitcnt vmcnt(9)
    s_barrier
    ds_read_b64_tr_b16 a[228:229], v23 offset:40960
    ds_read_b64_tr_b16 a[230:231], v23 offset:43520
    v_mfma_f32_16x16x32_bf16 v[92:95], a[232:235], a[124:127], v[92:95]
    v_exp_f32 v159, v59
    v_mfma_f32_16x16x32_bf16 v[76:79], a[236:239], a[120:123], v[76:79]
    s_waitcnt lgkmcnt(6)
    ds_read_b64_tr_b16 a[232:233], v23 offset:40968
    ds_read_b64_tr_b16 a[234:235], v23 offset:43528
    v_mfma_f32_16x16x32_bf16 v[96:99], a[236:239], a[124:127], v[96:99]
    buffer_load_dwordx4 v5, s[12:15], s57 offen offset:3072 lds
    s_add_u32 m0, s40, 86016
    v_mfma_f32_16x16x32_bf16 v[80:83], a[240:243], a[120:123], v[80:83]
    s_waitcnt lgkmcnt(6)
    ds_read_b64_tr_b16 a[236:237], v23 offset:40976
    ds_read_b64_tr_b16 a[238:239], v23 offset:43536
    v_mfma_f32_16x16x32_bf16 v[100:103], a[240:243], a[124:127], v[100:103]
    v_exp_f32 v160, v60
    v_mfma_f32_16x16x32_bf16 v[84:87], a[220:223], a[120:123], v[84:87]
    s_waitcnt lgkmcnt(6)
    ds_read_b64_tr_b16 a[240:241], v23 offset:40984
    ds_read_b64_tr_b16 a[242:243], v23 offset:43544
    v_mfma_f32_16x16x32_bf16 v[104:107], a[220:223], a[124:127], v[104:107]
    v_exp_f32 v161, v61
    v_mfma_f32_16x16x32_bf16 v[88:91], a[224:227], a[120:123], v[88:91]
    s_waitcnt lgkmcnt(6)
    ds_read_b64_tr_b16 a[220:221], v23 offset:40992
    ds_read_b64_tr_b16 a[222:223], v23 offset:43552
    v_mfma_f32_16x16x32_bf16 v[108:111], a[224:227], a[124:127], v[108:111]
    v_exp_f32 v162, v62
    v_mfma_f32_16x16x32_bf16 v[72:75], a[228:231], a[64:67], v[72:75]
    s_waitcnt lgkmcnt(6)
    ds_read_b64_tr_b16 a[224:225], v23 offset:46080
    ds_read_b64_tr_b16 a[226:227], v23 offset:48640
    v_mfma_f32_16x16x32_bf16 v[92:95], a[228:231], a[68:71], v[92:95]
    buffer_load_dwordx4 v6, s[12:15], s57 offen lds
    v_mfma_f32_16x16x32_bf16 v[76:79], a[232:235], a[64:67], v[76:79]
    s_waitcnt lgkmcnt(6)
    ds_read_b64_tr_b16 a[228:229], v23 offset:46088
    ds_read_b64_tr_b16 a[230:231], v23 offset:48648
    v_mfma_f32_16x16x32_bf16 v[96:99], a[232:235], a[68:71], v[96:99]
    s_bfe_u32 s8, s32, 0x80000
    v_exp_f32 v163, v63
    v_mfma_f32_16x16x32_bf16 v[80:83], a[236:239], a[64:67], v[80:83]
L_hop2A:
    s_cbranch_execz L_hopretA
    s_waitcnt lgkmcnt(6)
    ds_read_b64_tr_b16 a[232:233], v23 offset:46096
    ds_read_b64_tr_b16 a[234:235], v23 offset:48656
    v_mfma_f32_16x16x32_bf16 v[100:103], a[236:239], a[68:71], v[100:103]
    s_bfe_u32 s9, s32, 0x80008
    v_exp_f32 v164, v64
    v_mfma_f32_16x16x32_bf16 v[84:87], a[240:243], a[64:67], v[84:87]
    s_waitcnt lgkmcnt(6)
    ds_read_b64_tr_b16 a[236:237], v23 offset:46104
    ds_read_b64_tr_b16 a[238:239], v23 offset:48664
    v_mfma_f32_16x16x32_bf16 v[104:107], a[240:243], a[68:71], v[104:107]
    s_bfe_u32 s10, s32, 0x80010
    v_exp_f32 v165, v65
    v_mfma_f32_16x16x32_bf16 v[88:91], a[220:223], a[64:67], v[88:91]
    s_waitcnt lgkmcnt(6)
    ds_read_b64_tr_b16 a[240:241], v23 offset:46112
    ds_read_b64_tr_b16 a[242:243], v23 offset:48672
    v_mfma_f32_16x16x32_bf16 v[108:111], a[220:223], a[68:71], v[108:111]
    s_add_u32 m0, s40, 0
    s_add_u32 s57, s37, 0
    buffer_load_dwordx4 v2, s[12:15], s57 offen lds
    s_bfe_u32 s11, s32, 0x80018
    v_mfma_f32_16x16x32_bf16 v[72:75], a[224:227], a[72:75], v[72:75]
    s_waitcnt lgkmcnt(6)
    ds_read_b64_tr_b16 a[220:221], v24 offset:0
    ds_read_b64_tr_b16 a[222:223], v24 offset:2560
    v_mfma_f32_16x16x32_bf16 v[92:95], a[224:227], a[76:79], v[92:95]
    s_lshr_b32 s38, s32, 16
    v_exp_f32 v166, v66
    v_mfma_f32_16x16x32_bf16 v[76:79], a[228:231], a[72:75], v[76:79]
    s_waitcnt lgkmcnt(6)
    ds_read_b64_tr_b16 a[224:225], v24 offset:8
    ds_read_b64_tr_b16 a[226:227], v24 offset:2568
    v_mfma_f32_16x16x32_bf16 v[96:99], a[228:231], a[76:79], v[96:99]
    v_exp_f32 v167, v67
    v_mfma_f32_16x16x32_bf16 v[80:83], a[232:235], a[72:75], v[80:83]
    s_waitcnt lgkmcnt(6)
    ds_read_b64_tr_b16 a[228:229], v24 offset:16
    ds_read_b64_tr_b16 a[230:231], v24 offset:2576
    v_mfma_f32_16x16x32_bf16 v[100:103], a[232:235], a[76:79], v[100:103]
    v_exp_f32 v168, v68
    v_mfma_f32_16x16x32_bf16 v[84:87], a[236:239], a[72:75], v[84:87]
    s_waitcnt lgkmcnt(6)
    ds_read_b64_tr_b16 a[232:233], v24 offset:24
    ds_read_b64_tr_b16 a[234:235], v24 offset:2584
    v_mfma_f32_16x16x32_bf16 v[104:107], a[236:239], a[76:79], v[104:107]
    buffer_load_dwordx4 v3, s[12:15], s57 offen offset:1024 lds
    v_mfma_f32_16x16x32_bf16 v[88:91], a[240:243], a[72:75], v[88:91]
    s_waitcnt lgkmcnt(6)
    ds_read_b64_tr_b16 a[236:237], v24 offset:32
    ds_read_b64_tr_b16 a[238:239], v24 offset:2592
    v_mfma_f32_16x16x32_bf16 v[108:111], a[240:243], a[76:79], v[108:111]
    v_exp_f32 v169, v69
    v_mfma_f32_16x16x32_bf16 v[72:75], a[220:223], a[80:83], v[72:75]
    s_waitcnt lgkmcnt(6)
    ds_read_b64_tr_b16 a[240:241], v24 offset:5120
    ds_read_b64_tr_b16 a[242:243], v24 offset:7680
    v_mfma_f32_16x16x32_bf16 v[92:95], a[220:223], a[84:87], v[92:95]
    v_exp_f32 v170, v70
    v_mfma_f32_16x16x32_bf16 v[76:79], a[224:227], a[80:83], v[76:79]
    s_waitcnt lgkmcnt(6)
    ds_read_b64_tr_b16 a[220:221], v24 offset:5128
    ds_read_b64_tr_b16 a[222:223], v24 offset:7688
    v_mfma_f32_16x16x32_bf16 v[96:99], a[224:227], a[84:87], v[96:99]
    v_exp_f32 v171, v71
    v_pk_mul_f32 v[182:183], v[152:153], v[162:163]
    v_pk_mul_f32 v[184:185], v[154:155], v[164:165]
    v_pk_mul_f32 v[186:187], v[156:157], v[166:167]
    v_pk_mul_f32 v[188:189], v[158:159], v[168:169]
    v_pk_mul_f32 v[190:191], v[160:161], v[170:171]
    v_pk_add_f32 v[172:173], v[152:153], v[162:163]
    v_pk_add_f32 v[174:175], v[154:155], v[164:165]
    v_pk_add_f32 v[176:177], v[156:157], v[166:167]
    v_pk_add_f32 v[178:179], v[158:159], v[168:169]
    v_pk_add_f32 v[180:181], v[160:161], v[170:171]
    v_mfma_f32_16x16x32_bf16 v[80:83], a[228:231], a[80:83], v[80:83]
    s_waitcnt lgkmcnt(6)
    ds_read_b64_tr_b16 a[224:225], v24 offset:5136
    ds_read_b64_tr_b16 a[226:227], v24 offset:7696
    v_mfma_f32_16x16x32_bf16 v[100:103], a[228:231], a[84:87], v[100:103]
    buffer_load_dwordx4 v4, s[12:15], s57 offen offset:2048 lds
    v_mfma_f32_16x16x32_bf16 v[84:87], a[232:235], a[80:83], v[84:87]
    s_waitcnt lgkmcnt(6)
    ds_read_b64_tr_b16 a[228:229], v24 offset:5144
    ds_read_b64_tr_b16 a[230:231], v24 offset:7704
    v_mfma_f32_16x16x32_bf16 v[104:107], a[232:235], a[84:87], v[104:107]
    v_rcp_f32 v182, v182
    v_mfma_f32_16x16x32_bf16 v[88:91], a[236:239], a[80:83], v[88:91]
    s_waitcnt lgkmcnt(6)
    ds_read_b64_tr_b16 a[232:233], v24 offset:5152
    ds_read_b64_tr_b16 a[234:235], v24 offset:7712
    v_mfma_f32_16x16x32_bf16 v[108:111], a[236:239], a[84:87], v[108:111]
    v_rcp_f32 v183, v183
    v_mfma_f32_16x16x32_bf16 v[72:75], a[240:243], a[88:91], v[72:75]
    s_waitcnt lgkmcnt(6)
    s_waitcnt vmcnt(8)
    s_barrier
    ds_read_b64_tr_b16 a[236:237], v24 offset:10240
    ds_read_b64_tr_b16 a[238:239], v24 offset:12800
    v_mfma_f32_16x16x32_bf16 v[92:95], a[240:243], a[92:95], v[92:95]
    v_rcp_f32 v184, v184
    v_mfma_f32_16x16x32_bf16 v[76:79], a[220:223], a[88:91], v[76:79]
    s_waitcnt lgkmcnt(6)
    ds_read_b64_tr_b16 a[240:241], v24 offset:10248
    ds_read_b64_tr_b16 a[242:243], v24 offset:12808
    v_mfma_f32_16x16x32_bf16 v[96:99], a[220:223], a[92:95], v[96:99]
    buffer_load_dwordx4 v5, s[12:15], s57 offen offset:3072 lds
    s_add_u32 m0, s40, 4096
    v_mfma_f32_16x16x32_bf16 v[80:83], a[224:227], a[88:91], v[80:83]
    s_waitcnt lgkmcnt(6)
    ds_read_b64_tr_b16 a[220:221], v24 offset:10256
    ds_read_b64_tr_b16 a[222:223], v24 offset:12816
    v_mfma_f32_16x16x32_bf16 v[100:103], a[224:227], a[92:95], v[100:103]
    v_rcp_f32 v185, v185
    v_mfma_f32_16x16x32_bf16 v[84:87], a[228:231], a[88:91], v[84:87]
    s_waitcnt lgkmcnt(6)
    ds_read_b64_tr_b16 a[224:225], v24 offset:10264
    ds_read_b64_tr_b16 a[226:227], v24 offset:12824
    v_mfma_f32_16x16x32_bf16 v[104:107], a[228:231], a[92:95], v[104:107]
    v_rcp_f32 v186, v186
    v_mfma_f32_16x16x32_bf16 v[88:91], a[232:235], a[88:91], v[88:91]
    s_waitcnt lgkmcnt(6)
    ds_read_b64_tr_b16 a[228:229], v24 offset:10272
    ds_read_b64_tr_b16 a[230:231], v24 offset:12832
    v_mfma_f32_16x16x32_bf16 v[108:111], a[232:235], a[92:95], v[108:111]
    v_rcp_f32 v187, v187
    v_mfma_f32_16x16x32_bf16 v[72:75], a[236:239], a[32:35], v[72:75]
    s_waitcnt lgkmcnt(6)
    ds_read_b64_tr_b16 a[232:233], v24 offset:15360
    ds_read_b64_tr_b16 a[234:235], v24 offset:17920
    v_mfma_f32_16x16x32_bf16 v[92:95], a[236:239], a[36:39], v[92:95]
    buffer_load_dwordx4 v6, s[12:15], s57 offen lds
    v_mfma_f32_16x16x32_bf16 v[76:79], a[240:243], a[32:35], v[76:79]
    s_waitcnt lgkmcnt(6)
    ds_read_b64_tr_b16 a[236:237], v24 offset:15368
    ds_read_b64_tr_b16 a[238:239], v24 offset:17928
    v_mfma_f32_16x16x32_bf16 v[96:99], a[240:243], a[36:39], v[96:99]
    v_rcp_f32 v188, v188
    v_mfma_f32_16x16x32_bf16 v[80:83], a[220:223], a[32:35], v[80:83]
    s_waitcnt lgkmcnt(6)
    ds_read_b64_tr_b16 a[240:241], v24 offset:15376
    ds_read_b64_tr_b16 a[242:243], v24 offset:17936
    v_mfma_f32_16x16x32_bf16 v[100:103], a[220:223], a[36:39], v[100:103]
    v_rcp_f32 v189, v189
    v_mfma_f32_16x16x32_bf16 v[84:87], a[224:227], a[32:35], v[84:87]
    s_waitcnt lgkmcnt(6)
    ds_read_b64_tr_b16 a[220:221], v24 offset:15384
    ds_read_b64_tr_b16 a[222:223], v24 offset:17944
    v_mfma_f32_16x16x32_bf16 v[104:107], a[224:227], a[36:39], v[104:107]
    v_rcp_f32 v190, v190
    v_mfma_f32_16x16x32_bf16 v[88:91], a[228:231], a[32:35], v[88:91]
    s_waitcnt lgkmcnt(6)
    ds_read_b64_tr_b16 a[224:225], v24 offset:15392
    ds_read_b64_tr_b16 a[226:227], v24 offset:17952
    v_mfma_f32_16x16x32_bf16 v[108:111], a[228:231], a[36:39], v[108:111]
    s_add_u32 m0, s40, 20480
    s_add_u32 s57, s36, 0
    buffer_load_dwordx4 v2, s[12:15], s57 offen lds
    v_mfma_f32_16x16x32_bf16 v[72:75], a[232:235], a[40:43], v[72:75]
    s_waitcnt lgkmcnt(6)
    ds_read_b64_tr_b16 a[228:229], v24 offset:20480
    ds_read_b64_tr_b16 a[230:231], v24 offset:23040
    v_mfma_f32_16x16x32_bf16 v[92:95], a[232:235], a[44:47], v[92:95]
    v_rcp_f32_e64 v191, v191
    v_pk_add_f32 v[198:199], v[172:173], v[174:175]
    v_pk_mul_f32 v[200:201], v[172:173], v[182:183]
    v_pk_fma_f32 v[200:201], v[174:175], v[184:185], v[200:201]
    v_pk_add_f32 v[198:199], v[198:199], v[176:177]
    v_pk_fma_f32 v[200:201], v[176:177], v[186:187], v[200:201]
    v_pk_add_f32 v[198:199], v[198:199], v[178:179]
    v_pk_fma_f32 v[200:201], v[178:179], v[188:189], v[200:201]
    v_pk_add_f32 v[198:199], v[198:199], v[180:181]
    v_pk_fma_f32 v[200:201], v[180:181], v[190:191], v[200:201]
    v_add_f32 v198, v198, v199
    v_add_f32 v200, v200, v201
    v_add_f32 v199, v198, v200
    v_rcp_f32 v200, v200
    v_cmp_ngt_f32 vcc, 0x53800000, v199
    v_rcp_f32_e64 v202, v198
    v_pk_mul_f32 v[182:183], v[182:183], v[200:201] op_sel_hi:[1,0]
    v_pk_mul_f32 v[184:185], v[184:185], v[200:201] op_sel_hi:[1,0]
    v_pk_mul_f32 v[186:187], v[186:187], v[200:201] op_sel_hi:[1,0]
    v_pk_mul_f32 v[188:189], v[188:189], v[200:201] op_sel_hi:[1,0]
    v_pk_mul_f32 v[190:191], v[190:191], v[200:201] op_sel_hi:[1,0]
    v_pk_mul_f32 v[172:173], v[182:183], v[162:163]
    v_pk_mul_f32 v[174:175], v[184:185], v[164:165]
    v_pk_mul_f32 v[176:177], v[186:187], v[166:167]
    v_pk_mul_f32 v[178:179], v[188:189], v[168:169]
    v_pk_mul_f32 v[180:181], v[190:191], v[170:171]
    v_pk_mul_f32 v[182:183], v[182:183], v[152:153]
    v_pk_mul_f32 v[184:185], v[184:185], v[154:155]
    v_pk_mul_f32 v[186:187], v[186:187], v[156:157]
    v_pk_mul_f32 v[188:189], v[188:189], v[158:159]
    v_pk_mul_f32 v[190:191], v[190:191], v[160:161]
    s_cbranch_vccnz L_k1A_slow
L_k1A_back:
    v_pk_mul_f32 v[152:153], v[152:153], v[202:203] op_sel_hi:[1,0]
    v_pk_mul_f32 v[154:155], v[154:155], v[202:203] op_sel_hi:[1,0]
    v_pk_mul_f32 v[156:157], v[156:157], v[202:203] op_sel_hi:[1,0]
    v_pk_mul_f32 v[158:159], v[158:159], v[202:203] op_sel_hi:[1,0]
    v_mfma_f32_16x16x32_bf16 v[76:79], a[236:239], a[40:43], v[76:79]
    s_waitcnt lgkmcnt(6)
    ds_read_b64_tr_b16 a[232:233], v24 offset:20488
    ds_read_b64_tr_b16 a[234:235], v24 offset:23048
    v_mfma_f32_16x16x32_bf16 v[96:99], a[236:239], a[44:47], v[96:99]
    v_cvt_pk_bf16_f32 v52, v152, v153
    v_cvt_pk_bf16_f32 v53, v154, v155
    v_mfma_f32_16x16x32_bf16 v[80:83], a[240:243], a[40:43], v[80:83]
    s_waitcnt lgkmcnt(6)
    ds_read_b64_tr_b16 a[236:237], v24 offset:20496
    ds_read_b64_tr_b16 a[238:239], v24 offset:23056
    v_mfma_f32_16x16x32_bf16 v[100:103], a[240:243], a[44:47], v[100:103]
    ds_write_b64 v26, v[52:53] offset:1920
    v_mfma_f32_16x16x32_bf16 v[84:87], a[220:223], a[40:43], v[84:87]
    s_waitcnt lgkmcnt(7)
    ds_read_b64_tr_b16 a[240:241], v24 offset:20504
    ds_read_b64_tr_b16 a[242:243], v24 offset:23064
    v_mfma_f32_16x16x32_bf16 v[104:107], a[220:223], a[44:47], v[104:107]
    buffer_load_dwordx4 v3, s[12:15], s57 offen offset:1024 lds
    v_mfma_f32_16x16x32_bf16 v[88:91], a[224:227], a[40:43], v[88:91]
    s_waitcnt lgkmcnt(7)
    ds_read_b64_tr_b16 a[220:221], v24 offset:20512
    ds_read_b64_tr_b16 a[222:223], v24 offset:23072
    v_mfma_f32_16x16x32_bf16 v[108:111], a[224:227], a[44:47], v[108:111]
    v_cvt_pk_bf16_f32 v54, v156, v157
    v_cvt_pk_bf16_f32 v55, v158, v159
    v_mfma_f32_16x16x32_bf16 v[72:75], a[228:231], a[48:51], v[72:75]
    s_waitcnt lgkmcnt(7)
    ds_read_b64_tr_b16 a[224:225], v24 offset:25600
    ds_read_b64_tr_b16 a[226:227], v24 offset:28160
    v_mfma_f32_16x16x32_bf16 v[92:95], a[228:231], a[52:55], v[92:95]
    ds_write_b64 v26, v[54:55] offset:1928
    v_mfma_f32_16x16x32_bf16 v[76:79], a[232:235], a[48:51], v[76:79]
    s_waitcnt lgkmcnt(8)
    ds_read_b64_tr_b16 a[228:229], v24 offset:25608
    ds_read_b64_tr_b16 a[230:231], v24 offset:28168
    v_mfma_f32_16x16x32_bf16 v[96:99], a[232:235], a[52:55], v[96:99]
    v_mul_f32 v160, v160, v202
    v_mul_f32 v161, v161, v202
    v_mfma_f32_16x16x32_bf16 v[80:83], a[236:239], a[48:51], v[80:83]
    s_waitcnt lgkmcnt(7)
    ds_read_b64_tr_b16 a[232:233], v24 offset:25616
    ds_read_b64_tr_b16 a[234:235], v24 offset:28176
    v_mfma_f32_16x16x32_bf16 v[100:103], a[236:239], a[52:55], v[100:103]
    buffer_load_dwordx4 v4, s[12:15], s57 offen offset:2048 lds
    v_mfma_f32_16x16x32_bf16 v[84:87], a[240:243], a[48:51], v[84:87]
    s_waitcnt lgkmcnt(7)
    ds_read_b64_tr_b16 a[236:237], v24 offset:25624
    ds_read_b64_tr_b16 a[238:239], v24 offset:28184
    v_mfma_f32_16x16x32_bf16 v[104:107], a[240:243], a[52:55], v[104:107]
    v_mul_f32 v162, v162, v202
    v_mul_f32 v163, v163, v202
    v_mfma_f32_16x16x32_bf16 v[88:91], a[220:223], a[48:51], v[88:91]
    s_waitcnt lgkmcnt(7)
    ds_read_b64_tr_b16 a[240:241], v24 offset:25632
    ds_read_b64_tr_b16 a[242:243], v24 offset:28192
    v_mfma_f32_16x16x32_bf16 v[108:111], a[220:223], a[52:55], v[108:111]
    v_cvt_pk_bf16_f32 v56, v160, v161
    v_cvt_pk_bf16_f32 v57, v162, v163
    v_mfma_f32_16x16x32_bf16 v[72:75], a[224:227], a[56:59], v[72:75]
    s_waitcnt lgkmcnt(6)
    s_waitcnt vmcnt(8)
    s_barrier
    ds_read_b64_tr_b16 a[220:221], v24 offset:30720
    ds_read_b64_tr_b16 a[222:223], v24 offset:33280
    v_mfma_f32_16x16x32_bf16 v[92:95], a[224:227], a[60:63], v[92:95]
    ds_write_b64 v26, v[56:57] offset:1936
    v_mfma_f32_16x16x32_bf16 v[76:79], a[228:231], a[56:59], v[76:79]
    s_waitcnt lgkmcnt(7)
    ds_read_b64_tr_b16 a[224:225], v24 offset:30728
    ds_read_b64_tr_b16 a[226:227], v24 offset:33288
    v_mfma_f32_16x16x32_bf16 v[96:99], a[228:231], a[60:63], v[96:99]
    buffer_load_dwordx4 v5, s[12:15], s57 offen offset:3072 lds
    s_add_u32 m0, s40, 24576
    v_mfma_f32_16x16x32_bf16 v[80:83], a[232:235], a[56:59], v[80:83]
    s_waitcnt lgkmcnt(7)
    ds_read_b64_tr_b16 a[228:229], v24 offset:30736
    ds_read_b64_tr_b16 a[230:231], v24 offset:33296
    v_mfma_f32_16x16x32_bf16 v[100:103], a[232:235], a[60:63], v[100:103]
    v_mul_f32 v164, v164, v202
    v_mul_f32 v165, v165, v202
    v_mfma_f32_16x16x32_bf16 v[84:87], a[236:239], a[56:59], v[84:87]
    s_waitcnt lgkmcnt(7)
    ds_read_b64_tr_b16 a[232:233], v24 offset:30744
    ds_read_b64_tr_b16 a[234:235], v24 offset:33304
    v_mfma_f32_16x16x32_bf16 v[104:107], a[236:239], a[60:63], v[104:107]
    v_mul_f32 v166, v166, v202
    v_mul_f32 v167, v167, v202
    v_mfma_f32_16x16x32_bf16 v[88:91], a[240:243], a[56:59], v[88:91]
    s_waitcnt lgkmcnt(7)
    ds_read_b64_tr_b16 a[236:237], v24 offset:30752
    ds_read_b64_tr_b16 a[238:239], v24 offset:33312
    v_mfma_f32_16x16x32_bf16 v[108:111], a[240:243], a[60:63], v[108:111]
    v_cvt_pk_bf16_f32 v58, v164, v165
    v_cvt_pk_bf16_f32 v59, v166, v167
    v_mfma_f32_16x16x32_bf16 v[72:75], a[220:223], a[0:3], v[72:75]
    s_waitcnt lgkmcnt(6)
    ds_read_b64_tr_b16 a[240:241], v24 offset:35840
    ds_read_b64_tr_b16 a[242:243], v24 offset:38400
    v_mfma_f32_16x16x32_bf16 v[92:95], a[220:223], a[4:7], v[92:95]
    buffer_load_dwordx4 v6, s[12:15], s57 offen lds
    v_mfma_f32_16x16x32_bf16 v[76:79], a[224:227], a[0:3], v[76:79]
    s_waitcnt lgkmcnt(6)
    ds_read_b64_tr_b16 a[220:221], v24 offset:35848
    ds_read_b64_tr_b16 a[222:223], v24 offset:38408
    v_mfma_f32_16x16x32_bf16 v[96:99], a[224:227], a[4:7], v[96:99]
    ds_write_b64 v26, v[58:59] offset:1944
    v_mfma_f32_16x16x32_bf16 v[80:83], a[228:231], a[0:3], v[80:83]
    s_waitcnt lgkmcnt(7)
    ds_read_b64_tr_b16 a[224:225], v24 offset:35856
    ds_read_b64_tr_b16 a[226:227], v24 offset:38416
    v_mfma_f32_16x16x32_bf16 v[100:103], a[228:231], a[4:7], v[100:103]
    v_mul_f32 v168, v168, v202
    v_mul_f32 v169, v169, v202
    v_mfma_f32_16x16x32_bf16 v[84:87], a[232:235], a[0:3], v[84:87]
    s_waitcnt lgkmcnt(7)
    ds_read_b64_tr_b16 a[228:229], v24 offset:35864
    ds_read_b64_tr_b16 a[230:231], v24 offset:38424
    v_mfma_f32_16x16x32_bf16 v[104:107], a[232:235], a[4:7], v[104:107]
    v_mul_f32 v170, v170, v202
    v_mul_f32 v171, v171, v202
    v_mfma_f32_16x16x32_bf16 v[88:91], a[236:239], a[0:3], v[88:91]
    s_waitcnt lgkmcnt(7)
    ds_read_b64_tr_b16 a[232:233], v24 offset:35872
    ds_read_b64_tr_b16 a[234:235], v24 offset:38432
    v_mfma_f32_16x16x32_bf16 v[108:111], a[236:239], a[4:7], v[108:111]
    s_add_u32 m0, s40, 40960
    s_add_u32 s57, s35, 0
    buffer_load_dwordx4 v2, s[12:15], s57 offen lds
    v_mfma_f32_16x16x32_bf16 v[72:75], a[240:243], a[8:11], v[72:75]
    s_waitcnt lgkmcnt(7)
    ds_read_b64_tr_b16 a[236:237], v24 offset:40960
    ds_read_b64_tr_b16 a[238:239], v24 offset:43520
    v_mfma_f32_16x16x32_bf16 v[92:95], a[240:243], a[12:15], v[92:95]
    v_cvt_pk_bf16_f32 v60, v168, v169
    v_cvt_pk_bf16_f32 v61, v170, v171
    v_mfma_f32_16x16x32_bf16 v[76:79], a[220:223], a[8:11], v[76:79]
    s_waitcnt lgkmcnt(6)
    ds_read_b64_tr_b16 a[240:241], v24 offset:40968
    ds_read_b64_tr_b16 a[242:243], v24 offset:43528
    v_mfma_f32_16x16x32_bf16 v[96:99], a[220:223], a[12:15], v[96:99]
    ds_write_b64 v26, v[60:61] offset:1952
    v_mfma_f32_16x16x32_bf16 v[80:83], a[224:227], a[8:11], v[80:83]
    s_waitcnt lgkmcnt(7)
    ds_read_b64_tr_b16 a[220:221], v24 offset:40976
    ds_read_b64_tr_b16 a[222:223], v24 offset:43536
    v_mfma_f32_16x16x32_bf16 v[100:103], a[224:227], a[12:15], v[100:103]
    v_cvt_pk_bf16_f32 v62, v172, v173
    v_cvt_pk_bf16_f32 v63, v174, v175
    v_mfma_f32_16x16x32_bf16 v[84:87], a[228:231], a[8:11], v[84:87]
    s_waitcnt lgkmcnt(7)
    ds_read_b64_tr_b16 a[224:225], v24 offset:40984
    ds_read_b64_tr_b16 a[226:227], v24 offset:43544
    v_mfma_f32_16x16x32_bf16 v[104:107], a[228:231], a[12:15], v[104:107]
    buffer_load_dwordx4 v3, s[12:15], s57 offen offset:1024 lds
    v_mfma_f32_16x16x32_bf16 v[88:91], a[232:235], a[8:11], v[88:91]
    s_waitcnt lgkmcnt(7)
    ds_read_b64_tr_b16 a[228:229], v24 offset:40992
    ds_read_b64_tr_b16 a[230:231], v24 offset:43552
    v_mfma_f32_16x16x32_bf16 v[108:111], a[232:235], a[12:15], v[108:111]
    ds_write_b64 v26, v[62:63] offset:1960
    v_mfma_f32_16x16x32_bf16 v[72:75], a[236:239], a[16:19], v[72:75]
    s_waitcnt lgkmcnt(8)
    ds_read_b64_tr_b16 a[232:233], v24 offset:46080
    ds_read_b64_tr_b16 a[234:235], v24 offset:48640
    v_mfma_f32_16x16x32_bf16 v[92:95], a[236:239], a[20:23], v[92:95]
    buffer_load_dword v204, v250, s[20:23], s93 offen sc1
    v_cvt_pk_bf16_f32 v64, v176, v177
    v_cvt_pk_bf16_f32 v65, v178, v179
    v_mfma_f32_16x16x32_bf16 v[76:79], a[240:243], a[16:19], v[76:79]
    s_waitcnt lgkmcnt(7)
    ds_read_b64_tr_b16 a[236:237], v24 offset:46088
    ds_read_b64_tr_b16 a[238:239], v24 offset:48648
    v_mfma_f32_16x16x32_bf16 v[96:99], a[240:243], a[20:23], v[96:99]
    ds_write_b64 v26, v[64:65] offset:1968
    v_mfma_f32_16x16x32_bf16 v[80:83], a[220:223], a[16:19], v[80:83]
    s_waitcnt lgkmcnt(8)
    ds_read_b64_tr_b16 a[240:241], v24 offset:46096
    ds_read_b64_tr_b16 a[242:243], v24 offset:48656
    v_mfma_f32_16x16x32_bf16 v[100:103], a[220:223], a[20:23], v[100:103]
    buffer_load_dwordx4 v4, s[12:15], s57 offen offset:2048 lds
    v_mfma_f32_16x16x32_bf16 v[84:87], a[224:227], a[16:19], v[84:87]
    s_waitcnt lgkmcnt(8)
    ds_read_b64_tr_b16 a[220:221], v24 offset:46104
    ds_read_b64_tr_b16 a[222:223], v24 offset:48664
    v_mfma_f32_16x16x32_bf16 v[104:107], a[224:227], a[20:23], v[104:107]
    v_cvt_pk_bf16_f32 v66, v180, v181
    v_cvt_pk_bf16_f32 v67, v182, v183
    v_mfma_f32_16x16x32_bf16 v[88:91], a[228:231], a[16:19], v[88:91]
    s_waitcnt lgkmcnt(7)
    ds_read_b64_tr_b16 a[224:225], v24 offset:46112
    ds_read_b64_tr_b16 a[226:227], v24 offset:48672
    v_mfma_f32_16x16x32_bf16 v[108:111], a[228:231], a[20:23], v[108:111]
    ds_write_b64 v26, v[66:67] offset:1976
    v_mfma_f32_16x16x32_bf16 v[72:75], a[232:235], a[24:27], v[72:75]
    s_waitcnt lgkmcnt(8)
    v_cvt_pk_bf16_f32 v68, v184, v185
    v_cvt_pk_bf16_f32 v69, v186, v187
    v_mfma_f32_16x16x32_bf16 v[92:95], a[232:235], a[28:31], v[92:95]
    ds_write_b64 v26, v[68:69] offset:1984
    v_mfma_f32_16x16x32_bf16 v[76:79], a[236:239], a[24:27], v[76:79]
    s_waitcnt lgkmcnt(6)
    v_cvt_pk_bf16_f32 v70, v188, v189
    v_cvt_pk_bf16_f32 v71, v190, v191
    v_mfma_f32_16x16x32_bf16 v[96:99], a[236:239], a[28:31], v[96:99]
    buffer_load_dwordx4 v5, s[12:15], s57 offen offset:3072 lds
    s_add_u32 m0, s40, 45056
    v_mfma_f32_16x16x32_bf16 v[80:83], a[240:243], a[24:27], v[80:83]
    s_waitcnt lgkmcnt(4)
    ds_write_b64 v26, v[70:71] offset:1992
    v_mfma_f32_16x16x32_bf16 v[100:103], a[240:243], a[28:31], v[100:103]
    v_cvt_pk_bf16_f32 v112, v72, v73
    v_cvt_pk_bf16_f32 v113, v74, v75
    v_mfma_f32_16x16x32_bf16 v[84:87], a[220:223], a[24:27], v[84:87]
    s_waitcnt lgkmcnt(3)
    ds_write_b64 v26, v[112:113] offset:80
    v_mfma_f32_16x16x32_bf16 v[104:107], a[220:223], a[28:31], v[104:107]
    v_cvt_pk_bf16_f32 v122, v92, v93
    v_cvt_pk_bf16_f32 v123, v94, v95
    v_mfma_f32_16x16x32_bf16 v[88:91], a[224:227], a[24:27], v[88:91]
    ds_write_b64 v26, v[122:123] offset:2000
    v_mfma_f32_16x16x32_bf16 v[108:111], a[224:227], a[28:31], v[108:111]
    v_cvt_pk_bf16_f32 v114, v76, v77
    v_cvt_pk_bf16_f32 v115, v78, v79
    ds_write_b64 v26, v[114:115] offset:88
    v_cvt_pk_bf16_f32 v124, v96, v97
    v_cvt_pk_bf16_f32 v125, v98, v99
    ds_write_b64 v26, v[124:125] offset:2008
    v_cvt_pk_bf16_f32 v116, v80, v81
    v_cvt_pk_bf16_f32 v117, v82, v83
    ds_write_b64 v26, v[116:117] offset:96
    v_cvt_pk_bf16_f32 v126, v100, v101
    v_cvt_pk_bf16_f32 v127, v102, v103
    ds_write_b64 v26, v[126:127] offset:2016
    v_cvt_pk_bf16_f32 v118, v84, v85
    v_cvt_pk_bf16_f32 v119, v86, v87
    ds_write_b64 v26, v[118:119] offset:104
    v_cvt_pk_bf16_f32 v128, v104, v105
    v_cvt_pk_bf16_f32 v129, v106, v107
    buffer_load_dwordx4 v6, s[12:15], s57 offen lds
    ds_write_b64 v26, v[128:129] offset:2024
    v_cvt_pk_bf16_f32 v120, v88, v89
    v_cvt_pk_bf16_f32 v121, v90, v91
    ds_write_b64 v26, v[120:121] offset:112
    v_cvt_pk_bf16_f32 v130, v108, v109
    v_cvt_pk_bf16_f32 v131, v110, v111
    ds_write_b64 v26, v[130:131] offset:2032
    s_waitcnt vmcnt(6) lgkmcnt(0)
    s_barrier
    ds_read_b64_tr_b16 v[32:33], v28 offset:80
    ds_read_b64_tr_b16 v[34:35], v28 offset:200
    ds_read_b64_tr_b16 v[40:41], v28 offset:0
    ds_read_b64_tr_b16 v[42:43], v28 offset:120
    ds_read_b64_tr_b16 v[44:45], v28 offset:32
    ds_read_b64_tr_b16 v[46:47], v28 offset:152
    ds_read_b64_tr_b16 v[48:49], v28 offset:64
    ds_read_b64_tr_b16 v[50:51], v28 offset:184
    ds_read_b64_tr_b16 v[36:37], v30 offset:112
    ds_read_b64_tr_b16 v[38:39], v30 offset:232
    ds_read_b64_tr_b16 v[52:53], v28 offset:15440
    ds_read_b64_tr_b16 v[54:55], v28 offset:15560
    ds_read_b64_tr_b16 v[60:61], v28 offset:15360
    ds_read_b64_tr_b16 v[62:63], v28 offset:15480
    ds_read_b64_tr_b16 v[64:65], v28 offset:15392
    s_add_u32 m0, s40, 61440
    s_add_u32 s57, s34, 0
    buffer_load_dwordx4 v2, s[12:15], s57 offen lds
    v_mov_b32 v113, 0xff
    s_waitcnt lgkmcnt(11)
    v_mfma_f32_16x16x32_bf16 v[176:179], v[32:35], v[40:43], 0
    s_waitcnt lgkmcnt(9)
    ds_read_b64_tr_b16 v[66:67], v28 offset:15512
    ds_read_b64_tr_b16 v[68:69], v28 offset:15424
    ds_read_b64_tr_b16 v[70:71], v28 offset:15544
    ds_read_b64_tr_b16 v[56:57], v30 offset:15472
    v_mfma_f32_16x16x32_bf16 v[180:183], v[32:35], v[44:47], 0
    s_waitcnt lgkmcnt(11)
    ds_read_b64_tr_b16 v[58:59], v30 offset:15592
    ds_read_b64_tr_b16 v[72:73], v28 offset:30800
    ds_read_b64_tr_b16 v[74:75], v28 offset:30920
    ds_read_b64_tr_b16 v[80:81], v28 offset:30720
    v_mfma_f32_16x16x32_bf16 v[184:187], v[32:35], v[48:51], 0
    s_waitcnt lgkmcnt(9)
    ds_read_b64_tr_b16 v[82:83], v28 offset:30840
    ds_read_b64_tr_b16 v[84:85], v28 offset:30752
    ds_read_b64_tr_b16 v[86:87], v28 offset:30872
    ds_read_b64_tr_b16 v[88:89], v28 offset:30784
    v_mfma_f32_16x16x32_bf16 v[176:179], v[52:55], v[60:63], v[176:179]
    s_waitcnt lgkmcnt(11)
    ds_read_b64_tr_b16 v[90:91], v28 offset:30904
    ds_read_b64_tr_b16 v[76:77], v30 offset:30832
    ds_read_b64_tr_b16 v[78:79], v30 offset:30952
    ds_read_b64_tr_b16 v[92:93], v28 offset:46160
    v_mfma_f32_16x16x32_bf16 v[180:183], v[52:55], v[64:67], v[180:183]
    s_waitcnt lgkmcnt(13)
    ds_read_b64_tr_b16 v[94:95], v28 offset:46280
    ds_read_b64_tr_b16 v[100:101], v28 offset:46080
    v_and_or_b32 v36, v36, v237, v238
    v_mfma_f32_16x16x32_bf16 v[184:187], v[52:55], v[68:71], v[184:187]
    s_waitcnt lgkmcnt(9)
    ds_read_b64_tr_b16 v[102:103], v28 offset:46200
    ds_read_b64_tr_b16 v[104:105], v28 offset:46112
    ds_read_b64_tr_b16 v[106:107], v28 offset:46232
    ds_read_b64_tr_b16 v[108:109], v28 offset:46144
    v_mfma_f32_16x16x32_bf16 v[176:179], v[72:75], v[80:83], v[176:179]
    s_waitcnt lgkmcnt(11)
    ds_read_b64_tr_b16 v[110:111], v28 offset:46264
    ds_read_b64_tr_b16 v[96:97], v30 offset:46192
    ds_read_b64_tr_b16 v[98:99], v30 offset:46312
    v_mfma_f32_16x16x32_bf16 v[180:183], v[72:75], v[84:87], v[180:183]
    s_waitcnt lgkmcnt(12)
    v_and_or_b32 v37, v37, v237, v238
    v_and_or_b32 v38, v38, v237, v238
    v_and_or_b32 v39, v39, v237, v238
    v_mfma_f32_16x16x32_bf16 v[184:187], v[72:75], v[88:91], v[184:187]
    s_waitcnt lgkmcnt(6)
    v_and_or_b32 v56, v56, v237, v238
    v_and_or_b32 v57, v57, v237, v238
    v_and_or_b32 v58, v58, v237, v238
    v_mfma_f32_16x16x32_bf16 v[176:179], v[92:95], v[100:103], v[176:179]
    s_waitcnt lgkmcnt(4)
    v_and_or_b32 v59, v59, v237, v238
    v_and_or_b32 v76, v76, v237, v238
    v_and_or_b32 v77, v77, v237, v238
    v_mfma_f32_16x16x32_bf16 v[180:183], v[92:95], v[104:107], v[180:183]
    s_waitcnt lgkmcnt(2)
    v_and_or_b32 v78, v78, v237, v238
    v_and_or_b32 v79, v79, v237, v238
    v_mfma_f32_16x16x32_bf16 v[184:187], v[92:95], v[108:111], v[184:187]
    s_waitcnt lgkmcnt(0)
    v_and_or_b32 v96, v96, v237, v238
    v_and_or_b32 v97, v97, v237, v238
    v_and_or_b32 v98, v98, v237, v238
    v_mfma_f32_16x16x32_bf16 v[188:191], v[36:39], v[40:43], 0
    v_and_or_b32 v99, v99, v237, v238
    v_bfi_b32 v176, v113, s8, v176
    v_mfma_f32_16x16x32_bf16 v[188:191], v[56:59], v[60:63], v[188:191]
    v_bfi_b32 v177, v113, s9, v177
    v_bfi_b32 v178, v113, s10, v178
    v_mfma_f32_16x16x32_bf16 v[188:191], v[76:79], v[80:83], v[188:191]
    v_bfi_b32 v179, v113, s11, v179
    v_mfma_f32_16x16x32_bf16 v[188:191], v[96:99], v[100:103], v[188:191]
    buffer_store_dwordx4 v[176:179], v228, s[20:23], s68 offen offset:0 sc1
    v_mfma_f32_16x16x32_bf16 v[192:195], v[36:39], v[44:47], 0
    v_bfi_b32 v180, v113, s8, v180
    v_bfi_b32 v181, v113, s9, v181
    v_mfma_f32_16x16x32_bf16 v[192:195], v[56:59], v[64:67], v[192:195]
    v_bfi_b32 v182, v113, s10, v182
    v_bfi_b32 v183, v113, s11, v183
    v_mfma_f32_16x16x32_bf16 v[192:195], v[76:79], v[84:87], v[192:195]
    buffer_store_dwordx4 v[180:183], v228, s[20:23], s68 offen offset:256 sc1
    v_mfma_f32_16x16x32_bf16 v[192:195], v[96:99], v[104:107], v[192:195]
    v_bfi_b32 v184, v113, s8, v184
    v_bfi_b32 v185, v113, s9, v185
    v_mfma_f32_16x16x32_bf16 v[196:199], v[36:39], v[48:51], 0
    v_bfi_b32 v186, v113, s10, v186
    v_bfi_b32 v187, v113, s11, v187
    v_mfma_f32_16x16x32_bf16 v[196:199], v[56:59], v[68:71], v[196:199]
    buffer_store_dwordx4 v[184:187], v14, s[20:23], s68 offen offset:512 sc1
    v_mfma_f32_16x16x32_bf16 v[196:199], v[76:79], v[88:91], v[196:199]
    ds_read_b64_tr_b16 a[228:229], v23 offset:0
    ds_read_b64_tr_b16 a[230:231], v23 offset:2560
    v_mfma_f32_16x16x32_bf16 v[196:199], v[96:99], v[108:111], v[196:199]
    ds_read_b64_tr_b16 a[232:233], v23 offset:8
    ds_read_b64_tr_b16 a[234:235], v23 offset:2568
    ds_read_b64_tr_b16 a[236:237], v23 offset:16
    ds_read_b64_tr_b16 a[238:239], v23 offset:2576
    ds_read_b64_tr_b16 a[240:241], v23 offset:24
    ds_read_b64_tr_b16 a[242:243], v23 offset:2584
    ds_read_b64_tr_b16 a[220:221], v23 offset:32
    ds_read_b64_tr_b16 a[222:223], v23 offset:2592
    s_waitcnt lgkmcnt(8)
    v_mfma_f32_16x16x32_bf16 v[32:35], a[228:231], a[128:131], 0
L_hop3A:
    s_cbranch_execz L_hopretA
    s_waitcnt lgkmcnt(6)
    ds_read_b64_tr_b16 a[224:225], v23 offset:5120
    ds_read_b64_tr_b16 a[226:227], v23 offset:7680
    v_mfma_f32_16x16x32_bf16 v[52:55], a[228:231], a[132:135], 0
    v_bfi_b32 v188, v113, s8, v188
    v_bfi_b32 v189, v113, s9, v189
    v_mfma_f32_16x16x32_bf16 v[36:39], a[232:235], a[128:131], 0
    s_waitcnt lgkmcnt(6)
    ds_read_b64_tr_b16 a[228:229], v23 offset:5128
    ds_read_b64_tr_b16 a[230:231], v23 offset:7688
    v_mfma_f32_16x16x32_bf16 v[56:59], a[232:235], a[132:135], 0
    buffer_load_dwordx2 v[206:207], v13, s[20:23], s91 offen sc1
    v_bfi_b32 v190, v113, s10, v190
    v_bfi_b32 v191, v113, s11, v191
    v_mfma_f32_16x16x32_bf16 v[40:43], a[236:239], a[128:131], 0
    s_waitcnt lgkmcnt(6)
    ds_read_b64_tr_b16 a[232:233], v23 offset:5136
    ds_read_b64_tr_b16 a[234:235], v23 offset:7696
    v_mfma_f32_16x16x32_bf16 v[60:63], a[236:239], a[132:135], 0
    buffer_store_dwordx4 v[188:191], v15, s[20:23], s68 offen offset:2560 sc1
    v_mfma_f32_16x16x32_bf16 v[44:47], a[240:243], a[128:131], 0
    s_waitcnt lgkmcnt(6)
    ds_read_b64_tr_b16 a[236:237], v23 offset:5144
    ds_read_b64_tr_b16 a[238:239], v23 offset:7704
    v_mfma_f32_16x16x32_bf16 v[64:67], a[240:243], a[132:135], 0
    v_bfi_b32 v192, v113, s8, v192
    v_bfi_b32 v193, v113, s9, v193
    v_mfma_f32_16x16x32_bf16 v[48:51], a[220:223], a[128:131], 0
    s_waitcnt lgkmcnt(6)
    ds_read_b64_tr_b16 a[240:241], v23 offset:5152
    ds_read_b64_tr_b16 a[242:243], v23 offset:7712
    v_mfma_f32_16x16x32_bf16 v[68:71], a[220:223], a[132:135], 0
    v_bfi_b32 v194, v113, s10, v194
    v_bfi_b32 v195, v113, s11, v195
    v_mfma_f32_16x16x32_bf16 v[32:35], a[224:227], a[136:139], v[32:35]
    s_waitcnt lgkmcnt(6)
    ds_read_b64_tr_b16 a[220:221], v23 offset:10240
    ds_read_b64_tr_b16 a[222:223], v23 offset:12800
    v_mfma_f32_16x16x32_bf16 v[52:55], a[224:227], a[140:143], v[52:55]
    buffer_store_dwordx4 v[192:195], v15, s[20:23], s68 offen offset:2816 sc1
    v_mfma_f32_16x16x32_bf16 v[36:39], a[228:231], a[136:139], v[36:39]
    s_waitcnt lgkmcnt(6)
    ds_read_b64_tr_b16 a[224:225], v23 offset:10248
    ds_read_b64_tr_b16 a[226:227], v23 offset:12808
    v_mfma_f32_16x16x32_bf16 v[56:59], a[228:231], a[140:143], v[56:59]
    v_bfi_b32 v196, v113, s8, v196
    v_bfi_b32 v197, v113, s9, v197
    v_mfma_f32_16x16x32_bf16 v[40:43], a[232:235], a[136:139], v[40:43]
    s_waitcnt lgkmcnt(6)
    ds_read_b64_tr_b16 a[228:229], v23 offset:10256
    ds_read_b64_tr_b16 a[230:231], v23 offset:12816
    v_mfma_f32_16x16x32_bf16 v[60:63], a[232:235], a[140:143], v[60:63]
    v_bfi_b32 v198, v113, s10, v198
    v_bfi_b32 v199, v113, s11, v199
    v_mfma_f32_16x16x32_bf16 v[44:47], a[236:239], a[136:139], v[44:47]
    s_waitcnt lgkmcnt(6)
    ds_read_b64_tr_b16 a[232:233], v23 offset:10264
    ds_read_b64_tr_b16 a[234:235], v23 offset:12824
    v_mfma_f32_16x16x32_bf16 v[64:67], a[236:239], a[140:143], v[64:67]
    buffer_store_dwordx4 v[196:199], v16, s[20:23], s68 offen offset:3072 sc1
    v_mfma_f32_16x16x32_bf16 v[48:51], a[240:243], a[136:139], v[48:51]
    s_waitcnt lgkmcnt(6)
    ds_read_b64_tr_b16 a[236:237], v23 offset:10272
    ds_read_b64_tr_b16 a[238:239], v23 offset:12832
    v_mfma_f32_16x16x32_bf16 v[68:71], a[240:243], a[140:143], v[68:71]
    v_mfma_f32_16x16x32_bf16 v[32:35], a[220:223], a[144:147], v[32:35]
    s_waitcnt lgkmcnt(6)
    ds_read_b64_tr_b16 a[240:241], v23 offset:15360
    ds_read_b64_tr_b16 a[242:243], v23 offset:17920
    v_mfma_f32_16x16x32_bf16 v[52:55], a[220:223], a[148:151], v[52:55]
    v_mfma_f32_16x16x32_bf16 v[36:39], a[224:227], a[144:147], v[36:39]
    s_waitcnt lgkmcnt(6)
    ds_read_b64_tr_b16 a[220:221], v23 offset:15368
    ds_read_b64_tr_b16 a[222:223], v23 offset:17928
    v_mfma_f32_16x16x32_bf16 v[56:59], a[224:227], a[148:151], v[56:59]
    v_mfma_f32_16x16x32_bf16 v[40:43], a[228:231], a[144:147], v[40:43]
    s_waitcnt lgkmcnt(6)
    ds_read_b64_tr_b16 a[224:225], v23 offset:15376
    ds_read_b64_tr_b16 a[226:227], v23 offset:17936
    v_mfma_f32_16x16x32_bf16 v[60:63], a[228:231], a[148:151], v[60:63]
    buffer_load_dwordx4 v3, s[12:15], s57 offen offset:1024 lds
    v_mfma_f32_16x16x32_bf16 v[44:47], a[232:235], a[144:147], v[44:47]
    s_waitcnt lgkmcnt(6)
    ds_read_b64_tr_b16 a[228:229], v23 offset:15384
    ds_read_b64_tr_b16 a[230:231], v23 offset:17944
    v_mfma_f32_16x16x32_bf16 v[64:67], a[232:235], a[148:151], v[64:67]
    v_mfma_f32_16x16x32_bf16 v[48:51], a[236:239], a[144:147], v[48:51]
    s_waitcnt lgkmcnt(6)
    ds_read_b64_tr_b16 a[232:233], v23 offset:15392
    ds_read_b64_tr_b16 a[234:235], v23 offset:17952
    v_mfma_f32_16x16x32_bf16 v[68:71], a[236:239], a[148:151], v[68:71]
    v_mfma_f32_16x16x32_bf16 v[32:35], a[240:243], a[152:155], v[32:35]
    s_waitcnt lgkmcnt(6)
    ds_read_b64_tr_b16 a[236:237], v23 offset:20480
    ds_read_b64_tr_b16 a[238:239], v23 offset:23040
    v_mfma_f32_16x16x32_bf16 v[52:55], a[240:243], a[156:159], v[52:55]
    v_mfma_f32_16x16x32_bf16 v[36:39], a[220:223], a[152:155], v[36:39]
    s_waitcnt lgkmcnt(6)
    ds_read_b64_tr_b16 a[240:241], v23 offset:20488
    ds_read_b64_tr_b16 a[242:243], v23 offset:23048
    v_mfma_f32_16x16x32_bf16 v[56:59], a[220:223], a[156:159], v[56:59]
    buffer_load_dwordx4 v4, s[12:15], s57 offen offset:2048 lds
    v_mfma_f32_16x16x32_bf16 v[40:43], a[224:227], a[152:155], v[40:43]
    s_waitcnt lgkmcnt(6)
    ds_read_b64_tr_b16 a[220:221], v23 offset:20496
    ds_read_b64_tr_b16 a[222:223], v23 offset:23056
    v_mfma_f32_16x16x32_bf16 v[60:63], a[224:227], a[156:159], v[60:63]
    v_mfma_f32_16x16x32_bf16 v[44:47], a[228:231], a[152:155], v[44:47]
    s_waitcnt lgkmcnt(6)
    ds_read_b64_tr_b16 a[224:225], v23 offset:20504
    ds_read_b64_tr_b16 a[226:227], v23 offset:23064
    v_mfma_f32_16x16x32_bf16 v[64:67], a[228:231], a[156:159], v[64:67]
    v_mfma_f32_16x16x32_bf16 v[48:51], a[232:235], a[152:155], v[48:51]
    s_waitcnt lgkmcnt(6)
    ds_read_b64_tr_b16 a[228:229], v23 offset:20512
    ds_read_b64_tr_b16 a[230:231], v23 offset:23072
    v_mfma_f32_16x16x32_bf16 v[68:71], a[232:235], a[156:159], v[68:71]
    v_mfma_f32_16x16x32_bf16 v[32:35], a[236:239], a[96:99], v[32:35]
    s_waitcnt lgkmcnt(6)
    ds_read_b64_tr_b16 a[232:233], v23 offset:25600
    ds_read_b64_tr_b16 a[234:235], v23 offset:28160
    v_mfma_f32_16x16x32_bf16 v[52:55], a[236:239], a[100:103], v[52:55]
    buffer_load_dwordx4 v5, s[12:15], s57 offen offset:3072 lds
    s_add_u32 m0, s40, 65536
    v_mfma_f32_16x16x32_bf16 v[36:39], a[240:243], a[96:99], v[36:39]
    s_waitcnt lgkmcnt(6)
    ds_read_b64_tr_b16 a[236:237], v23 offset:25608
    ds_read_b64_tr_b16 a[238:239], v23 offset:28168
    v_mfma_f32_16x16x32_bf16 v[56:59], a[240:243], a[100:103], v[56:59]
    v_mfma_f32_16x16x32_bf16 v[40:43], a[220:223], a[96:99], v[40:43]
    s_waitcnt lgkmcnt(6)
    ds_read_b64_tr_b16 a[240:241], v23 offset:25616
    ds_read_b64_tr_b16 a[242:243], v23 offset:28176
    v_mfma_f32_16x16x32_bf16 v[60:63], a[220:223], a[100:103], v[60:63]
    s_waitcnt vmcnt(14)
    v_xor_b32 v205, s32, v204
    v_lshlrev_b32 v205, 4, v205
    v_mfma_f32_16x16x32_bf16 v[44:47], a[224:227], a[96:99], v[44:47]
    s_waitcnt lgkmcnt(6)
    ds_read_b64_tr_b16 a[220:221], v23 offset:25624
    ds_read_b64_tr_b16 a[222:223], v23 offset:28184
    v_mfma_f32_16x16x32_bf16 v[64:67], a[224:227], a[100:103], v[64:67]
    v_cmp_ne_u32 vcc, 0, v205
    v_mfma_f32_16x16x32_bf16 v[48:51], a[228:231], a[96:99], v[48:51]
    s_waitcnt lgkmcnt(6)
    ds_read_b64_tr_b16 a[224:225], v23 offset:25632
    ds_read_b64_tr_b16 a[226:227], v23 offset:28192
    v_mfma_f32_16x16x32_bf16 v[68:71], a[228:231], a[100:103], v[68:71]
    buffer_load_dwordx4 v6, s[12:15], s57 offen lds
    s_cbranch_vccnz L_xcA_retry
L_xcA_ok:
    v_cmp_ne_u32 vcc, s74, v204
    v_mfma_f32_16x16x32_bf16 v[32:35], a[232:235], a[104:107], v[32:35]
    s_waitcnt lgkmcnt(6)
    ds_read_b64_tr_b16 a[228:229], v23 offset:30720
    ds_read_b64_tr_b16 a[230:231], v23 offset:33280
    v_mfma_f32_16x16x32_bf16 v[52:55], a[232:235], a[108:111], v[52:55]
    s_mov_b32 s53, vcc_lo
    s_add_u32 s42, s20, 8388608
    s_addc_u32 s43, s21, 0
    v_mfma_f32_16x16x32_bf16 v[36:39], a[236:239], a[104:107], v[36:39]
    s_waitcnt lgkmcnt(6)
    ds_read_b64_tr_b16 a[232:233], v23 offset:30728
    ds_read_b64_tr_b16 a[234:235], v23 offset:33288
    v_mfma_f32_16x16x32_bf16 v[56:59], a[236:239], a[108:111], v[56:59]
    s_cmp_eq_u32 s53, 0
    s_cselect_b32 s28, s24, s42
    s_cselect_b32 s29, s25, s43
    v_mfma_f32_16x16x32_bf16 v[40:43], a[240:243], a[104:107], v[40:43]
    s_waitcnt lgkmcnt(6)
    ds_read_b64_tr_b16 a[236:237], v23 offset:30736
    ds_read_b64_tr_b16 a[238:239], v23 offset:33296
    v_mfma_f32_16x16x32_bf16 v[60:63], a[240:243], a[108:111], v[60:63]
    s_mov_b32 s30, 5242880
    s_mov_b32 s31, 0x20000
    v_mfma_f32_16x16x32_bf16 v[44:47], a[220:223], a[104:107], v[44:47]
    s_waitcnt lgkmcnt(6)
    ds_read_b64_tr_b16 a[240:241], v23 offset:30744
    ds_read_b64_tr_b16 a[242:243], v23 offset:33304
    v_mfma_f32_16x16x32_bf16 v[64:67], a[220:223], a[108:111], v[64:67]
    s_add_u32 m0, s40, 81920
    s_add_u32 s57, s33, 0
    buffer_load_dwordx4 v2, s[12:15], s57 offen lds
    s_waitcnt vmcnt(8)
    v_xor_b32 v206, s32, v206
    v_bitop3_b32 v206, v206, v207, s32 bitop3:0xf6
    v_mfma_f32_16x16x32_bf16 v[48:51], a[224:227], a[104:107], v[48:51]
    s_waitcnt lgkmcnt(6)
    ds_read_b64_tr_b16 a[220:221], v23 offset:30752
    ds_read_b64_tr_b16 a[222:223], v23 offset:33312
    v_mfma_f32_16x16x32_bf16 v[68:71], a[224:227], a[108:111], v[68:71]
    v_cmp_ne_u32 vcc, 0, v206
    v_mfma_f32_16x16x32_bf16 v[32:35], a[228:231], a[112:115], v[32:35]
    s_waitcnt lgkmcnt(6)
    ds_read_b64_tr_b16 a[224:225], v23 offset:35840
    ds_read_b64_tr_b16 a[226:227], v23 offset:38400
    v_mfma_f32_16x16x32_bf16 v[52:55], a[228:231], a[116:119], v[52:55]
    s_barrier
    v_mfma_f32_16x16x32_bf16 v[36:39], a[232:235], a[112:115], v[36:39]
    s_waitcnt lgkmcnt(6)
    ds_read_b64_tr_b16 a[228:229], v23 offset:35848
    ds_read_b64_tr_b16 a[230:231], v23 offset:38408
    v_mfma_f32_16x16x32_bf16 v[56:59], a[232:235], a[116:119], v[56:59]
    s_cbranch_vccnz L_pfA_retry
L_pfA_ok:
    v_mfma_f32_16x16x32_bf16 v[40:43], a[236:239], a[112:115], v[40:43]
    s_waitcnt lgkmcnt(6)
    ds_read_b64_tr_b16 a[232:233], v23 offset:35856
    ds_read_b64_tr_b16 a[234:235], v23 offset:38416
    v_mfma_f32_16x16x32_bf16 v[60:63], a[236:239], a[116:119], v[60:63]
    buffer_load_dwordx4 v3, s[12:15], s57 offen offset:1024 lds
    v_mfma_f32_16x16x32_bf16 v[44:47], a[240:243], a[112:115], v[44:47]
    s_waitcnt lgkmcnt(6)
    ds_read_b64_tr_b16 a[236:237], v23 offset:35864
    ds_read_b64_tr_b16 a[238:239], v23 offset:38424
    v_mfma_f32_16x16x32_bf16 v[64:67], a[240:243], a[116:119], v[64:67]
    v_mfma_f32_16x16x32_bf16 v[48:51], a[220:223], a[112:115], v[48:51]
    s_waitcnt lgkmcnt(6)
    ds_read_b64_tr_b16 a[240:241], v23 offset:35872
    ds_read_b64_tr_b16 a[242:243], v23 offset:38432
    v_mfma_f32_16x16x32_bf16 v[68:71], a[220:223], a[116:119], v[68:71]
    v_mov_b32 v116, 0
    v_mov_b32 v117, 0
    v_mfma_f32_16x16x32_bf16 v[32:35], a[224:227], a[120:123], v[32:35]
    s_waitcnt lgkmcnt(6)
    ds_read_b64_tr_b16 a[220:221], v23 offset:40960
    ds_read_b64_tr_b16 a[222:223], v23 offset:43520
    v_mfma_f32_16x16x32_bf16 v[52:55], a[224:227], a[124:127], v[52:55]
    ds_write_b64 v252, v[116:117]
    v_mfma_f32_16x16x32_bf16 v[36:39], a[228:231], a[120:123], v[36:39]
    s_waitcnt lgkmcnt(7)
    ds_read_b64_tr_b16 a[224:225], v23 offset:40968
    ds_read_b64_tr_b16 a[226:227], v23 offset:43528
    v_mfma_f32_16x16x32_bf16 v[56:59], a[228:231], a[124:127], v[56:59]
    buffer_load_dwordx4 v4, s[12:15], s57 offen offset:2048 lds
    v_mfma_f32_16x16x32_bf16 v[40:43], a[232:235], a[120:123], v[40:43]
    s_waitcnt lgkmcnt(7)
    ds_read_b64_tr_b16 a[228:229], v23 offset:40976
    ds_read_b64_tr_b16 a[230:231], v23 offset:43536
    v_mfma_f32_16x16x32_bf16 v[60:63], a[232:235], a[124:127], v[60:63]
    v_mfma_f32_16x16x32_bf16 v[44:47], a[236:239], a[120:123], v[44:47]
    s_waitcnt lgkmcnt(7)
    ds_read_b64_tr_b16 a[232:233], v23 offset:40984
    ds_read_b64_tr_b16 a[234:235], v23 offset:43544
    v_mfma_f32_16x16x32_bf16 v[64:67], a[236:239], a[124:127], v[64:67]
    v_mfma_f32_16x16x32_bf16 v[48:51], a[240:243], a[120:123], v[48:51]
    s_waitcnt lgkmcnt(7)
    ds_read_b64_tr_b16 a[236:237], v23 offset:40992
    ds_read_b64_tr_b16 a[238:239], v23 offset:43552
    v_mfma_f32_16x16x32_bf16 v[68:71], a[240:243], a[124:127], v[68:71]
    v_mfma_f32_16x16x32_bf16 v[32:35], a[220:223], a[64:67], v[32:35]
    s_waitcnt lgkmcnt(6)
    ds_read_b64_tr_b16 a[240:241], v23 offset:46080
    ds_read_b64_tr_b16 a[242:243], v23 offset:48640
    v_mfma_f32_16x16x32_bf16 v[52:55], a[220:223], a[68:71], v[52:55]
    buffer_load_dwordx4 v5, s[12:15], s57 offen offset:3072 lds
    s_add_u32 m0, s40, 86016
    v_mfma_f32_16x16x32_bf16 v[36:39], a[224:227], a[64:67], v[36:39]
    s_waitcnt lgkmcnt(6)
    ds_read_b64_tr_b16 a[220:221], v23 offset:46088
    ds_read_b64_tr_b16 a[222:223], v23 offset:48648
    v_mfma_f32_16x16x32_bf16 v[56:59], a[224:227], a[68:71], v[56:59]
    v_mfma_f32_16x16x32_bf16 v[40:43], a[228:231], a[64:67], v[40:43]
    s_waitcnt lgkmcnt(6)
    ds_read_b64_tr_b16 a[224:225], v23 offset:46096
    ds_read_b64_tr_b16 a[226:227], v23 offset:48656
    v_mfma_f32_16x16x32_bf16 v[60:63], a[228:231], a[68:71], v[60:63]
    buffer_load_dwordx4 v6, s[12:15], s57 offen lds
    v_mfma_f32_16x16x32_bf16 v[44:47], a[232:235], a[64:67], v[44:47]
    s_waitcnt lgkmcnt(6)
    ds_read_b64_tr_b16 a[228:229], v23 offset:46104
    ds_read_b64_tr_b16 a[230:231], v23 offset:48664
    v_mfma_f32_16x16x32_bf16 v[64:67], a[232:235], a[68:71], v[64:67]
    v_mfma_f32_16x16x32_bf16 v[48:51], a[236:239], a[64:67], v[48:51]
    s_waitcnt lgkmcnt(6)
    ds_read_b64_tr_b16 a[232:233], v23 offset:46112
    ds_read_b64_tr_b16 a[234:235], v23 offset:48672
    v_mfma_f32_16x16x32_bf16 v[68:71], a[236:239], a[68:71], v[68:71]
    v_mfma_f32_16x16x32_bf16 v[32:35], a[240:243], a[72:75], v[32:35]
    s_waitcnt lgkmcnt(6)
    ds_read_b64_tr_b16 a[236:237], v24 offset:0
    ds_read_b64_tr_b16 a[238:239], v24 offset:2560
    v_mfma_f32_16x16x32_bf16 v[52:55], a[240:243], a[76:79], v[52:55]
    s_add_u32 m0, s40, 0
    s_nop 0
    buffer_load_dwordx4 v25, s[20:23], s46 offen sc1 lds
    v_mfma_f32_16x16x32_bf16 v[36:39], a[220:223], a[72:75], v[36:39]
    s_waitcnt lgkmcnt(6)
    ds_read_b64_tr_b16 a[240:241], v24 offset:8
    ds_read_b64_tr_b16 a[242:243], v24 offset:2568
    v_mfma_f32_16x16x32_bf16 v[56:59], a[220:223], a[76:79], v[56:59]
    s_add_u32 s42, s69, 0
    buffer_load_dwordx4 v[120:123], v229, s[20:23], s42 offen sc1
    v_mfma_f32_16x16x32_bf16 v[40:43], a[224:227], a[72:75], v[40:43]
    s_waitcnt lgkmcnt(6)
    ds_read_b64_tr_b16 a[220:221], v24 offset:16
    ds_read_b64_tr_b16 a[222:223], v24 offset:2576
    v_mfma_f32_16x16x32_bf16 v[60:63], a[224:227], a[76:79], v[60:63]
    s_add_u32 s42, s69, 16384
    buffer_load_dwordx4 v[124:127], v229, s[20:23], s42 offen sc1
    v_mfma_f32_16x16x32_bf16 v[44:47], a[228:231], a[72:75], v[44:47]
    s_waitcnt lgkmcnt(6)
    ds_read_b64_tr_b16 a[224:225], v24 offset:24
    ds_read_b64_tr_b16 a[226:227], v24 offset:2584
    v_mfma_f32_16x16x32_bf16 v[64:67], a[228:231], a[76:79], v[64:67]
    s_add_u32 s42, s69, 32768
    buffer_load_dwordx4 v[128:131], v229, s[20:23], s42 offen sc1
    v_mfma_f32_16x16x32_bf16 v[48:51], a[232:235], a[72:75], v[48:51]
    s_waitcnt lgkmcnt(6)
    ds_read_b64_tr_b16 a[228:229], v24 offset:32
    ds_read_b64_tr_b16 a[230:231], v24 offset:2592
    v_mfma_f32_16x16x32_bf16 v[68:71], a[232:235], a[76:79], v[68:71]
    s_add_u32 s42, s69, 49152
    buffer_load_dwordx4 v[132:135], v229, s[20:23], s42 offen sc1
    v_mfma_f32_16x16x32_bf16 v[32:35], a[236:239], a[80:83], v[32:35]
    s_waitcnt lgkmcnt(6)
    ds_read_b64_tr_b16 a[232:233], v24 offset:5120
    ds_read_b64_tr_b16 a[234:235], v24 offset:7680
    v_mfma_f32_16x16x32_bf16 v[52:55], a[236:239], a[84:87], v[52:55]
    v_mfma_f32_16x16x32_bf16 v[36:39], a[240:243], a[80:83], v[36:39]
    s_waitcnt lgkmcnt(6)
    ds_read_b64_tr_b16 a[236:237], v24 offset:5128
    ds_read_b64_tr_b16 a[238:239], v24 offset:7688
    v_mfma_f32_16x16x32_bf16 v[56:59], a[240:243], a[84:87], v[56:59]
    buffer_load_dwordx4 v25, s[20:23], s46 offen offset:1024 sc1 lds
    v_mfma_f32_16x16x32_bf16 v[40:43], a[220:223], a[80:83], v[40:43]
    s_waitcnt lgkmcnt(6)
    ds_read_b64_tr_b16 a[240:241], v24 offset:5136
    ds_read_b64_tr_b16 a[242:243], v24 offset:7696
    v_mfma_f32_16x16x32_bf16 v[60:63], a[220:223], a[84:87], v[60:63]
    v_mfma_f32_16x16x32_bf16 v[44:47], a[224:227], a[80:83], v[44:47]
    s_waitcnt lgkmcnt(6)
    ds_read_b64_tr_b16 a[220:221], v24 offset:5144
    ds_read_b64_tr_b16 a[222:223], v24 offset:7704
    v_mfma_f32_16x16x32_bf16 v[64:67], a[224:227], a[84:87], v[64:67]
    s_waitcnt vmcnt(11)
    s_barrier
    v_mfma_f32_16x16x32_bf16 v[48:51], a[228:231], a[80:83], v[48:51]
    s_waitcnt lgkmcnt(6)
    ds_read_b64_tr_b16 a[224:225], v24 offset:5152
    ds_read_b64_tr_b16 a[226:227], v24 offset:7712
    v_mfma_f32_16x16x32_bf16 v[68:71], a[228:231], a[84:87], v[68:71]
    buffer_load_dwordx4 v25, s[20:23], s46 offen offset:2048 sc1 lds
    v_mfma_f32_16x16x32_bf16 v[32:35], a[232:235], a[88:91], v[32:35]
    s_waitcnt lgkmcnt(6)
    ds_read_b64_tr_b16 a[228:229], v24 offset:10240
    ds_read_b64_tr_b16 a[230:231], v24 offset:12800
    v_mfma_f32_16x16x32_bf16 v[52:55], a[232:235], a[92:95], v[52:55]
    v_mfma_f32_16x16x32_bf16 v[36:39], a[236:239], a[88:91], v[36:39]
    s_waitcnt lgkmcnt(6)
    ds_read_b64_tr_b16 a[232:233], v24 offset:10248
    ds_read_b64_tr_b16 a[234:235], v24 offset:12808
    v_mfma_f32_16x16x32_bf16 v[56:59], a[236:239], a[92:95], v[56:59]
    v_mfma_f32_16x16x32_bf16 v[40:43], a[240:243], a[88:91], v[40:43]
    s_waitcnt lgkmcnt(6)
    ds_read_b64_tr_b16 a[236:237], v24 offset:10256
    ds_read_b64_tr_b16 a[238:239], v24 offset:12816
    v_mfma_f32_16x16x32_bf16 v[60:63], a[240:243], a[92:95], v[60:63]
    buffer_load_dwordx4 v25, s[20:23], s46 offen offset:3072 sc1 lds
    s_add_u32 m0, s40, 4096
    s_add_u32 s46, s46, 4096
    v_mfma_f32_16x16x32_bf16 v[44:47], a[220:223], a[88:91], v[44:47]
    s_waitcnt lgkmcnt(6)
    ds_read_b64_tr_b16 a[240:241], v24 offset:10264
    ds_read_b64_tr_b16 a[242:243], v24 offset:12824
    v_mfma_f32_16x16x32_bf16 v[64:67], a[220:223], a[92:95], v[64:67]
    v_mfma_f32_16x16x32_bf16 v[48:51], a[224:227], a[88:91], v[48:51]
    s_waitcnt lgkmcnt(6)
    ds_read_b64_tr_b16 a[220:221], v24 offset:10272
    ds_read_b64_tr_b16 a[222:223], v24 offset:12832
    v_mfma_f32_16x16x32_bf16 v[68:71], a[224:227], a[92:95], v[68:71]
    v_mfma_f32_16x16x32_bf16 v[32:35], a[228:231], a[32:35], v[32:35]
    s_waitcnt lgkmcnt(6)
    ds_read_b64_tr_b16 a[224:225], v24 offset:15360
    ds_read_b64_tr_b16 a[226:227], v24 offset:17920
    v_mfma_f32_16x16x32_bf16 v[52:55], a[228:231], a[36:39], v[52:55]
    buffer_load_dwordx4 v25, s[20:23], s46 offen sc1 lds
    v_mfma_f32_16x16x32_bf16 v[36:39], a[232:235], a[32:35], v[36:39]
    s_waitcnt lgkmcnt(6)
    ds_read_b64_tr_b16 a[228:229], v24 offset:15368
    ds_read_b64_tr_b16 a[230:231], v24 offset:17928
    v_mfma_f32_16x16x32_bf16 v[56:59], a[232:235], a[36:39], v[56:59]
    v_mfma_f32_16x16x32_bf16 v[40:43], a[236:239], a[32:35], v[40:43]
    s_waitcnt lgkmcnt(6)
    ds_read_b64_tr_b16 a[232:233], v24 offset:15376
    ds_read_b64_tr_b16 a[234:235], v24 offset:17936
    v_mfma_f32_16x16x32_bf16 v[60:63], a[236:239], a[36:39], v[60:63]
    v_mfma_f32_16x16x32_bf16 v[44:47], a[240:243], a[32:35], v[44:47]
    s_waitcnt lgkmcnt(6)
    ds_read_b64_tr_b16 a[236:237], v24 offset:15384
    ds_read_b64_tr_b16 a[238:239], v24 offset:17944
    v_mfma_f32_16x16x32_bf16 v[64:67], a[240:243], a[36:39], v[64:67]
    s_add_u32 m0, s40, 20480
    s_nop 0
    buffer_load_dwordx4 v25, s[20:23], s47 offen sc1 lds
    v_mfma_f32_16x16x32_bf16 v[48:51], a[220:223], a[32:35], v[48:51]
    s_waitcnt lgkmcnt(6)
    ds_read_b64_tr_b16 a[240:241], v24 offset:15392
    ds_read_b64_tr_b16 a[242:243], v24 offset:17952
    v_mfma_f32_16x16x32_bf16 v[68:71], a[220:223], a[36:39], v[68:71]
    v_mfma_f32_16x16x32_bf16 v[32:35], a[224:227], a[40:43], v[32:35]
    s_waitcnt lgkmcnt(6)
    ds_read_b64_tr_b16 a[220:221], v24 offset:20480
    ds_read_b64_tr_b16 a[222:223], v24 offset:23040
    v_mfma_f32_16x16x32_bf16 v[52:55], a[224:227], a[44:47], v[52:55]
    v_mfma_f32_16x16x32_bf16 v[36:39], a[228:231], a[40:43], v[36:39]
    s_waitcnt lgkmcnt(6)
    ds_read_b64_tr_b16 a[224:225], v24 offset:20488
    ds_read_b64_tr_b16 a[226:227], v24 offset:23048
    v_mfma_f32_16x16x32_bf16 v[56:59], a[228:231], a[44:47], v[56:59]
    buffer_load_dwordx4 v25, s[20:23], s47 offen offset:1024 sc1 lds
    s_waitcnt vmcnt(11)
    s_barrier
    v_mfma_f32_16x16x32_bf16 v[40:43], a[232:235], a[40:43], v[40:43]
    s_waitcnt lgkmcnt(6)
    ds_read_b64_tr_b16 a[228:229], v24 offset:20496
    ds_read_b64_tr_b16 a[230:231], v24 offset:23056
    v_mfma_f32_16x16x32_bf16 v[60:63], a[232:235], a[44:47], v[60:63]
    v_mfma_f32_16x16x32_bf16 v[44:47], a[236:239], a[40:43], v[44:47]
    s_waitcnt lgkmcnt(6)
    ds_read_b64_tr_b16 a[232:233], v24 offset:20504
    ds_read_b64_tr_b16 a[234:235], v24 offset:23064
    v_mfma_f32_16x16x32_bf16 v[64:67], a[236:239], a[44:47], v[64:67]
    v_mfma_f32_16x16x32_bf16 v[48:51], a[240:243], a[40:43], v[48:51]
    s_waitcnt lgkmcnt(6)
    ds_read_b64_tr_b16 a[236:237], v24 offset:20512
    ds_read_b64_tr_b16 a[238:239], v24 offset:23072
    v_mfma_f32_16x16x32_bf16 v[68:71], a[240:243], a[44:47], v[68:71]
    buffer_load_dwordx4 v25, s[20:23], s47 offen offset:2048 sc1 lds
    v_mfma_f32_16x16x32_bf16 v[32:35], a[220:223], a[48:51], v[32:35]
    s_waitcnt lgkmcnt(6)
    ds_read_b64_tr_b16 a[240:241], v24 offset:25600
    ds_read_b64_tr_b16 a[242:243], v24 offset:28160
    v_mfma_f32_16x16x32_bf16 v[52:55], a[220:223], a[52:55], v[52:55]
    s_waitcnt vmcnt(10)
    v_xor_b32 v120, s8, v120
    v_xor_b32 v121, s9, v121
    v_xor_b32 v122, s10, v122
    v_xor_b32 v123, s11, v123
    v_or_b32 v114, v120, v121
    v_or3_b32 v114, v114, v122, v123
    s_waitcnt vmcnt(9)
    v_xor_b32 v124, s8, v124
    v_xor_b32 v125, s9, v125
    v_xor_b32 v126, s10, v126
    v_xor_b32 v127, s11, v127
    v_mfma_f32_16x16x32_bf16 v[36:39], a[224:227], a[48:51], v[36:39]
    s_waitcnt lgkmcnt(6)
    ds_read_b64_tr_b16 a[220:221], v24 offset:25608
    ds_read_b64_tr_b16 a[222:223], v24 offset:28168
    v_mfma_f32_16x16x32_bf16 v[56:59], a[224:227], a[52:55], v[56:59]
    v_or3_b32 v114, v114, v124, v125
    v_or3_b32 v114, v114, v126, v127
    v_add_f32 v120, v120, v124
    v_add_f32 v121, v121, v125
    v_add_f32 v122, v122, v126
    v_add_f32 v123, v123, v127
    s_waitcnt vmcnt(8)
    v_xor_b32 v128, s8, v128
    v_xor_b32 v129, s9, v129
    v_xor_b32 v130, s10, v130
    v_xor_b32 v131, s11, v131
    v_mfma_f32_16x16x32_bf16 v[40:43], a[228:231], a[48:51], v[40:43]
    s_waitcnt lgkmcnt(6)
    ds_read_b64_tr_b16 a[224:225], v24 offset:25616
    ds_read_b64_tr_b16 a[226:227], v24 offset:28176
    v_mfma_f32_16x16x32_bf16 v[60:63], a[228:231], a[52:55], v[60:63]
    buffer_load_dwordx4 v25, s[20:23], s47 offen offset:3072 sc1 lds
    s_add_u32 m0, s40, 24576
    s_add_u32 s47, s47, 4096
    v_or3_b32 v114, v114, v128, v129
    v_or3_b32 v114, v114, v130, v131
    v_add_f32 v120, v120, v128
    v_add_f32 v121, v121, v129
    v_add_f32 v122, v122, v130
    v_add_f32 v123, v123, v131
    s_waitcnt vmcnt(8)
    v_xor_b32 v132, s8, v132
    v_xor_b32 v133, s9, v133
    v_xor_b32 v134, s10, v134
    v_mfma_f32_16x16x32_bf16 v[44:47], a[232:235], a[48:51], v[44:47]
    s_waitcnt lgkmcnt(6)
    ds_read_b64_tr_b16 a[228:229], v24 offset:25624
    ds_read_b64_tr_b16 a[230:231], v24 offset:28184
    v_mfma_f32_16x16x32_bf16 v[64:67], a[232:235], a[52:55], v[64:67]
    v_xor_b32_e64 v135, s11, v135
    v_or3_b32 v114, v114, v132, v133
    v_or3_b32 v114, v114, v134, v135
    v_and_b32 v114, 0xff, v114
    v_cmp_ne_u32 vcc, 0, v114
    v_add_f32 v120, v120, v132
    v_add_f32 v121, v121, v133
    v_mfma_f32_16x16x32_bf16 v[48:51], a[236:239], a[48:51], v[48:51]
    s_waitcnt lgkmcnt(6)
    ds_read_b64_tr_b16 a[232:233], v24 offset:25632
    ds_read_b64_tr_b16 a[234:235], v24 offset:28192
    v_mfma_f32_16x16x32_bf16 v[68:71], a[236:239], a[52:55], v[68:71]
    v_add_f32 v122, v122, v134
    v_add_f32 v123, v123, v135
    s_cbranch_vccnz L_h1A_retry
L_h1A_ok:
    v_permlane32_swap_b32 v120, v122
    v_permlane32_swap_b32 v121, v123
    v_add_f32 v120, v120, v122
    v_add_f32 v121, v121, v123
    v_mfma_f32_16x16x32_bf16 v[32:35], a[240:243], a[56:59], v[32:35]
    s_waitcnt lgkmcnt(6)
    ds_read_b64_tr_b16 a[236:237], v24 offset:30720
    ds_read_b64_tr_b16 a[238:239], v24 offset:33280
    v_mfma_f32_16x16x32_bf16 v[52:55], a[240:243], a[60:63], v[52:55]
    buffer_load_dwordx4 v25, s[20:23], s47 offen sc1 lds
    v_mov_b32 v114, 0xffff
    v_permlane16_swap_b32 v120, v121
    v_add_f32 v120, v120, v121
    v_cvt_pk_bf16_f32 v120, v120, v120
    v_bfi_b32 v120, v114, v27, v120
    buffer_store_dword v120, v230, s[20:23], s70 offen sc1
    v_mfma_f32_16x16x32_bf16 v[36:39], a[220:223], a[56:59], v[36:39]
    s_waitcnt lgkmcnt(6)
    ds_read_b64_tr_b16 a[240:241], v24 offset:30728
    ds_read_b64_tr_b16 a[242:243], v24 offset:33288
    v_mfma_f32_16x16x32_bf16 v[56:59], a[220:223], a[60:63], v[56:59]
    s_add_u32 s70, s70, 262144
    buffer_store_dword v120, v230, s[20:23], s70 offen sc1
    s_add_u32 s70, s70, 262144
    buffer_store_dword v120, v230, s[20:23], s70 offen sc1
    v_mfma_f32_16x16x32_bf16 v[40:43], a[224:227], a[56:59], v[40:43]
    s_waitcnt lgkmcnt(6)
    ds_read_b64_tr_b16 a[220:221], v24 offset:30736
    ds_read_b64_tr_b16 a[222:223], v24 offset:33296
    v_mfma_f32_16x16x32_bf16 v[60:63], a[224:227], a[60:63], v[60:63]
    s_add_u32 s70, s70, 262144
    buffer_store_dword v120, v230, s[20:23], s70 offen sc1
    v_mfma_f32_16x16x32_bf16 v[44:47], a[228:231], a[56:59], v[44:47]
    s_waitcnt lgkmcnt(6)
    ds_read_b64_tr_b16 a[224:225], v24 offset:30744
    ds_read_b64_tr_b16 a[226:227], v24 offset:33304
    v_mfma_f32_16x16x32_bf16 v[64:67], a[228:231], a[60:63], v[64:67]
    s_add_u32 m0, s40, 40960
    s_nop 0
    buffer_load_dwordx4 v25, s[20:23], s48 offen sc1 lds
    v_mfma_f32_16x16x32_bf16 v[48:51], a[232:235], a[56:59], v[48:51]
    s_waitcnt lgkmcnt(6)
    ds_read_b64_tr_b16 a[228:229], v24 offset:30752
    ds_read_b64_tr_b16 a[230:231], v24 offset:33312
    v_mfma_f32_16x16x32_bf16 v[68:71], a[232:235], a[60:63], v[68:71]
    v_mfma_f32_16x16x32_bf16 v[32:35], a[236:239], a[0:3], v[32:35]
    s_waitcnt lgkmcnt(6)
    ds_read_b64_tr_b16 a[232:233], v24 offset:35840
    ds_read_b64_tr_b16 a[234:235], v24 offset:38400
    v_mfma_f32_16x16x32_bf16 v[52:55], a[236:239], a[4:7], v[52:55]
    v_mov_b32 v150, 0
    v_mov_b32 v151, 0
    v_mfma_f32_16x16x32_bf16 v[36:39], a[240:243], a[0:3], v[36:39]
    s_waitcnt lgkmcnt(6)
    ds_read_b64_tr_b16 a[236:237], v24 offset:35848
    ds_read_b64_tr_b16 a[238:239], v24 offset:38408
    v_mfma_f32_16x16x32_bf16 v[56:59], a[240:243], a[4:7], v[56:59]
    buffer_load_dwordx4 v25, s[20:23], s48 offen offset:1024 sc1 lds
    v_mfma_f32_16x16x32_bf16 v[40:43], a[220:223], a[0:3], v[40:43]
    s_waitcnt lgkmcnt(6)
    ds_read_b64_tr_b16 a[240:241], v24 offset:35856
    ds_read_b64_tr_b16 a[242:243], v24 offset:38416
    v_mfma_f32_16x16x32_bf16 v[60:63], a[220:223], a[4:7], v[60:63]
    v_mov_b32 v190, 0
    v_mov_b32 v191, 0
    v_mfma_f32_16x16x32_bf16 v[44:47], a[224:227], a[0:3], v[44:47]
    s_waitcnt lgkmcnt(6)
    ds_read_b64_tr_b16 a[220:221], v24 offset:35864
    ds_read_b64_tr_b16 a[222:223], v24 offset:38424
    v_mfma_f32_16x16x32_bf16 v[64:67], a[224:227], a[4:7], v[64:67]
    v_mfma_f32_16x16x32_bf16 v[48:51], a[228:231], a[0:3], v[48:51]
    s_waitcnt lgkmcnt(6)
    ds_read_b64_tr_b16 a[224:225], v24 offset:35872
    ds_read_b64_tr_b16 a[226:227], v24 offset:38432
    v_mfma_f32_16x16x32_bf16 v[68:71], a[228:231], a[4:7], v[68:71]
    buffer_load_dwordx4 v25, s[20:23], s48 offen offset:2048 sc1 lds
    v_mfma_f32_16x16x32_bf16 v[32:35], a[232:235], a[8:11], v[32:35]
    s_waitcnt lgkmcnt(6)
    ds_read_b64_tr_b16 a[228:229], v24 offset:40960
    ds_read_b64_tr_b16 a[230:231], v24 offset:43520
    v_mfma_f32_16x16x32_bf16 v[52:55], a[232:235], a[12:15], v[52:55]
    v_mfma_f32_16x16x32_bf16 v[36:39], a[236:239], a[8:11], v[36:39]
    s_waitcnt lgkmcnt(6)
    ds_read_b64_tr_b16 a[232:233], v24 offset:40968
    ds_read_b64_tr_b16 a[234:235], v24 offset:43528
    v_mfma_f32_16x16x32_bf16 v[56:59], a[236:239], a[12:15], v[56:59]
    v_mfma_f32_16x16x32_bf16 v[40:43], a[240:243], a[8:11], v[40:43]
    s_waitcnt lgkmcnt(6)
    ds_read_b64_tr_b16 a[236:237], v24 offset:40976
    ds_read_b64_tr_b16 a[238:239], v24 offset:43536
    v_mfma_f32_16x16x32_bf16 v[60:63], a[240:243], a[12:15], v[60:63]
L_hop4A:
    s_cbranch_execz L_hopretA
    buffer_load_dwordx4 v25, s[20:23], s48 offen offset:3072 sc1 lds
    s_add_u32 m0, s40, 45056
    s_add_u32 s48, s48, 4096
    v_mfma_f32_16x16x32_bf16 v[44:47], a[220:223], a[8:11], v[44:47]
    s_waitcnt lgkmcnt(6)
    ds_read_b64_tr_b16 a[240:241], v24 offset:40984
    ds_read_b64_tr_b16 a[242:243], v24 offset:43544
    v_mfma_f32_16x16x32_bf16 v[64:67], a[220:223], a[12:15], v[64:67]
    v_mfma_f32_16x16x32_bf16 v[48:51], a[224:227], a[8:11], v[48:51]
    s_waitcnt lgkmcnt(6)
    ds_read_b64_tr_b16 a[220:221], v24 offset:40992
    ds_read_b64_tr_b16 a[222:223], v24 offset:43552
    v_mfma_f32_16x16x32_bf16 v[68:71], a[224:227], a[12:15], v[68:71]
    v_mfma_f32_16x16x32_bf16 v[32:35], a[228:231], a[16:19], v[32:35]
    s_waitcnt lgkmcnt(6)
    ds_read_b64_tr_b16 a[224:225], v24 offset:46080
    ds_read_b64_tr_b16 a[226:227], v24 offset:48640
    v_mfma_f32_16x16x32_bf16 v[52:55], a[228:231], a[20:23], v[52:55]
    buffer_load_dwordx4 v25, s[20:23], s48 offen sc1 lds
    v_mfma_f32_16x16x32_bf16 v[36:39], a[232:235], a[16:19], v[36:39]
    s_waitcnt lgkmcnt(6)
    ds_read_b64_tr_b16 a[228:229], v24 offset:46088
    ds_read_b64_tr_b16 a[230:231], v24 offset:48648
    v_mfma_f32_16x16x32_bf16 v[56:59], a[232:235], a[20:23], v[56:59]
    v_mfma_f32_16x16x32_bf16 v[40:43], a[236:239], a[16:19], v[40:43]
    s_waitcnt lgkmcnt(6)
    ds_read_b64_tr_b16 a[232:233], v24 offset:46096
    ds_read_b64_tr_b16 a[234:235], v24 offset:48656
    v_mfma_f32_16x16x32_bf16 v[60:63], a[236:239], a[20:23], v[60:63]
    v_mfma_f32_16x16x32_bf16 v[44:47], a[240:243], a[16:19], v[44:47]
    s_waitcnt lgkmcnt(6)
    ds_read_b64_tr_b16 a[236:237], v24 offset:46104
    ds_read_b64_tr_b16 a[238:239], v24 offset:48664
    v_mfma_f32_16x16x32_bf16 v[64:67], a[240:243], a[20:23], v[64:67]
    s_add_u32 m0, s40, 112128
    s_nop 0
    buffer_load_dwordx4 v25, s[20:23], s49 offen sc1 lds
    v_mfma_f32_16x16x32_bf16 v[48:51], a[220:223], a[16:19], v[48:51]
    s_waitcnt lgkmcnt(6)
    ds_read_b64_tr_b16 a[240:241], v24 offset:46112
    ds_read_b64_tr_b16 a[242:243], v24 offset:48672
    v_mfma_f32_16x16x32_bf16 v[68:71], a[220:223], a[20:23], v[68:71]
    v_mfma_f32_16x16x32_bf16 v[32:35], a[224:227], a[24:27], v[32:35]
    s_waitcnt lgkmcnt(6)
    v_mfma_f32_16x16x32_bf16 v[52:55], a[224:227], a[28:31], v[52:55]
    v_mfma_f32_16x16x32_bf16 v[36:39], a[228:231], a[24:27], v[36:39]
    s_waitcnt lgkmcnt(4)
    v_mfma_f32_16x16x32_bf16 v[56:59], a[228:231], a[28:31], v[56:59]
    buffer_load_dwordx4 v25, s[20:23], s49 offen offset:1024 sc1 lds
    v_mfma_f32_16x16x32_bf16 v[40:43], a[232:235], a[24:27], v[40:43]
    s_waitcnt lgkmcnt(2)
    v_mfma_f32_16x16x32_bf16 v[60:63], a[232:235], a[28:31], v[60:63]
    v_cvt_pk_bf16_f32 v140, v32, v33
    v_cvt_pk_bf16_f32 v141, v34, v35
    v_mfma_f32_16x16x32_bf16 v[44:47], a[236:239], a[24:27], v[44:47]
    s_waitcnt lgkmcnt(0)
    v_cvt_pk_bf16_f32 v180, v52, v53
    v_cvt_pk_bf16_f32 v181, v54, v55
    v_mfma_f32_16x16x32_bf16 v[64:67], a[236:239], a[28:31], v[64:67]
    v_cvt_pk_bf16_f32 v142, v36, v37
    v_cvt_pk_bf16_f32 v143, v38, v39
    v_mfma_f32_16x16x32_bf16 v[48:51], a[240:243], a[24:27], v[48:51]
    v_cvt_pk_bf16_f32 v182, v56, v57
    v_cvt_pk_bf16_f32 v183, v58, v59
    v_mfma_f32_16x16x32_bf16 v[68:71], a[240:243], a[28:31], v[68:71]
    buffer_load_dwordx4 v25, s[20:23], s49 offen offset:2048 sc1 lds
    v_cvt_pk_bf16_f32 v144, v40, v41
    v_cvt_pk_bf16_f32 v145, v42, v43
    v_cvt_pk_bf16_f32 v146, v44, v45
    v_cvt_pk_bf16_f32 v147, v46, v47
    v_cvt_pk_bf16_f32 v148, v48, v49
    v_cvt_pk_bf16_f32 v149, v50, v51
    v_mfma_f32_16x16x32_bf16 v[32:35], a[160:163], v[140:143], 0
    v_cvt_pk_bf16_f32 v184, v60, v61
    v_cvt_pk_bf16_f32 v185, v62, v63
    v_mfma_f32_16x16x32_bf16 v[32:35], a[164:167], v[144:147], v[32:35]
    v_cvt_pk_bf16_f32 v186, v64, v65
    v_cvt_pk_bf16_f32 v187, v66, v67
    v_mfma_f32_16x16x32_bf16 v[32:35], a[168:171], v[148:151], v[32:35]
    v_cvt_pk_bf16_f32 v188, v68, v69
    v_cvt_pk_bf16_f32 v189, v70, v71
    v_mfma_f32_16x16x32_bf16 v[36:39], a[172:175], v[140:143], 0
    buffer_load_dwordx4 v25, s[20:23], s49 offen offset:3072 sc1 lds
    s_add_u32 m0, s40, 116224
    s_add_u32 s49, s49, 4096
    v_mfma_f32_16x16x32_bf16 v[36:39], a[176:179], v[144:147], v[36:39]
    v_mfma_f32_16x16x32_bf16 v[36:39], a[180:183], v[148:151], v[36:39]
    v_exp_f32 v112, v32
    v_mfma_f32_16x16x32_bf16 v[40:43], a[184:187], v[140:143], 0
    v_exp_f32 v113, v33
    v_mfma_f32_16x16x32_bf16 v[40:43], a[188:191], v[144:147], v[40:43]
    v_exp_f32 v114, v34
    v_mfma_f32_16x16x32_bf16 v[40:43], a[192:195], v[148:151], v[40:43]
    v_exp_f32 v115, v35
    v_mfma_f32_16x16x32_bf16 v[44:47], a[196:199], v[140:143], 0
    buffer_load_dwordx4 v25, s[20:23], s49 offen sc1 lds
    v_exp_f32 v116, v36
    v_mfma_f32_16x16x32_bf16 v[44:47], a[200:203], v[144:147], v[44:47]
    v_exp_f32 v117, v37
    v_mfma_f32_16x16x32_bf16 v[44:47], a[204:207], v[148:151], v[44:47]
    v_exp_f32 v118, v38
    v_mfma_f32_16x16x32_bf16 v[48:51], a[208:211], v[140:143], 0
    v_exp_f32 v119, v39
    v_mfma_f32_16x16x32_bf16 v[48:51], a[212:215], v[144:147], v[48:51]
    v_exp_f32 v120, v40
    v_mfma_f32_16x16x32_bf16 v[48:51], a[216:219], v[148:151], v[48:51]
    s_add_u32 m0, s40, 132608
    s_nop 0
    buffer_load_dwordx4 v25, s[20:23], s50 offen sc1 lds
    v_exp_f32 v121, v41
    v_mfma_f32_16x16x32_bf16 v[52:55], a[160:163], v[180:183], 0
    v_exp_f32 v122, v42
    v_mfma_f32_16x16x32_bf16 v[52:55], a[164:167], v[184:187], v[52:55]
    v_exp_f32 v123, v43
    v_mfma_f32_16x16x32_bf16 v[52:55], a[168:171], v[188:191], v[52:55]
    v_exp_f32 v124, v44
    v_mfma_f32_16x16x32_bf16 v[56:59], a[172:175], v[180:183], 0
    v_exp_f32 v125, v45
    v_mfma_f32_16x16x32_bf16 v[56:59], a[176:179], v[184:187], v[56:59]
    buffer_load_dwordx4 v25, s[20:23], s50 offen offset:1024 sc1 lds
    v_exp_f32 v126, v46
    v_mfma_f32_16x16x32_bf16 v[56:59], a[180:183], v[188:191], v[56:59]
    v_exp_f32 v127, v47
    v_mfma_f32_16x16x32_bf16 v[60:63], a[184:187], v[180:183], 0
    v_exp_f32 v128, v48
    v_mfma_f32_16x16x32_bf16 v[60:63], a[188:191], v[184:187], v[60:63]
    v_exp_f32 v129, v49
    v_mfma_f32_16x16x32_bf16 v[60:63], a[192:195], v[188:191], v[60:63]
    v_exp_f32 v130, v50
    v_mfma_f32_16x16x32_bf16 v[64:67], a[196:199], v[180:183], 0
    buffer_load_dwordx4 v25, s[20:23], s50 offen offset:2048 sc1 lds
    v_exp_f32 v131, v51
    v_mfma_f32_16x16x32_bf16 v[64:67], a[200:203], v[184:187], v[64:67]
    v_exp_f32 v152, v52
    v_mfma_f32_16x16x32_bf16 v[64:67], a[204:207], v[188:191], v[64:67]
    v_exp_f32 v153, v53
    v_mfma_f32_16x16x32_bf16 v[68:71], a[208:211], v[180:183], 0
    v_exp_f32 v154, v54
    v_mfma_f32_16x16x32_bf16 v[68:71], a[212:215], v[184:187], v[68:71]
    v_exp_f32 v155, v55
    v_mfma_f32_16x16x32_bf16 v[68:71], a[216:219], v[188:191], v[68:71]
    buffer_load_dwordx4 v25, s[20:23], s50 offen offset:3072 sc1 lds
    s_add_u32 m0, s40, 136704
    s_add_u32 s50, s50, 4096
    v_exp_f32 v156, v56
    v_pk_mul_f32 v[142:143], v[112:113], v[122:123]
    v_pk_mul_f32 v[144:145], v[114:115], v[124:125]
    v_pk_mul_f32 v[146:147], v[116:117], v[126:127]
    v_pk_mul_f32 v[148:149], v[118:119], v[128:129]
    v_pk_mul_f32 v[150:151], v[120:121], v[130:131]
    v_pk_add_f32 v[132:133], v[112:113], v[122:123]
    v_pk_add_f32 v[134:135], v[114:115], v[124:125]
    v_pk_add_f32 v[136:137], v[116:117], v[126:127]
    v_pk_add_f32 v[138:139], v[118:119], v[128:129]
    v_pk_add_f32 v[140:141], v[120:121], v[130:131]
    v_rcp_f32 v142, v142
    v_rcp_f32 v143, v143
    v_rcp_f32 v144, v144
    v_rcp_f32 v145, v145
    buffer_load_dwordx4 v25, s[20:23], s50 offen sc1 lds
    v_rcp_f32 v146, v146
    v_rcp_f32 v147, v147
    v_rcp_f32 v148, v148
    v_rcp_f32 v149, v149
    v_rcp_f32 v150, v150
    v_rcp_f32 v151, v151
    v_pk_add_f32 v[192:193], v[132:133], v[134:135]
    v_pk_mul_f32 v[194:195], v[132:133], v[142:143]
    v_pk_fma_f32 v[194:195], v[134:135], v[144:145], v[194:195]
    v_pk_add_f32 v[192:193], v[192:193], v[136:137]
    v_pk_fma_f32 v[194:195], v[136:137], v[146:147], v[194:195]
    v_pk_add_f32 v[192:193], v[192:193], v[138:139]
    v_pk_fma_f32 v[194:195], v[138:139], v[148:149], v[194:195]
    v_pk_add_f32 v[192:193], v[192:193], v[140:141]
    v_pk_fma_f32 v[194:195], v[140:141], v[150:151], v[194:195]
    v_add_f32 v192, v192, v193
    v_add_f32 v194, v194, v195
    v_add_f32 v193, v192, v194
    v_rcp_f32 v194, v194
    v_cmp_ngt_f32 vcc, 0x53800000, v193
    v_mul_f32_e64 v194, v194, v192
    v_pk_mul_f32 v[142:143], v[142:143], v[194:195] op_sel_hi:[1,0]
    v_pk_mul_f32 v[144:145], v[144:145], v[194:195] op_sel_hi:[1,0]
    v_pk_mul_f32 v[146:147], v[146:147], v[194:195] op_sel_hi:[1,0]
    v_pk_mul_f32 v[148:149], v[148:149], v[194:195] op_sel_hi:[1,0]
    v_pk_mul_f32 v[150:151], v[150:151], v[194:195] op_sel_hi:[1,0]
    v_pk_mul_f32 v[132:133], v[142:143], v[122:123]
    v_pk_mul_f32 v[134:135], v[144:145], v[124:125]
    buffer_load_dwordx4 v[208:211], v25, s[20:23], s71 offen offset:0 sc1
    buffer_load_dwordx4 v[212:215], v25, s[20:23], s71 offen offset:1024 sc1
    buffer_load_dwordx4 v[216:219], v25, s[20:23], s71 offen offset:2048 sc1
    buffer_load_dwordx4 v[220:223], v231, s[20:23], s71 offen offset:0 sc1
    v_pk_mul_f32 v[136:137], v[146:147], v[126:127]
    v_pk_mul_f32 v[138:139], v[148:149], v[128:129]
    v_pk_mul_f32 v[140:141], v[150:151], v[130:131]
    v_pk_mul_f32 v[142:143], v[142:143], v[112:113]
    v_pk_mul_f32 v[144:145], v[144:145], v[114:115]
    v_pk_mul_f32 v[146:147], v[146:147], v[116:117]
    v_pk_mul_f32 v[148:149], v[148:149], v[118:119]
    v_pk_mul_f32 v[150:151], v[150:151], v[120:121]
    s_cbranch_vccnz L_q0A_slow
L_q0A_back:
    s_nop 0
    v_cvt_pk_bf16_f32 v32, v112, v113
    v_cvt_pk_bf16_f32 v33, v114, v115
    v_cvt_pk_bf16_f32 v34, v116, v117
    v_cvt_pk_bf16_f32 v35, v118, v119
    v_cvt_pk_bf16_f32 v36, v120, v121
    v_cvt_pk_bf16_f32 v37, v122, v123
    v_cvt_pk_bf16_f32 v38, v124, v125
    v_cvt_pk_bf16_f32 v39, v126, v127
    v_cvt_pk_bf16_f32 v40, v128, v129
    v_cvt_pk_bf16_f32 v41, v130, v131
    v_cvt_pk_bf16_f32 v42, v132, v133
    v_cvt_pk_bf16_f32 v43, v134, v135
    s_mov_b32 exec_hi, 0xff
    buffer_load_dword v251, v253, s[28:31], s60 offen sc1
    s_mov_b64 exec, 1
    buffer_load_dword v251, v250, s[20:23], s59 offen sc1
    s_mov_b64 exec, -1
    v_cvt_pk_bf16_f32 v44, v136, v137
    v_cvt_pk_bf16_f32 v45, v138, v139
    v_cvt_pk_bf16_f32 v46, v140, v141
    v_cvt_pk_bf16_f32 v47, v142, v143
    v_cvt_pk_bf16_f32 v48, v144, v145
    v_cvt_pk_bf16_f32 v49, v146, v147
    v_cvt_pk_bf16_f32 v50, v148, v149
    v_cvt_pk_bf16_f32 v51, v150, v151
    v_exp_f32 v157, v57
    v_exp_f32 v158, v58
    v_exp_f32 v159, v59
    v_exp_f32 v160, v60
    v_exp_f32 v161, v61
    v_exp_f32 v162, v62
    v_exp_f32 v163, v63
    v_exp_f32 v164, v64
    v_exp_f32 v165, v65
    v_exp_f32 v166, v66
    v_exp_f32 v167, v67
    v_exp_f32 v168, v68
    v_exp_f32 v169, v69
    v_exp_f32 v170, v70
    v_exp_f32_e64 v171, v71
    v_pk_mul_f32 v[182:183], v[152:153], v[162:163]
    v_pk_mul_f32 v[184:185], v[154:155], v[164:165]
    v_pk_mul_f32 v[186:187], v[156:157], v[166:167]
    v_pk_mul_f32 v[188:189], v[158:159], v[168:169]
    v_pk_mul_f32 v[190:191], v[160:161], v[170:171]
    v_pk_add_f32 v[172:173], v[152:153], v[162:163]
    v_pk_add_f32 v[174:175], v[154:155], v[164:165]
    v_pk_add_f32 v[176:177], v[156:157], v[166:167]
    v_pk_add_f32 v[178:179], v[158:159], v[168:169]
    v_pk_add_f32 v[180:181], v[160:161], v[170:171]
    v_rcp_f32 v182, v182
    v_rcp_f32 v183, v183
    v_rcp_f32 v184, v184
    v_rcp_f32 v185, v185
    v_rcp_f32 v186, v186
    v_rcp_f32 v187, v187
    v_rcp_f32 v188, v188
    v_rcp_f32 v189, v189
    v_rcp_f32 v190, v190
    v_rcp_f32 v191, v191
    v_pk_add_f32 v[198:199], v[172:173], v[174:175]
    v_pk_mul_f32 v[200:201], v[172:173], v[182:183]
    v_pk_fma_f32 v[200:201], v[174:175], v[184:185], v[200:201]
    v_pk_add_f32 v[198:199], v[198:199], v[176:177]
    v_pk_fma_f32 v[200:201], v[176:177], v[186:187], v[200:201]
    v_pk_add_f32 v[198:199], v[198:199], v[178:179]
    v_pk_fma_f32 v[200:201], v[178:179], v[188:189], v[200:201]
    v_pk_add_f32 v[198:199], v[198:199], v[180:181]
    v_pk_fma_f32 v[200:201], v[180:181], v[190:191], v[200:201]
    v_add_f32 v198, v198, v199
    v_add_f32 v200, v200, v201
    v_add_f32 v199, v198, v200
    v_rcp_f32 v200, v200
    v_cmp_ngt_f32 vcc, 0x53800000, v199
    v_mul_f32_e64 v200, v200, v198
    v_pk_mul_f32 v[182:183], v[182:183], v[200:201] op_sel_hi:[1,0]
    v_pk_mul_f32 v[184:185], v[184:185], v[200:201] op_sel_hi:[1,0]
    v_pk_mul_f32 v[186:187], v[186:187], v[200:201] op_sel_hi:[1,0]
    v_pk_mul_f32 v[188:189], v[188:189], v[200:201] op_sel_hi:[1,0]
    v_pk_mul_f32 v[190:191], v[190:191], v[200:201] op_sel_hi:[1,0]
    v_pk_mul_f32 v[172:173], v[182:183], v[162:163]
    v_pk_mul_f32 v[174:175], v[184:185], v[164:165]
    v_pk_mul_f32 v[176:177], v[186:187], v[166:167]
    v_pk_mul_f32 v[178:179], v[188:189], v[168:169]
    v_pk_mul_f32 v[180:181], v[190:191], v[170:171]
    v_pk_mul_f32 v[182:183], v[182:183], v[152:153]
    v_pk_mul_f32 v[184:185], v[184:185], v[154:155]
    v_pk_mul_f32 v[186:187], v[186:187], v[156:157]
    v_pk_mul_f32 v[188:189], v[188:189], v[158:159]
    v_pk_mul_f32 v[190:191], v[190:191], v[160:161]
    s_cbranch_vccnz L_q1A_slow
L_q1A_back:
    s_nop 0
    v_cvt_pk_bf16_f32 v52, v152, v153
    v_cvt_pk_bf16_f32 v53, v154, v155
    v_cvt_pk_bf16_f32 v54, v156, v157
    v_cvt_pk_bf16_f32 v55, v158, v159
    v_cvt_pk_bf16_f32 v56, v160, v161
    v_cvt_pk_bf16_f32 v57, v162, v163
    v_cvt_pk_bf16_f32 v58, v164, v165
    v_cvt_pk_bf16_f32 v59, v166, v167
    v_cvt_pk_bf16_f32 v60, v168, v169
    v_cvt_pk_bf16_f32 v61, v170, v171
    v_cvt_pk_bf16_f32 v62, v172, v173
    v_cvt_pk_bf16_f32 v63, v174, v175
    v_cvt_pk_bf16_f32 v64, v176, v177
    v_cvt_pk_bf16_f32 v65, v178, v179
    v_cvt_pk_bf16_f32 v66, v180, v181
    v_cvt_pk_bf16_f32 v67, v182, v183
    v_cvt_pk_bf16_f32 v68, v184, v185
    v_cvt_pk_bf16_f32 v69, v186, v187
    v_cvt_pk_bf16_f32 v70, v188, v189
    v_cvt_pk_bf16_f32 v71, v190, v191
    s_waitcnt vmcnt(2)
    v_perm_b32 v120, v209, v208, s75
    v_perm_b32 v121, v211, v210, s75
    ds_write_b64 v232, v[120:121]
    v_perm_b32 v122, v213, v212, s75
    v_perm_b32 v123, v215, v214, s75
    ds_write_b64 v233, v[122:123]
    v_perm_b32 v124, v217, v216, s75
    v_perm_b32 v125, v219, v218, s75
    ds_write_b64 v234, v[124:125]
    v_perm_b32 v126, v221, v220, s75
    v_perm_b32 v127, v223, v222, s75
    ds_write_b64 v235, v[126:127]
    v_xor_b32 v204, s32, v208
    v_bitop3_b32 v204, v204, v209, s38 bitop3:0xf6
    v_bitop3_b32 v204, v204, v210, s32 bitop3:0xf6
    v_bitop3_b32 v204, v204, v211, s38 bitop3:0xf6
    v_bitop3_b32 v204, v204, v212, s32 bitop3:0xf6
    v_bitop3_b32 v204, v204, v213, s38 bitop3:0xf6
    v_bitop3_b32 v204, v204, v214, s32 bitop3:0xf6
    v_bitop3_b32 v204, v204, v215, s38 bitop3:0xf6
    v_bitop3_b32 v204, v204, v216, s32 bitop3:0xf6
    v_bitop3_b32 v204, v204, v217, s38 bitop3:0xf6
    v_bitop3_b32 v204, v204, v218, s32 bitop3:0xf6
    v_bitop3_b32 v204, v204, v219, s38 bitop3:0xf6
    v_bitop3_b32 v204, v204, v220, s32 bitop3:0xf6
    v_bitop3_b32 v204, v204, v221, s38 bitop3:0xf6
    v_bitop3_b32 v204, v204, v222, s32 bitop3:0xf6
    v_bitop3_b32 v204, v204, v223, s38 bitop3:0xf6
    v_and_b32 v204, 0xffff, v204
    v_cmp_ne_u32 vcc, 0, v204
    s_nop 3
    s_cbranch_vccnz L_h2A_retry
L_h2A_ok:
    s_cmp_eq_u32 s53, 0
    s_waitcnt lgkmcnt(0)
    s_barrier
    s_cbranch_scc0 L_tailAs
    ds_read_b128 a[40:43], v236 offset:1600
    ds_read_b128 a[44:47], v236 offset:1616
    ds_read_b128 a[48:51], v236 offset:1632
    ds_read_b128 a[52:55], v236 offset:1648
    ds_read_b128 a[56:59], v236 offset:1664
    ds_read_b128 a[60:63], v236 offset:0
    ds_read_b128 a[64:67], v236 offset:16
    ds_read_b128 a[68:71], v236 offset:32
    ds_read_b128 a[72:75], v236 offset:48
    ds_read_b128 a[76:79], v236 offset:64
    v_mov_b32 v224, v192
    v_mov_b32 v225, v198
    s_waitcnt lgkmcnt(9)
    v_mfma_f32_16x16x32_bf16 v[92:95], a[40:43], v[32:35], 0
    s_waitcnt lgkmcnt(8)
    ds_read_b128 a[80:83], v236 offset:320
    v_mfma_f32_16x16x32_bf16 v[92:95], a[44:47], v[36:39], v[92:95]
    s_waitcnt lgkmcnt(8)
    ds_read_b128 a[84:87], v236 offset:336
    v_mfma_f32_16x16x32_bf16 v[92:95], a[48:51], v[40:43], v[92:95]
    s_waitcnt lgkmcnt(8)
    ds_read_b128 a[88:91], v236 offset:352
    v_mfma_f32_16x16x32_bf16 v[92:95], a[52:55], v[44:47], v[92:95]
    s_waitcnt lgkmcnt(8)
    ds_read_b128 a[92:95], v236 offset:368
    v_mfma_f32_16x16x32_bf16 v[92:95], a[56:59], v[48:51], v[92:95]
    s_waitcnt lgkmcnt(8)
    ds_read_b128 a[96:99], v236 offset:384
    v_mfma_f32_16x16x32_bf16 v[72:75], a[60:63], v[32:35], 0
    s_waitcnt lgkmcnt(8)
    ds_read_b128 a[100:103], v236 offset:640
    v_mfma_f32_16x16x32_bf16 v[72:75], a[64:67], v[36:39], v[72:75]
    s_waitcnt lgkmcnt(8)
    ds_read_b128 a[104:107], v236 offset:656
    v_mfma_f32_16x16x32_bf16 v[72:75], a[68:71], v[40:43], v[72:75]
    s_waitcnt lgkmcnt(8)
    ds_read_b128 a[108:111], v236 offset:672
    v_mfma_f32_16x16x32_bf16 v[72:75], a[72:75], v[44:47], v[72:75]
    s_waitcnt lgkmcnt(8)
    ds_read_b128 a[112:115], v236 offset:688
    v_fmac_f32 v92, 0x358637bd, v224
    v_mfma_f32_16x16x32_bf16 v[72:75], a[76:79], v[48:51], v[72:75]
    s_waitcnt lgkmcnt(8)
    ds_read_b128 a[116:119], v236 offset:704
    v_rcp_f32 v92, v92
    v_mfma_f32_16x16x32_bf16 v[76:79], a[80:83], v[32:35], 0
    s_waitcnt lgkmcnt(8)
    ds_read_b128 a[120:123], v236 offset:960
    v_mfma_f32_16x16x32_bf16 v[76:79], a[84:87], v[36:39], v[76:79]
    s_waitcnt lgkmcnt(8)
    ds_read_b128 a[124:127], v236 offset:976
    v_mfma_f32_16x16x32_bf16 v[76:79], a[88:91], v[40:43], v[76:79]
    s_waitcnt lgkmcnt(8)
    ds_read_b128 a[128:131], v236 offset:992
    v_mfma_f32_16x16x32_bf16 v[76:79], a[92:95], v[44:47], v[76:79]
    s_waitcnt lgkmcnt(8)
    ds_read_b128 a[132:135], v236 offset:1008
    v_mul_f32 v72, v72, v92
    v_mfma_f32_16x16x32_bf16 v[76:79], a[96:99], v[48:51], v[76:79]
    s_waitcnt lgkmcnt(8)
    ds_read_b128 a[136:139], v236 offset:1024
    v_mul_f32 v73, v73, v92
    v_mfma_f32_16x16x32_bf16 v[80:83], a[100:103], v[32:35], 0
    s_waitcnt lgkmcnt(8)
    ds_read_b128 a[140:143], v236 offset:1280
    v_mul_f32 v74, v74, v92
    v_mfma_f32_16x16x32_bf16 v[80:83], a[104:107], v[36:39], v[80:83]
    s_waitcnt lgkmcnt(8)
    ds_read_b128 a[144:147], v236 offset:1296
    v_mul_f32 v75, v75, v92
    v_mfma_f32_16x16x32_bf16 v[80:83], a[108:111], v[40:43], v[80:83]
    s_waitcnt lgkmcnt(8)
    ds_read_b128 a[148:151], v236 offset:1312
    v_cvt_pk_bf16_f32 v176, v72, v73
    v_mfma_f32_16x16x32_bf16 v[80:83], a[112:115], v[44:47], v[80:83]
    s_waitcnt lgkmcnt(8)
    ds_read_b128 a[152:155], v236 offset:1328
    v_cvt_pk_bf16_f32 v177, v74, v75
    v_mfma_f32_16x16x32_bf16 v[80:83], a[116:119], v[48:51], v[80:83]
    s_waitcnt lgkmcnt(8)
    ds_read_b128 a[156:159], v236 offset:1344
    v_mul_f32 v76, v76, v92
    v_mfma_f32_16x16x32_bf16 v[84:87], a[120:123], v[32:35], 0
    s_waitcnt lgkmcnt(8)
    v_mul_f32 v77, v77, v92
    v_mul_f32 v78, v78, v92
    v_mfma_f32_16x16x32_bf16 v[84:87], a[124:127], v[36:39], v[84:87]
    s_waitcnt lgkmcnt(7)
    v_mul_f32 v79, v79, v92
    v_cvt_pk_bf16_f32 v178, v76, v77
    v_mfma_f32_16x16x32_bf16 v[84:87], a[128:131], v[40:43], v[84:87]
    s_waitcnt lgkmcnt(6)
    v_cvt_pk_bf16_f32 v179, v78, v79
    v_mfma_f32_16x16x32_bf16 v[84:87], a[132:135], v[44:47], v[84:87]
    s_waitcnt lgkmcnt(5)
    buffer_store_dwordx4 v[176:179], v7, s[28:31], s60 offen
    v_mfma_f32_16x16x32_bf16 v[84:87], a[136:139], v[48:51], v[84:87]
    s_waitcnt lgkmcnt(4)
    v_mul_f32 v80, v80, v92
    v_mul_f32 v81, v81, v92
    v_mfma_f32_16x16x32_bf16 v[116:119], a[40:43], v[52:55], 0
    v_mul_f32 v82, v82, v92
    v_mul_f32 v83, v83, v92
    v_mfma_f32_16x16x32_bf16 v[116:119], a[44:47], v[56:59], v[116:119]
    v_cvt_pk_bf16_f32 v184, v80, v81
    v_cvt_pk_bf16_f32 v185, v82, v83
    v_mfma_f32_16x16x32_bf16 v[116:119], a[48:51], v[60:63], v[116:119]
    ds_read_b128 v[148:151], v25 offset:0
    v_mfma_f32_16x16x32_bf16 v[116:119], a[52:55], v[64:67], v[116:119]
    v_mul_f32 v84, v84, v92
    v_mul_f32 v85, v85, v92
    v_mfma_f32_16x16x32_bf16 v[116:119], a[56:59], v[68:71], v[116:119]
    v_mul_f32 v86, v86, v92
    v_mul_f32 v87, v87, v92
    v_mfma_f32_16x16x32_bf16 v[96:99], a[60:63], v[52:55], 0
    v_cvt_pk_bf16_f32 v186, v84, v85
    v_cvt_pk_bf16_f32 v187, v86, v87
    v_mfma_f32_16x16x32_bf16 v[96:99], a[64:67], v[56:59], v[96:99]
    buffer_store_dwordx4 v[184:187], v8, s[28:31], s60 offen
    v_mfma_f32_16x16x32_bf16 v[96:99], a[68:71], v[60:63], v[96:99]
    ds_read_b128 v[152:155], v25 offset:1024
    v_mfma_f32_16x16x32_bf16 v[96:99], a[72:75], v[64:67], v[96:99]
    v_fmac_f32 v116, 0x358637bd, v225
    v_mfma_f32_16x16x32_bf16 v[96:99], a[76:79], v[68:71], v[96:99]
    v_rcp_f32 v116, v116
    v_mfma_f32_16x16x32_bf16 v[100:103], a[80:83], v[52:55], 0
    ds_read_b128 v[156:159], v25 offset:2048
    v_mfma_f32_16x16x32_bf16 v[100:103], a[84:87], v[56:59], v[100:103]
    ds_read_b128 v[160:163], v25 offset:3072
    v_mfma_f32_16x16x32_bf16 v[100:103], a[88:91], v[60:63], v[100:103]
    ds_read_b128 v[164:167], v25 offset:4096
    v_mfma_f32_16x16x32_bf16 v[100:103], a[92:95], v[64:67], v[100:103]
    v_mul_f32 v96, v96, v116
    v_mul_f32 v97, v97, v116
    v_mfma_f32_16x16x32_bf16 v[100:103], a[96:99], v[68:71], v[100:103]
    v_mul_f32 v98, v98, v116
    v_mul_f32 v99, v99, v116
    v_mfma_f32_16x16x32_bf16 v[104:107], a[100:103], v[52:55], 0
    v_cvt_pk_bf16_f32 v180, v96, v97
    v_cvt_pk_bf16_f32 v181, v98, v99
    v_mfma_f32_16x16x32_bf16 v[104:107], a[104:107], v[56:59], v[104:107]
    ds_read_b128 v[168:171], v25 offset:5120
    v_mfma_f32_16x16x32_bf16 v[104:107], a[108:111], v[60:63], v[104:107]
    v_mfma_f32_16x16x32_bf16 v[104:107], a[112:115], v[64:67], v[104:107]
    v_mul_f32 v100, v100, v116
    v_mul_f32 v101, v101, v116
    v_mfma_f32_16x16x32_bf16 v[104:107], a[116:119], v[68:71], v[104:107]
    v_mul_f32 v102, v102, v116
    v_mul_f32 v103, v103, v116
    v_mfma_f32_16x16x32_bf16 v[108:111], a[120:123], v[52:55], 0
    v_cvt_pk_bf16_f32 v182, v100, v101
    v_cvt_pk_bf16_f32 v183, v102, v103
    v_mfma_f32_16x16x32_bf16 v[108:111], a[124:127], v[56:59], v[108:111]
    buffer_store_dwordx4 v[180:183], v9, s[28:31], s60 offen
    v_mfma_f32_16x16x32_bf16 v[108:111], a[128:131], v[60:63], v[108:111]
    v_mfma_f32_16x16x32_bf16 v[108:111], a[132:135], v[64:67], v[108:111]
    v_mul_f32 v104, v104, v116
    v_mul_f32 v105, v105, v116
    v_mfma_f32_16x16x32_bf16 v[108:111], a[136:139], v[68:71], v[108:111]
    v_mul_f32 v106, v106, v116
    v_mul_f32 v107, v107, v116
    v_mfma_f32_16x16x32_bf16 v[88:91], a[140:143], v[32:35], 0
    s_waitcnt lgkmcnt(9)
    v_cvt_pk_bf16_f32 v188, v104, v105
    v_cvt_pk_bf16_f32 v189, v106, v107
    v_mfma_f32_16x16x32_bf16 v[88:91], a[144:147], v[36:39], v[88:91]
    s_waitcnt lgkmcnt(8)
    v_mfma_f32_16x16x32_bf16 v[88:91], a[148:151], v[40:43], v[88:91]
    s_waitcnt lgkmcnt(7)
    v_mfma_f32_16x16x32_bf16 v[88:91], a[152:155], v[44:47], v[88:91]
    s_waitcnt lgkmcnt(6)
    s_waitcnt vmcnt(1)
    buffer_store_dword v254, v255, s[20:23], s59 offen offset:0
    v_mfma_f32_16x16x32_bf16 v[88:91], a[156:159], v[48:51], v[88:91]
    v_mul_f32 v108, v108, v116
    v_mul_f32 v109, v109, v116
    v_mfma_f32_16x16x32_bf16 v[112:115], a[140:143], v[52:55], 0
    v_mul_f32 v110, v110, v116
    v_mul_f32 v111, v111, v116
    v_mfma_f32_16x16x32_bf16 v[112:115], a[144:147], v[56:59], v[112:115]
    v_cvt_pk_bf16_f32 v190, v108, v109
    v_cvt_pk_bf16_f32 v191, v110, v111
    v_mfma_f32_16x16x32_bf16 v[112:115], a[148:151], v[60:63], v[112:115]
    buffer_store_dwordx4 v[188:191], v10, s[28:31], s60 offen
    v_mfma_f32_16x16x32_bf16 v[112:115], a[152:155], v[64:67], v[112:115]
    v_mul_f32 v88, v88, v92
    v_mul_f32 v89, v89, v92
    v_mfma_f32_16x16x32_bf16 v[112:115], a[156:159], v[68:71], v[112:115]
    v_mul_f32 v90, v90, v92
    v_mul_f32 v91, v91, v92
    v_cvt_pk_bf16_f32 v192, v88, v89
    v_cvt_pk_bf16_f32 v193, v90, v91
    s_waitcnt lgkmcnt(5)
    v_mfma_f32_16x16x32_bf16 v[32:35], v[148:151], v[176:179], 0
    s_waitcnt lgkmcnt(4)
    ds_read_b128 v[172:175], v25 offset:6144
    v_mfma_f32_16x16x32_bf16 v[52:55], v[148:151], v[180:183], 0
    v_mfma_f32_16x16x32_bf16 v[36:39], v[152:155], v[176:179], 0
    s_waitcnt lgkmcnt(4)
    ds_read_b128 v[148:151], v25 offset:7168
    v_mfma_f32_16x16x32_bf16 v[56:59], v[152:155], v[180:183], 0
    v_mul_f32 v112, v112, v116
    v_mul_f32 v113, v113, v116
    v_mul_f32 v114, v114, v116
    v_mfma_f32_16x16x32_bf16 v[40:43], v[156:159], v[176:179], 0
    s_waitcnt lgkmcnt(4)
    ds_read_b128 v[152:155], v25 offset:8192
    v_mfma_f32_16x16x32_bf16 v[60:63], v[156:159], v[180:183], 0
    v_mul_f32 v115, v115, v116
    v_cvt_pk_bf16_f32 v194, v112, v113
    v_cvt_pk_bf16_f32 v195, v114, v115
    v_mfma_f32_16x16x32_bf16 v[44:47], v[160:163], v[176:179], 0
    s_waitcnt lgkmcnt(4)
    ds_read_b128 v[156:159], v25 offset:9216
    v_mfma_f32_16x16x32_bf16 v[64:67], v[160:163], v[180:183], 0
    buffer_store_dwordx4 v[192:195], v11, s[28:31], s60 offen
    v_mfma_f32_16x16x32_bf16 v[48:51], v[164:167], v[176:179], 0
    s_waitcnt lgkmcnt(4)
    ds_read_b128 a[128:131], v25 offset:10240
    v_mfma_f32_16x16x32_bf16 v[68:71], v[164:167], v[180:183], 0
    buffer_load_dword v251, v250, s[20:23], s59 offen offset:0 sc1
    v_mfma_f32_16x16x32_bf16 v[32:35], v[168:171], v[184:187], v[32:35]
    s_waitcnt lgkmcnt(4)
    ds_read_b128 a[132:135], v25 offset:11264
    ds_read_b128 a[136:139], v25 offset:12288
    v_mfma_f32_16x16x32_bf16 v[52:55], v[168:171], v[188:191], v[52:55]
    v_mfma_f32_16x16x32_bf16 v[36:39], v[172:175], v[184:187], v[36:39]
    s_waitcnt lgkmcnt(5)
    ds_read_b128 a[140:143], v25 offset:13312
    ds_read_b128 a[144:147], v25 offset:14336
    v_mfma_f32_16x16x32_bf16 v[56:59], v[172:175], v[188:191], v[56:59]
    v_mfma_f32_16x16x32_bf16 v[40:43], v[148:151], v[184:187], v[40:43]
    s_waitcnt lgkmcnt(6)
    ds_read_b128 a[148:151], v25 offset:15360
    ds_read_b128 a[152:155], v25 offset:16384
    v_mfma_f32_16x16x32_bf16 v[60:63], v[148:151], v[188:191], v[60:63]
    v_mfma_f32_16x16x32_bf16 v[44:47], v[152:155], v[184:187], v[44:47]
    s_waitcnt lgkmcnt(7)
    ds_read_b128 a[156:159], v25 offset:17408
    ds_read_b128 a[160:163], v25 offset:18432
    v_mfma_f32_16x16x32_bf16 v[64:67], v[152:155], v[188:191], v[64:67]
    v_mfma_f32_16x16x32_bf16 v[48:51], v[156:159], v[184:187], v[48:51]
    s_waitcnt lgkmcnt(8)
    ds_read_b128 a[164:167], v25 offset:19456
    ds_read_b128 a[168:171], v25 offset:20480
    v_mfma_f32_16x16x32_bf16 v[68:71], v[156:159], v[188:191], v[68:71]
    s_waitcnt lgkmcnt(0)
    ds_read_b128 a[172:175], v25 offset:21504
    ds_read_b128 a[176:179], v25 offset:22528
    ds_read_b128 a[180:183], v25 offset:23552
    ds_read_b128 a[184:187], v25 offset:24576
    ds_read_b128 a[188:191], v25 offset:25600
    ds_read_b128 a[192:195], v25 offset:26624
    ds_read_b128 a[196:199], v25 offset:27648
    ds_read_b128 a[200:203], v25 offset:28672
    ds_read_b128 a[204:207], v25 offset:29696
L_hop5A:
    s_cbranch_execz L_hopretA
    ds_read_b128 a[208:211], v25 offset:30720
    ds_read_b128 a[212:215], v25 offset:31744
    ds_read_b128 a[216:219], v25 offset:32768
    ds_read_b128 a[220:223], v25 offset:33792
    ds_read_b128 a[224:227], v25 offset:34816
    s_waitcnt vmcnt(1)
    buffer_store_dword v254, v255, s[20:23], s59 offen offset:32
    s_waitcnt vmcnt(1)
    v_cmp_ne_u32 vcc, s32, v251
    s_nop 3
    s_cbranch_vccnz L_f0A_retry
L_f0A_ok:
    buffer_load_dwordx4 a[16:19], v7, s[28:31], s61 offen sc1
    buffer_load_dwordx4 a[24:27], v8, s[28:31], s61 offen sc1
    buffer_load_dwordx4 a[32:35], v7, s[28:31], s62 offen sc1
    buffer_load_dwordx4 a[40:43], v8, s[28:31], s62 offen sc1
    buffer_load_dword v251, v250, s[20:23], s59 offen offset:32 sc1
    buffer_load_dwordx4 a[48:51], v7, s[28:31], s63 offen sc1
    buffer_load_dwordx4 a[56:59], v8, s[28:31], s63 offen sc1
    buffer_load_dwordx4 a[64:67], v7, s[28:31], s64 offen sc1
    s_waitcnt lgkmcnt(0)
    ds_read_b128 a[228:231], v25 offset:35840
    ds_read_b128 a[232:235], v25 offset:36864
    ds_read_b128 a[236:239], v25 offset:37888
    ds_read_b128 a[240:243], v25 offset:38912
    ds_read_b128 a[244:247], v25 offset:39936
    ds_read_b128 a[248:251], v25 offset:40960
    ds_read_b128 a[252:255], v25 offset:41984
    ds_read_b128 v[72:75], v25 offset:43008
    ds_read_b128 v[76:79], v25 offset:44032
    ds_read_b128 v[80:83], v25 offset:45056
    ds_read_b128 v[84:87], v25 offset:46080
    ds_read_b128 v[88:91], v25 offset:47104
    ds_read_b128 v[92:95], v25 offset:48128
    ds_read_b128 v[96:99], v25 offset:49152
    s_waitcnt vmcnt(7)
    v_mfma_f32_16x16x32_bf16 v[32:35], a[128:131], a[16:19], v[32:35]
    v_mfma_f32_16x16x32_bf16 v[36:39], a[132:135], a[16:19], v[36:39]
    v_mfma_f32_16x16x32_bf16 v[40:43], a[136:139], a[16:19], v[40:43]
    v_mfma_f32_16x16x32_bf16 v[44:47], a[140:143], a[16:19], v[44:47]
    v_mfma_f32_16x16x32_bf16 v[48:51], a[144:147], a[16:19], v[48:51]
    s_waitcnt vmcnt(6)
    buffer_load_dwordx4 a[72:75], v8, s[28:31], s64 offen sc1
    v_mfma_f32_16x16x32_bf16 v[32:35], a[148:151], a[24:27], v[32:35]
    s_waitcnt vmcnt(4)
    v_cmp_ne_u32 vcc, s32, v251
    v_mfma_f32_16x16x32_bf16 v[36:39], a[152:155], a[24:27], v[36:39]
    v_mfma_f32_16x16x32_bf16 v[40:43], a[156:159], a[24:27], v[40:43]
    s_nop 1
    s_cbranch_vccnz L_f1A_retry
L_f1A_ok:
    v_mfma_f32_16x16x32_bf16 v[44:47], a[160:163], a[24:27], v[44:47]
    v_mfma_f32_16x16x32_bf16 v[48:51], a[164:167], a[24:27], v[48:51]
    buffer_load_dwordx4 a[80:83], v7, s[28:31], s65 offen sc1
    v_mfma_f32_16x16x32_bf16 v[32:35], a[168:171], a[32:35], v[32:35]
    v_mfma_f32_16x16x32_bf16 v[36:39], a[172:175], a[32:35], v[36:39]
    v_mfma_f32_16x16x32_bf16 v[40:43], a[176:179], a[32:35], v[40:43]
    v_mfma_f32_16x16x32_bf16 v[44:47], a[180:183], a[32:35], v[44:47]
    buffer_load_dwordx4 a[84:87], v9, s[28:31], s65 offen sc1
    v_mfma_f32_16x16x32_bf16 v[48:51], a[184:187], a[32:35], v[48:51]
    v_mfma_f32_16x16x32_bf16 v[32:35], a[188:191], a[40:43], v[32:35]
    v_mfma_f32_16x16x32_bf16 v[36:39], a[192:195], a[40:43], v[36:39]
    v_mfma_f32_16x16x32_bf16 v[40:43], a[196:199], a[40:43], v[40:43]
    v_mfma_f32_16x16x32_bf16 v[44:47], a[200:203], a[40:43], v[44:47]
    buffer_load_dwordx4 a[88:91], v8, s[28:31], s65 offen sc1
    v_mfma_f32_16x16x32_bf16 v[48:51], a[204:207], a[40:43], v[48:51]
    s_waitcnt vmcnt(6)
    v_mfma_f32_16x16x32_bf16 v[32:35], a[208:211], a[48:51], v[32:35]
    v_mfma_f32_16x16x32_bf16 v[36:39], a[212:215], a[48:51], v[36:39]
    v_mfma_f32_16x16x32_bf16 v[40:43], a[216:219], a[48:51], v[40:43]
    buffer_load_dwordx4 a[92:95], v10, s[28:31], s65 offen sc1
    v_mfma_f32_16x16x32_bf16 v[44:47], a[220:223], a[48:51], v[44:47]
    v_mfma_f32_16x16x32_bf16 v[48:51], a[224:227], a[48:51], v[48:51]
    s_waitcnt vmcnt(6) lgkmcnt(13)
    v_mfma_f32_16x16x32_bf16 v[32:35], a[228:231], a[56:59], v[32:35]
    s_waitcnt lgkmcnt(12)
    v_mfma_f32_16x16x32_bf16 v[36:39], a[232:235], a[56:59], v[36:39]
    s_waitcnt lgkmcnt(11)
    v_mfma_f32_16x16x32_bf16 v[40:43], a[236:239], a[56:59], v[40:43]
    s_waitcnt lgkmcnt(10)
    ds_read_b128 v[100:103], v25 offset:50176
    buffer_load_dwordx4 a[96:99], v7, s[28:31], s66 offen sc1
    v_mfma_f32_16x16x32_bf16 v[44:47], a[240:243], a[56:59], v[44:47]
    s_waitcnt lgkmcnt(10)
    ds_read_b128 v[160:163], v12 offset:0
    v_mfma_f32_16x16x32_bf16 v[48:51], a[244:247], a[56:59], v[48:51]
    s_waitcnt vmcnt(6) lgkmcnt(10)
    v_mfma_f32_16x16x32_bf16 v[32:35], a[248:251], a[64:67], v[32:35]
    s_waitcnt lgkmcnt(9)
    ds_read_b128 v[164:167], v12 offset:1024
    v_mfma_f32_16x16x32_bf16 v[36:39], a[252:255], a[64:67], v[36:39]
    s_waitcnt lgkmcnt(9)
    v_mfma_f32_16x16x32_bf16 v[40:43], v[72:75], a[64:67], v[40:43]
    s_waitcnt lgkmcnt(8)
    ds_read_b128 v[168:171], v12 offset:2048
    buffer_load_dwordx4 a[100:103], v9, s[28:31], s66 offen sc1
    v_mfma_f32_16x16x32_bf16 v[44:47], v[76:79], a[64:67], v[44:47]
    s_waitcnt lgkmcnt(8)
    v_mfma_f32_16x16x32_bf16 v[48:51], v[80:83], a[64:67], v[48:51]
    s_waitcnt vmcnt(6) lgkmcnt(7)
    ds_read_b128 v[172:175], v12 offset:3072
    v_mfma_f32_16x16x32_bf16 v[32:35], v[84:87], a[72:75], v[32:35]
    s_waitcnt lgkmcnt(7)
    v_mfma_f32_16x16x32_bf16 v[36:39], v[88:91], a[72:75], v[36:39]
    s_waitcnt lgkmcnt(6)
    ds_read_b128 v[148:151], v12 offset:4096
    buffer_load_dwordx4 a[104:107], v8, s[28:31], s66 offen sc1
    v_mfma_f32_16x16x32_bf16 v[40:43], v[92:95], a[72:75], v[40:43]
    s_waitcnt lgkmcnt(6)
    v_mfma_f32_16x16x32_bf16 v[44:47], v[96:99], a[72:75], v[44:47]
    s_waitcnt lgkmcnt(5)
    ds_read_b128 v[152:155], v12 offset:5120
    v_mfma_f32_16x16x32_bf16 v[48:51], v[100:103], a[72:75], v[48:51]
    s_waitcnt vmcnt(5) lgkmcnt(5)
    v_mfma_f32_16x16x32_bf16 v[32:35], v[160:163], a[80:83], v[32:35]
    s_waitcnt lgkmcnt(4)
    ds_read_b128 v[156:159], v12 offset:6144
    v_mfma_f32_16x16x32_bf16 v[52:55], v[160:163], a[84:87], v[52:55]
    buffer_load_dwordx4 a[108:111], v10, s[28:31], s66 offen sc1
    v_mfma_f32_16x16x32_bf16 v[36:39], v[164:167], a[80:83], v[36:39]
    s_waitcnt lgkmcnt(4)
    ds_read_b128 v[160:163], v12 offset:7168
    v_mfma_f32_16x16x32_bf16 v[56:59], v[164:167], a[84:87], v[56:59]
    v_mfma_f32_16x16x32_bf16 v[40:43], v[168:171], a[80:83], v[40:43]
    s_waitcnt lgkmcnt(4)
    ds_read_b128 v[164:167], v12 offset:8192
    v_mfma_f32_16x16x32_bf16 v[60:63], v[168:171], a[84:87], v[60:63]
    buffer_load_dwordx4 a[112:115], v7, s[28:31], s67 offen sc1
    v_mfma_f32_16x16x32_bf16 v[44:47], v[172:175], a[80:83], v[44:47]
    s_waitcnt lgkmcnt(4)
    ds_read_b128 v[168:171], v12 offset:9216
    v_mfma_f32_16x16x32_bf16 v[64:67], v[172:175], a[84:87], v[64:67]
    v_mfma_f32_16x16x32_bf16 v[48:51], v[148:151], a[80:83], v[48:51]
    s_waitcnt vmcnt(5) lgkmcnt(4)
    ds_read_b128 v[172:175], v226 offset:0
    v_mfma_f32_16x16x32_bf16 v[68:71], v[148:151], a[84:87], v[68:71]
    v_mfma_f32_16x16x32_bf16 v[32:35], v[152:155], a[88:91], v[32:35]
    s_waitcnt lgkmcnt(4)
    ds_read_b128 v[148:151], v226 offset:1024
    v_mfma_f32_16x16x32_bf16 v[52:55], v[152:155], a[92:95], v[52:55]
    buffer_load_dwordx4 a[116:119], v9, s[28:31], s67 offen sc1
    v_mfma_f32_16x16x32_bf16 v[36:39], v[156:159], a[88:91], v[36:39]
    s_waitcnt lgkmcnt(4)
    ds_read_b128 v[152:155], v226 offset:2048
    v_mfma_f32_16x16x32_bf16 v[56:59], v[156:159], a[92:95], v[56:59]
    v_mfma_f32_16x16x32_bf16 v[40:43], v[160:163], a[88:91], v[40:43]
    s_waitcnt lgkmcnt(4)
    ds_read_b128 v[156:159], v226 offset:3072
    v_mfma_f32_16x16x32_bf16 v[60:63], v[160:163], a[92:95], v[60:63]
    buffer_load_dwordx4 a[120:123], v8, s[28:31], s67 offen sc1
    v_mfma_f32_16x16x32_bf16 v[44:47], v[164:167], a[88:91], v[44:47]
    s_waitcnt lgkmcnt(4)
    ds_read_b128 v[160:163], v226 offset:4096
    v_mfma_f32_16x16x32_bf16 v[64:67], v[164:167], a[92:95], v[64:67]
    v_mfma_f32_16x16x32_bf16 v[48:51], v[168:171], a[88:91], v[48:51]
    s_waitcnt vmcnt(5) lgkmcnt(4)
    ds_read_b128 v[164:167], v226 offset:5120
    v_mfma_f32_16x16x32_bf16 v[68:71], v[168:171], a[92:95], v[68:71]
    buffer_load_dwordx4 a[124:127], v10, s[28:31], s67 offen sc1
    v_mfma_f32_16x16x32_bf16 v[32:35], v[172:175], a[96:99], v[32:35]
    s_waitcnt lgkmcnt(4)
    ds_read_b128 v[168:171], v226 offset:6144
    v_mfma_f32_16x16x32_bf16 v[52:55], v[172:175], a[100:103], v[52:55]
    v_mfma_f32_16x16x32_bf16 v[36:39], v[148:151], a[96:99], v[36:39]
    s_waitcnt lgkmcnt(4)
    ds_read_b128 v[172:175], v226 offset:7168
    v_mfma_f32_16x16x32_bf16 v[56:59], v[148:151], a[100:103], v[56:59]
    v_mfma_f32_16x16x32_bf16 v[40:43], v[152:155], a[96:99], v[40:43]
    s_waitcnt lgkmcnt(4)
    ds_read_b128 v[148:151], v226 offset:8192
    v_mfma_f32_16x16x32_bf16 v[60:63], v[152:155], a[100:103], v[60:63]
    buffer_load_dwordx4 v[196:199], v11, s[28:31], s61 offen sc1
    v_mfma_f32_16x16x32_bf16 v[44:47], v[156:159], a[96:99], v[44:47]
    s_waitcnt lgkmcnt(4)
    ds_read_b128 v[152:155], v226 offset:9216
    v_mfma_f32_16x16x32_bf16 v[64:67], v[156:159], a[100:103], v[64:67]
    v_mfma_f32_16x16x32_bf16 v[48:51], v[160:163], a[96:99], v[48:51]
    s_waitcnt vmcnt(5) lgkmcnt(4)
    ds_read_b128 v[156:159], v226 offset:10240
    v_mfma_f32_16x16x32_bf16 v[68:71], v[160:163], a[100:103], v[68:71]
    buffer_load_dwordx4 v[200:203], v11, s[28:31], s62 offen sc1
    v_mfma_f32_16x16x32_bf16 v[32:35], v[164:167], a[104:107], v[32:35]
    s_waitcnt lgkmcnt(4)
    ds_read_b128 v[160:163], v226 offset:11264
    v_mfma_f32_16x16x32_bf16 v[52:55], v[164:167], a[108:111], v[52:55]
    v_mfma_f32_16x16x32_bf16 v[36:39], v[168:171], a[104:107], v[36:39]
    s_waitcnt lgkmcnt(4)
    ds_read_b128 v[164:167], v226 offset:12288
    v_mfma_f32_16x16x32_bf16 v[56:59], v[168:171], a[108:111], v[56:59]
    buffer_load_dwordx4 v[204:207], v11, s[28:31], s63 offen sc1
    v_mfma_f32_16x16x32_bf16 v[40:43], v[172:175], a[104:107], v[40:43]
    s_waitcnt lgkmcnt(4)
    ds_read_b128 v[168:171], v226 offset:13312
    v_mfma_f32_16x16x32_bf16 v[60:63], v[172:175], a[108:111], v[60:63]
    v_mfma_f32_16x16x32_bf16 v[44:47], v[148:151], a[104:107], v[44:47]
    s_waitcnt lgkmcnt(4)
    ds_read_b128 v[172:175], v226 offset:14336
    v_mfma_f32_16x16x32_bf16 v[64:67], v[148:151], a[108:111], v[64:67]
    v_mfma_f32_16x16x32_bf16 v[48:51], v[152:155], a[104:107], v[48:51]
    s_waitcnt vmcnt(5) lgkmcnt(4)
    ds_read_b128 v[148:151], v226 offset:15360
    v_mfma_f32_16x16x32_bf16 v[68:71], v[152:155], a[108:111], v[68:71]
    buffer_load_dwordx4 v[208:211], v11, s[28:31], s64 offen sc1
    v_mfma_f32_16x16x32_bf16 v[32:35], v[156:159], a[112:115], v[32:35]
    s_waitcnt lgkmcnt(4)
    ds_read_b128 v[152:155], v226 offset:16384
    v_mfma_f32_16x16x32_bf16 v[52:55], v[156:159], a[116:119], v[52:55]
    v_mfma_f32_16x16x32_bf16 v[36:39], v[160:163], a[112:115], v[36:39]
    s_waitcnt lgkmcnt(4)
    ds_read_b128 v[156:159], v226 offset:17408
    v_mfma_f32_16x16x32_bf16 v[56:59], v[160:163], a[116:119], v[56:59]
    buffer_load_dwordx4 v[212:215], v11, s[28:31], s65 offen sc1
    v_mfma_f32_16x16x32_bf16 v[40:43], v[164:167], a[112:115], v[40:43]
    s_waitcnt lgkmcnt(4)
    ds_read_b128 v[160:163], v226 offset:18432
    v_mfma_f32_16x16x32_bf16 v[60:63], v[164:167], a[116:119], v[60:63]
    v_mfma_f32_16x16x32_bf16 v[44:47], v[168:171], a[112:115], v[44:47]
    s_waitcnt lgkmcnt(4)
    ds_read_b128 v[164:167], v226 offset:19456
    v_mfma_f32_16x16x32_bf16 v[64:67], v[168:171], a[116:119], v[64:67]
    buffer_load_dwordx4 v[216:219], v11, s[28:31], s66 offen sc1
    v_mfma_f32_16x16x32_bf16 v[48:51], v[172:175], a[112:115], v[48:51]
    s_waitcnt vmcnt(6) lgkmcnt(4)
    ds_read_b128 v[168:171], v226 offset:20480
    v_mfma_f32_16x16x32_bf16 v[68:71], v[172:175], a[116:119], v[68:71]
    v_mfma_f32_16x16x32_bf16 v[32:35], v[148:151], a[120:123], v[32:35]
    s_waitcnt lgkmcnt(4)
    ds_read_b128 v[172:175], v226 offset:21504
    v_mfma_f32_16x16x32_bf16 v[52:55], v[148:151], a[124:127], v[52:55]
    buffer_load_dwordx4 v[220:223], v11, s[28:31], s67 offen sc1
    v_mfma_f32_16x16x32_bf16 v[36:39], v[152:155], a[120:123], v[36:39]
    s_waitcnt lgkmcnt(4)
    ds_read_b128 v[148:151], v226 offset:22528
    v_mfma_f32_16x16x32_bf16 v[56:59], v[152:155], a[124:127], v[56:59]
    v_mfma_f32_16x16x32_bf16 v[40:43], v[156:159], a[120:123], v[40:43]
    s_waitcnt lgkmcnt(4)
    ds_read_b128 v[152:155], v226 offset:23552
    v_mfma_f32_16x16x32_bf16 v[60:63], v[156:159], a[124:127], v[60:63]
    v_mfma_f32_16x16x32_bf16 v[44:47], v[160:163], a[120:123], v[44:47]
    s_waitcnt vmcnt(6) lgkmcnt(4)
    ds_read_b128 v[156:159], v226 offset:24576
    v_mfma_f32_16x16x32_bf16 v[64:67], v[160:163], a[124:127], v[64:67]
    v_swap_b32 v194, v196
    v_swap_b32 v195, v197
    v_mfma_f32_16x16x32_bf16 v[48:51], v[164:167], a[120:123], v[48:51]
    s_waitcnt lgkmcnt(4)
    ds_read_b128 v[160:163], v226 offset:25600
    v_mfma_f32_16x16x32_bf16 v[68:71], v[164:167], a[124:127], v[68:71]
    buffer_load_dwordx4 a[20:23], v9, s[28:31], s61 offen sc1
    v_mfma_f32_16x16x32_bf16 v[32:35], v[168:171], v[192:195], v[32:35]
    s_waitcnt lgkmcnt(4)
    ds_read_b128 v[164:167], v226 offset:26624
    v_mfma_f32_16x16x32_bf16 v[52:55], v[168:171], v[196:199], v[52:55]
    buffer_load_dwordx4 a[28:31], v10, s[28:31], s61 offen sc1
    v_mfma_f32_16x16x32_bf16 v[36:39], v[172:175], v[192:195], v[36:39]
    s_waitcnt lgkmcnt(4)
    ds_read_b128 v[168:171], v226 offset:27648
    v_mfma_f32_16x16x32_bf16 v[56:59], v[172:175], v[196:199], v[56:59]
    v_mfma_f32_16x16x32_bf16 v[40:43], v[148:151], v[192:195], v[40:43]
    s_waitcnt lgkmcnt(4)
    ds_read_b128 v[172:175], v226 offset:28672
    v_mfma_f32_16x16x32_bf16 v[60:63], v[148:151], v[196:199], v[60:63]
    buffer_load_dwordx4 a[36:39], v9, s[28:31], s62 offen sc1
    v_mfma_f32_16x16x32_bf16 v[44:47], v[152:155], v[192:195], v[44:47]
    s_waitcnt vmcnt(7) lgkmcnt(4)
    ds_read_b128 v[148:151], v226 offset:29696
    v_mfma_f32_16x16x32_bf16 v[64:67], v[152:155], v[196:199], v[64:67]
    v_swap_b32 v202, v204
    v_swap_b32 v203, v205
    v_mfma_f32_16x16x32_bf16 v[48:51], v[156:159], v[192:195], v[48:51]
    s_waitcnt lgkmcnt(4)
    ds_read_b128 v[152:155], v226 offset:30720
    v_mfma_f32_16x16x32_bf16 v[68:71], v[156:159], v[196:199], v[68:71]
    v_mfma_f32_16x16x32_bf16 v[32:35], v[160:163], v[200:203], v[32:35]
    s_waitcnt lgkmcnt(4)
    ds_read_b128 v[156:159], v226 offset:31744
    v_mfma_f32_16x16x32_bf16 v[52:55], v[160:163], v[204:207], v[52:55]
    buffer_load_dwordx4 a[44:47], v10, s[28:31], s62 offen sc1
    v_mfma_f32_16x16x32_bf16 v[36:39], v[164:167], v[200:203], v[36:39]
    s_waitcnt lgkmcnt(4)
    ds_read_b128 v[160:163], v226 offset:32768
    v_mfma_f32_16x16x32_bf16 v[56:59], v[164:167], v[204:207], v[56:59]
    v_mfma_f32_16x16x32_bf16 v[40:43], v[168:171], v[200:203], v[40:43]
    s_waitcnt lgkmcnt(4)
    ds_read_b128 v[164:167], v226 offset:33792
    v_mfma_f32_16x16x32_bf16 v[60:63], v[168:171], v[204:207], v[60:63]
    buffer_load_dwordx4 a[52:55], v9, s[28:31], s63 offen sc1
    v_mfma_f32_16x16x32_bf16 v[44:47], v[172:175], v[200:203], v[44:47]
    s_waitcnt vmcnt(7) lgkmcnt(4)
    ds_read_b128 v[168:171], v226 offset:34816
    v_mfma_f32_16x16x32_bf16 v[64:67], v[172:175], v[204:207], v[64:67]
    v_swap_b32 v210, v212
    v_swap_b32 v211, v213
    v_mfma_f32_16x16x32_bf16 v[48:51], v[148:151], v[200:203], v[48:51]
    s_waitcnt vmcnt(5) lgkmcnt(4)
    ds_read_b128 v[172:175], v226 offset:35840
    v_mfma_f32_16x16x32_bf16 v[68:71], v[148:151], v[204:207], v[68:71]
    buffer_store_dword v254, v255, s[20:23], s59 offen offset:64
    v_mfma_f32_16x16x32_bf16 v[32:35], v[152:155], v[208:211], v[32:35]
    s_waitcnt lgkmcnt(4)
    ds_read_b128 v[148:151], v226 offset:36864
    v_mfma_f32_16x16x32_bf16 v[52:55], v[152:155], v[212:215], v[52:55]
    buffer_load_dwordx4 a[60:63], v10, s[28:31], s63 offen sc1
    v_mfma_f32_16x16x32_bf16 v[36:39], v[156:159], v[208:211], v[36:39]
    s_waitcnt lgkmcnt(4)
    ds_read_b128 v[152:155], v226 offset:37888
    v_mfma_f32_16x16x32_bf16 v[56:59], v[156:159], v[212:215], v[56:59]
    v_mfma_f32_16x16x32_bf16 v[40:43], v[160:163], v[208:211], v[40:43]
    s_waitcnt lgkmcnt(4)
    ds_read_b128 v[156:159], v226 offset:38912
    v_mfma_f32_16x16x32_bf16 v[60:63], v[160:163], v[212:215], v[60:63]
    buffer_load_dwordx4 a[68:71], v9, s[28:31], s64 offen sc1
    v_mfma_f32_16x16x32_bf16 v[44:47], v[164:167], v[208:211], v[44:47]
    s_waitcnt lgkmcnt(4)
    ds_read_b128 v[160:163], v226 offset:39936
    v_mfma_f32_16x16x32_bf16 v[64:67], v[164:167], v[212:215], v[64:67]
    v_swap_b32 v218, v220
    v_swap_b32 v219, v221
    v_mfma_f32_16x16x32_bf16 v[48:51], v[168:171], v[208:211], v[48:51]
    s_waitcnt lgkmcnt(4)
    v_mfma_f32_16x16x32_bf16 v[68:71], v[168:171], v[212:215], v[68:71]
    buffer_load_dwordx4 a[76:79], v10, s[28:31], s64 offen sc1
    v_mfma_f32_16x16x32_bf16 v[32:35], v[172:175], v[216:219], v[32:35]
    s_waitcnt lgkmcnt(3)
    v_mfma_f32_16x16x32_bf16 v[52:55], v[172:175], v[220:223], v[52:55]
    v_mfma_f32_16x16x32_bf16 v[36:39], v[148:151], v[216:219], v[36:39]
    s_waitcnt lgkmcnt(2)
    v_mfma_f32_16x16x32_bf16 v[56:59], v[148:151], v[220:223], v[56:59]
    v_mfma_f32_16x16x32_bf16 v[40:43], v[152:155], v[216:219], v[40:43]
    s_waitcnt lgkmcnt(1)
    v_mfma_f32_16x16x32_bf16 v[60:63], v[152:155], v[220:223], v[60:63]
    v_mfma_f32_16x16x32_bf16 v[44:47], v[156:159], v[216:219], v[44:47]
    s_waitcnt lgkmcnt(0)
    v_mfma_f32_16x16x32_bf16 v[64:67], v[156:159], v[220:223], v[64:67]
    v_mfma_f32_16x16x32_bf16 v[48:51], v[160:163], v[216:219], v[48:51]
    s_waitcnt vmcnt(8)
    v_mfma_f32_16x16x32_bf16 v[68:71], v[160:163], v[220:223], v[68:71]
    v_mfma_f32_16x16x32_bf16 v[52:55], a[128:131], a[20:23], v[52:55]
    buffer_load_dword v251, v250, s[20:23], s59 offen offset:64 sc1
    v_mfma_f32_16x16x32_bf16 v[56:59], a[132:135], a[20:23], v[56:59]
    v_mfma_f32_16x16x32_bf16 v[60:63], a[136:139], a[20:23], v[60:63]
    v_mfma_f32_16x16x32_bf16 v[64:67], a[140:143], a[20:23], v[64:67]
    v_cvt_pk_bf16_f32 v120, v32, v33
    v_cvt_pk_bf16_f32 v121, v34, v35
    v_mfma_f32_16x16x32_bf16 v[68:71], a[144:147], a[20:23], v[68:71]
    s_waitcnt vmcnt(8)
    ds_write_b64 v239, v[120:121] offset:0
    v_mfma_f32_16x16x32_bf16 v[52:55], a[148:151], a[28:31], v[52:55]
    v_cvt_pk_bf16_f32 v122, v36, v37
    v_cvt_pk_bf16_f32 v123, v38, v39
    v_mfma_f32_16x16x32_bf16 v[56:59], a[152:155], a[28:31], v[56:59]
    ds_write_b64 v239, v[122:123] offset:8
    v_mfma_f32_16x16x32_bf16 v[60:63], a[156:159], a[28:31], v[60:63]
    v_cvt_pk_bf16_f32 v124, v40, v41
    v_cvt_pk_bf16_f32 v125, v42, v43
    v_mfma_f32_16x16x32_bf16 v[64:67], a[160:163], a[28:31], v[64:67]
    ds_write_b64 v239, v[124:125] offset:16
    v_mfma_f32_16x16x32_bf16 v[68:71], a[164:167], a[28:31], v[68:71]
    s_waitcnt vmcnt(7)
    v_cvt_pk_bf16_f32 v126, v44, v45
    v_cvt_pk_bf16_f32 v127, v46, v47
    v_mfma_f32_16x16x32_bf16 v[52:55], a[168:171], a[36:39], v[52:55]
    ds_write_b64 v239, v[126:127] offset:24
    v_mfma_f32_16x16x32_bf16 v[56:59], a[172:175], a[36:39], v[56:59]
    v_cvt_pk_bf16_f32 v128, v48, v49
    v_cvt_pk_bf16_f32 v129, v50, v51
    v_mfma_f32_16x16x32_bf16 v[60:63], a[176:179], a[36:39], v[60:63]
    s_waitcnt vmcnt(1)
    ds_write_b64 v239, v[128:129] offset:32
    buffer_store_dword v254, v255, s[20:23], s59 offen offset:96
    v_mfma_f32_16x16x32_bf16 v[64:67], a[180:183], a[36:39], v[64:67]
    ds_read_b128 v[136:139], v240
    ds_read_b128 v[140:143], v241
    v_mfma_f32_16x16x32_bf16 v[68:71], a[184:187], a[36:39], v[68:71]
    ds_read_b128 v[144:147], v242
    v_mfma_f32_16x16x32_bf16 v[52:55], a[188:191], a[44:47], v[52:55]
    v_mfma_f32_16x16x32_bf16 v[56:59], a[192:195], a[44:47], v[56:59]
    v_mfma_f32_16x16x32_bf16 v[60:63], a[196:199], a[44:47], v[60:63]
    v_mfma_f32_16x16x32_bf16 v[64:67], a[200:203], a[44:47], v[64:67]
    v_mfma_f32_16x16x32_bf16 v[68:71], a[204:207], a[44:47], v[68:71]
    v_mfma_f32_16x16x32_bf16 v[52:55], a[208:211], a[52:55], v[52:55]
    v_mfma_f32_16x16x32_bf16 v[56:59], a[212:215], a[52:55], v[56:59]
    v_mfma_f32_16x16x32_bf16 v[60:63], a[216:219], a[52:55], v[60:63]
    s_waitcnt vmcnt(1)
    v_cmp_ne_u32 vcc, s32, v251
    v_mfma_f32_16x16x32_bf16 v[64:67], a[220:223], a[52:55], v[64:67]
    v_mfma_f32_16x16x32_bf16 v[68:71], a[224:227], a[52:55], v[68:71]
    s_nop 1
    s_cbranch_vccnz L_d0A_retry
L_d0A_ok:
    v_mfma_f32_16x16x32_bf16 v[52:55], a[228:231], a[60:63], v[52:55]
    s_waitcnt lgkmcnt(2)
    buffer_store_dwordx4 v[136:139], v245, s[24:27], s73 offen
    v_mfma_f32_16x16x32_bf16 v[52:55], a[248:251], a[68:71], v[52:55]
    v_mfma_f32_16x16x32_bf16 v[52:55], v[84:87], a[76:79], v[52:55]
    s_waitcnt lgkmcnt(1)
    buffer_store_dwordx4 v[140:143], v246, s[24:27], s73 offen
    v_mfma_f32_16x16x32_bf16 v[56:59], a[232:235], a[60:63], v[56:59]
    v_mfma_f32_16x16x32_bf16 v[56:59], a[252:255], a[68:71], v[56:59]
    s_waitcnt lgkmcnt(0)
    buffer_store_dwordx4 v[144:147], v247, s[24:27], s73 offen
    v_mfma_f32_16x16x32_bf16 v[56:59], v[88:91], a[76:79], v[56:59]
    v_mfma_f32_16x16x32_bf16 v[60:63], a[236:239], a[60:63], v[60:63]
    v_cvt_pk_bf16_f32 v120, v52, v53
    v_cvt_pk_bf16_f32 v121, v54, v55
    v_mfma_f32_16x16x32_bf16 v[60:63], v[72:75], a[68:71], v[60:63]
    ds_write_b64 v239, v[120:121] offset:0
    buffer_load_dword v251, v250, s[20:23], s59 offen offset:96 sc1
    v_mfma_f32_16x16x32_bf16 v[60:63], v[92:95], a[76:79], v[60:63]
    v_mfma_f32_16x16x32_bf16 v[64:67], a[240:243], a[60:63], v[64:67]
    v_cvt_pk_bf16_f32 v122, v56, v57
    v_cvt_pk_bf16_f32 v123, v58, v59
    v_mfma_f32_16x16x32_bf16 v[64:67], v[76:79], a[68:71], v[64:67]
    s_or_b32 s42, s4, s51
    ds_write_b64 v239, v[122:123] offset:8
    v_mfma_f32_16x16x32_bf16 v[64:67], v[96:99], a[76:79], v[64:67]
    s_cmp_lg_u32 s42, 0
    v_mfma_f32_16x16x32_bf16 v[68:71], a[244:247], a[60:63], v[68:71]
    s_cselect_b32 s42, 33554432, 0
    v_cvt_pk_bf16_f32 v124, v60, v61
    v_cvt_pk_bf16_f32 v125, v62, v63
    v_mfma_f32_16x16x32_bf16 v[68:71], v[80:83], a[68:71], v[68:71]
    ds_write_b64 v239, v[124:125] offset:16
    buffer_store_dword v254, v255, s[20:23], s42 offen offset:0 sc1
    v_mfma_f32_16x16x32_bf16 v[68:71], v[100:103], a[76:79], v[68:71]
    s_add_u32 s73, s73, 40960
    v_cvt_pk_bf16_f32 v126, v64, v65
    v_cvt_pk_bf16_f32 v127, v66, v67
    ds_write_b64 v239, v[126:127] offset:24
    s_waitcnt vmcnt(1)
    v_cmp_ne_u32 vcc, s32, v251
    s_nop 1
    v_cvt_pk_bf16_f32 v128, v68, v69
    v_cvt_pk_bf16_f32 v129, v70, v71
    ds_write_b64 v239, v[128:129] offset:32
    ds_read_b128 v[136:139], v240
    ds_read_b128 v[140:143], v241
    ds_read_b128 v[144:147], v242
    s_cbranch_vccnz L_d1A_retry
L_d1A_ok:
    s_waitcnt lgkmcnt(2)
    buffer_store_dwordx4 v[136:139], v245, s[24:27], s73 offen
    s_waitcnt lgkmcnt(1)
    buffer_store_dwordx4 v[140:143], v246, s[24:27], s73 offen
    s_waitcnt lgkmcnt(0)
    buffer_store_dwordx4 v[144:147], v247, s[24:27], s73 offen
    s_endpgm
L_xcA_retry:
    s_mov_b32 s52, 0
L_xcA_loop:
    buffer_load_dword v204, v250, s[20:23], s93 offen sc1
    s_waitcnt vmcnt(0)
    v_xor_b32 v205, s32, v204
    v_lshlrev_b32 v205, 4, v205
    v_cmp_ne_u32 vcc, 0, v205
    s_nop 3
    s_cbranch_vccz L_xcA_ok
    s_add_u32 s52, s52, 1
    s_cmp_lt_u32 s52, 100000
    s_cbranch_scc1 L_xcA_loop
    s_branch L_xcA_ok
L_k0A_slow:
    v_max3_f32 v192, v32, v33, v34
    v_min3_f32 v193, v32, v33, v34
    v_max3_f32 v192, v192, v35, v36
    v_min3_f32 v193, v193, v35, v36
    v_max3_f32 v192, v192, v37, v38
    v_min3_f32 v193, v193, v37, v38
    v_max3_f32 v192, v192, v39, v40
    v_min3_f32 v193, v193, v39, v40
    v_max3_f32 v192, v192, v41, v42
    v_min3_f32 v193, v193, v41, v42
    v_max3_f32 v192, v192, v43, v44
    v_min3_f32 v193, v193, v43, v44
    v_max3_f32 v192, v192, v45, v46
    v_min3_f32 v193, v193, v45, v46
    v_max3_f32 v192, v192, v47, v48
    v_min3_f32 v193, v193, v47, v48
    v_max3_f32 v192, v192, v49, v50
    v_min3_f32 v193, v193, v49, v50
    v_max_f32 v192, v192, v51
    v_min_f32 v193, v193, v51
    v_sub_f32 v112, v32, v192
    v_sub_f32 v132, v193, v32
    v_sub_f32 v113, v33, v192
    v_sub_f32 v133, v193, v33
    v_sub_f32 v114, v34, v192
    v_sub_f32 v134, v193, v34
    v_sub_f32 v115, v35, v192
    v_sub_f32 v135, v193, v35
    v_sub_f32 v116, v36, v192
    v_sub_f32 v136, v193, v36
    v_sub_f32 v117, v37, v192
    v_sub_f32 v137, v193, v37
    v_sub_f32 v118, v38, v192
    v_sub_f32 v138, v193, v38
    v_sub_f32 v119, v39, v192
    v_sub_f32 v139, v193, v39
    v_sub_f32 v120, v40, v192
    v_sub_f32 v140, v193, v40
    v_sub_f32 v121, v41, v192
    v_sub_f32 v141, v193, v41
    v_sub_f32 v122, v42, v192
    v_sub_f32 v142, v193, v42
    v_sub_f32 v123, v43, v192
    v_sub_f32 v143, v193, v43
    v_sub_f32 v124, v44, v192
    v_sub_f32 v144, v193, v44
    v_sub_f32 v125, v45, v192
    v_sub_f32 v145, v193, v45
    v_sub_f32 v126, v46, v192
    v_sub_f32 v146, v193, v46
    v_sub_f32 v127, v47, v192
    v_sub_f32 v147, v193, v47
    v_sub_f32 v128, v48, v192
    v_sub_f32 v148, v193, v48
    v_sub_f32 v129, v49, v192
    v_sub_f32 v149, v193, v49
    v_sub_f32 v130, v50, v192
    v_sub_f32 v150, v193, v50
    v_sub_f32 v131, v51, v192
    v_sub_f32 v151, v193, v51
    v_exp_f32 v112, v112
    v_exp_f32 v113, v113
    v_exp_f32 v114, v114
    v_exp_f32 v115, v115
    v_exp_f32 v116, v116
    v_exp_f32 v117, v117
    v_exp_f32 v118, v118
    v_exp_f32 v119, v119
    v_exp_f32 v120, v120
    v_exp_f32 v121, v121
    v_exp_f32 v122, v122
    v_exp_f32 v123, v123
    v_exp_f32 v124, v124
    v_exp_f32 v125, v125
    v_exp_f32 v126, v126
    v_exp_f32 v127, v127
    v_exp_f32 v128, v128
    v_exp_f32 v129, v129
    v_exp_f32 v130, v130
    v_exp_f32 v131, v131
    v_exp_f32 v132, v132
    v_exp_f32 v133, v133
    v_exp_f32 v134, v134
    v_exp_f32 v135, v135
    v_exp_f32 v136, v136
    v_exp_f32 v137, v137
    v_exp_f32 v138, v138
    v_exp_f32 v139, v139
    v_exp_f32 v140, v140
    v_exp_f32 v141, v141
    v_exp_f32 v142, v142
    v_exp_f32 v143, v143
    v_exp_f32 v144, v144
    v_exp_f32 v145, v145
    v_exp_f32 v146, v146
    v_exp_f32 v147, v147
    v_exp_f32 v148, v148
    v_exp_f32 v149, v149
    v_exp_f32 v150, v150
    v_exp_f32 v151, v151
    v_pk_add_f32 v[192:193], v[112:113], v[114:115]
    v_pk_add_f32 v[194:195], v[132:133], v[134:135]
    v_pk_add_f32 v[192:193], v[192:193], v[116:117]
    v_pk_add_f32 v[194:195], v[194:195], v[136:137]
    v_pk_add_f32 v[192:193], v[192:193], v[118:119]
    v_pk_add_f32 v[194:195], v[194:195], v[138:139]
    v_pk_add_f32 v[192:193], v[192:193], v[120:121]
    v_pk_add_f32 v[194:195], v[194:195], v[140:141]
    v_pk_add_f32 v[192:193], v[192:193], v[122:123]
    v_pk_add_f32 v[194:195], v[194:195], v[142:143]
    v_pk_add_f32 v[192:193], v[192:193], v[124:125]
    v_pk_add_f32 v[194:195], v[194:195], v[144:145]
    v_pk_add_f32 v[192:193], v[192:193], v[126:127]
    v_pk_add_f32 v[194:195], v[194:195], v[146:147]
    v_pk_add_f32 v[192:193], v[192:193], v[128:129]
    v_pk_add_f32 v[194:195], v[194:195], v[148:149]
    v_pk_add_f32 v[192:193], v[192:193], v[130:131]
    v_pk_add_f32 v[194:195], v[194:195], v[150:151]
    v_add_f32 v192, v192, v193
    v_add_f32 v194, v194, v195
    v_rcp_f32 v194, v194
    v_rcp_f32 v196, v192
    v_pk_mul_f32 v[132:133], v[132:133], v[194:195] op_sel_hi:[1,0]
    v_pk_mul_f32 v[134:135], v[134:135], v[194:195] op_sel_hi:[1,0]
    v_pk_mul_f32 v[136:137], v[136:137], v[194:195] op_sel_hi:[1,0]
    v_pk_mul_f32 v[138:139], v[138:139], v[194:195] op_sel_hi:[1,0]
    v_pk_mul_f32 v[140:141], v[140:141], v[194:195] op_sel_hi:[1,0]
    v_pk_mul_f32 v[142:143], v[142:143], v[194:195] op_sel_hi:[1,0]
    v_pk_mul_f32 v[144:145], v[144:145], v[194:195] op_sel_hi:[1,0]
    v_pk_mul_f32 v[146:147], v[146:147], v[194:195] op_sel_hi:[1,0]
    v_pk_mul_f32 v[148:149], v[148:149], v[194:195] op_sel_hi:[1,0]
    v_pk_mul_f32 v[150:151], v[150:151], v[194:195] op_sel_hi:[1,0]
    s_branch L_k0A_back
L_k1A_slow:
    v_max3_f32 v198, v52, v53, v54
    v_min3_f32 v199, v52, v53, v54
    v_max3_f32 v198, v198, v55, v56
    v_min3_f32 v199, v199, v55, v56
    v_max3_f32 v198, v198, v57, v58
    v_min3_f32 v199, v199, v57, v58
    v_max3_f32 v198, v198, v59, v60
    v_min3_f32 v199, v199, v59, v60
    v_max3_f32 v198, v198, v61, v62
    v_min3_f32 v199, v199, v61, v62
    v_max3_f32 v198, v198, v63, v64
    v_min3_f32 v199, v199, v63, v64
    v_max3_f32 v198, v198, v65, v66
    v_min3_f32 v199, v199, v65, v66
    v_max3_f32 v198, v198, v67, v68
    v_min3_f32 v199, v199, v67, v68
    v_max3_f32 v198, v198, v69, v70
    v_min3_f32 v199, v199, v69, v70
    v_max_f32 v198, v198, v71
    v_min_f32 v199, v199, v71
    v_sub_f32 v152, v52, v198
    v_sub_f32 v172, v199, v52
    v_sub_f32 v153, v53, v198
    v_sub_f32 v173, v199, v53
    v_sub_f32 v154, v54, v198
    v_sub_f32 v174, v199, v54
    v_sub_f32 v155, v55, v198
    v_sub_f32 v175, v199, v55
    v_sub_f32 v156, v56, v198
    v_sub_f32 v176, v199, v56
    v_sub_f32 v157, v57, v198
    v_sub_f32 v177, v199, v57
    v_sub_f32 v158, v58, v198
    v_sub_f32 v178, v199, v58
    v_sub_f32 v159, v59, v198
    v_sub_f32 v179, v199, v59
    v_sub_f32 v160, v60, v198
    v_sub_f32 v180, v199, v60
    v_sub_f32 v161, v61, v198
    v_sub_f32 v181, v199, v61
    v_sub_f32 v162, v62, v198
    v_sub_f32 v182, v199, v62
    v_sub_f32 v163, v63, v198
    v_sub_f32 v183, v199, v63
    v_sub_f32 v164, v64, v198
    v_sub_f32 v184, v199, v64
    v_sub_f32 v165, v65, v198
    v_sub_f32 v185, v199, v65
    v_sub_f32 v166, v66, v198
    v_sub_f32 v186, v199, v66
    v_sub_f32 v167, v67, v198
    v_sub_f32 v187, v199, v67
    v_sub_f32 v168, v68, v198
    v_sub_f32 v188, v199, v68
    v_sub_f32 v169, v69, v198
    v_sub_f32 v189, v199, v69
    v_sub_f32 v170, v70, v198
    v_sub_f32 v190, v199, v70
    v_sub_f32 v171, v71, v198
    v_sub_f32 v191, v199, v71
    v_exp_f32 v152, v152
    v_exp_f32 v153, v153
    v_exp_f32 v154, v154
    v_exp_f32 v155, v155
    v_exp_f32 v156, v156
    v_exp_f32 v157, v157
    v_exp_f32 v158, v158
    v_exp_f32 v159, v159
    v_exp_f32 v160, v160
    v_exp_f32 v161, v161
    v_exp_f32 v162, v162
    v_exp_f32 v163, v163
    v_exp_f32 v164, v164
    v_exp_f32 v165, v165
    v_exp_f32 v166, v166
    v_exp_f32 v167, v167
    v_exp_f32 v168, v168
    v_exp_f32 v169, v169
    v_exp_f32 v170, v170
    v_exp_f32 v171, v171
    v_exp_f32 v172, v172
    v_exp_f32 v173, v173
    v_exp_f32 v174, v174
    v_exp_f32 v175, v175
    v_exp_f32 v176, v176
    v_exp_f32 v177, v177
    v_exp_f32 v178, v178
    v_exp_f32 v179, v179
    v_exp_f32 v180, v180
    v_exp_f32 v181, v181
    v_exp_f32 v182, v182
    v_exp_f32 v183, v183
    v_exp_f32 v184, v184
    v_exp_f32 v185, v185
    v_exp_f32 v186, v186
    v_exp_f32 v187, v187
    v_exp_f32 v188, v188
    v_exp_f32 v189, v189
    v_exp_f32 v190, v190
    v_exp_f32 v191, v191
    v_pk_add_f32 v[198:199], v[152:153], v[154:155]
    v_pk_add_f32 v[200:201], v[172:173], v[174:175]
    v_pk_add_f32 v[198:199], v[198:199], v[156:157]
    v_pk_add_f32 v[200:201], v[200:201], v[176:177]
    v_pk_add_f32 v[198:199], v[198:199], v[158:159]
    v_pk_add_f32 v[200:201], v[200:201], v[178:179]
    v_pk_add_f32 v[198:199], v[198:199], v[160:161]
    v_pk_add_f32 v[200:201], v[200:201], v[180:181]
    v_pk_add_f32 v[198:199], v[198:199], v[162:163]
    v_pk_add_f32 v[200:201], v[200:201], v[182:183]
    v_pk_add_f32 v[198:199], v[198:199], v[164:165]
    v_pk_add_f32 v[200:201], v[200:201], v[184:185]
    v_pk_add_f32 v[198:199], v[198:199], v[166:167]
    v_pk_add_f32 v[200:201], v[200:201], v[186:187]
    v_pk_add_f32 v[198:199], v[198:199], v[168:169]
    v_pk_add_f32 v[200:201], v[200:201], v[188:189]
    v_pk_add_f32 v[198:199], v[198:199], v[170:171]
    v_pk_add_f32 v[200:201], v[200:201], v[190:191]
    v_add_f32 v198, v198, v199
    v_add_f32 v200, v200, v201
    v_rcp_f32 v200, v200
    v_rcp_f32 v202, v198
    v_pk_mul_f32 v[172:173], v[172:173], v[200:201] op_sel_hi:[1,0]
    v_pk_mul_f32 v[174:175], v[174:175], v[200:201] op_sel_hi:[1,0]
    v_pk_mul_f32 v[176:177], v[176:177], v[200:201] op_sel_hi:[1,0]
    v_pk_mul_f32 v[178:179], v[178:179], v[200:201] op_sel_hi:[1,0]
    v_pk_mul_f32 v[180:181], v[180:181], v[200:201] op_sel_hi:[1,0]
    v_pk_mul_f32 v[182:183], v[182:183], v[200:201] op_sel_hi:[1,0]
    v_pk_mul_f32 v[184:185], v[184:185], v[200:201] op_sel_hi:[1,0]
    v_pk_mul_f32 v[186:187], v[186:187], v[200:201] op_sel_hi:[1,0]
    v_pk_mul_f32 v[188:189], v[188:189], v[200:201] op_sel_hi:[1,0]
    v_pk_mul_f32 v[190:191], v[190:191], v[200:201] op_sel_hi:[1,0]
    s_branch L_k1A_back
L_pfA_retry:
    s_mov_b32 s52, 0
L_pfA_loop:
    buffer_load_dwordx2 v[206:207], v13, s[20:23], s91 offen sc1
    s_waitcnt vmcnt(0)
    v_xor_b32 v206, s32, v206
    v_bitop3_b32 v206, v206, v207, s32 bitop3:0xf6
    v_cmp_ne_u32 vcc, 0, v206
    s_nop 3
    s_cbranch_vccz L_pfA_ok
    s_add_u32 s52, s52, 1
    s_cmp_lt_u32 s52, 100000
    s_cbranch_scc1 L_pfA_loop
    s_branch L_pfA_ok
L_h1A_retry:
    s_mov_b32 s52, 0
L_h1A_loop:
    s_add_u32 s42, s69, 0
    buffer_load_dwordx4 v[120:123], v229, s[20:23], s42 offen sc1
    s_add_u32 s42, s69, 16384
    buffer_load_dwordx4 v[124:127], v229, s[20:23], s42 offen sc1
    s_add_u32 s42, s69, 32768
    buffer_load_dwordx4 v[128:131], v229, s[20:23], s42 offen sc1
    s_add_u32 s42, s69, 49152
    buffer_load_dwordx4 v[132:135], v229, s[20:23], s42 offen sc1
    s_waitcnt vmcnt(0)
    v_xor_b32 v120, s8, v120
    v_xor_b32 v121, s9, v121
    v_xor_b32 v122, s10, v122
    v_xor_b32 v123, s11, v123
    v_xor_b32 v124, s8, v124
    v_xor_b32 v125, s9, v125
    v_xor_b32 v126, s10, v126
    v_xor_b32 v127, s11, v127
    v_xor_b32 v128, s8, v128
    v_xor_b32 v129, s9, v129
    v_xor_b32 v130, s10, v130
    v_xor_b32 v131, s11, v131
    v_xor_b32 v132, s8, v132
    v_xor_b32 v133, s9, v133
    v_xor_b32 v134, s10, v134
    v_xor_b32 v135, s11, v135
    v_or_b32 v114, v120, v121
    v_or3_b32 v114, v114, v122, v123
    v_or3_b32 v114, v114, v124, v125
    v_or3_b32 v114, v114, v126, v127
    v_or3_b32 v114, v114, v128, v129
    v_or3_b32 v114, v114, v130, v131
    v_or3_b32 v114, v114, v132, v133
    v_or3_b32 v114, v114, v134, v135
    v_and_b32 v114, 0xff, v114
    v_cmp_ne_u32 vcc, 0, v114
    s_nop 3
    s_cbranch_vccz L_h1A_redo
    s_add_u32 s52, s52, 1
    s_cmp_lt_u32 s52, 100000
    s_cbranch_scc1 L_h1A_loop
L_h1A_redo:
    v_add_f32 v120, v120, v124
    v_add_f32 v121, v121, v125
    v_add_f32 v122, v122, v126
    v_add_f32 v123, v123, v127
    v_add_f32 v120, v120, v128
    v_add_f32 v121, v121, v129
    v_add_f32 v122, v122, v130
    v_add_f32 v123, v123, v131
    v_add_f32 v120, v120, v132
    v_add_f32 v121, v121, v133
    v_add_f32 v122, v122, v134
    v_add_f32 v123, v123, v135
    s_branch L_h1A_ok
L_q0A_slow:
    v_max3_f32 v192, v32, v33, v34
    v_min3_f32 v193, v32, v33, v34
    v_max3_f32 v192, v192, v35, v36
    v_min3_f32 v193, v193, v35, v36
    v_max3_f32 v192, v192, v37, v38
    v_min3_f32 v193, v193, v37, v38
    v_max3_f32 v192, v192, v39, v40
    v_min3_f32 v193, v193, v39, v40
    v_max3_f32 v192, v192, v41, v42
    v_min3_f32 v193, v193, v41, v42
    v_max3_f32 v192, v192, v43, v44
    v_min3_f32 v193, v193, v43, v44
    v_max3_f32 v192, v192, v45, v46
    v_min3_f32 v193, v193, v45, v46
    v_max3_f32 v192, v192, v47, v48
    v_min3_f32 v193, v193, v47, v48
    v_max3_f32 v192, v192, v49, v50
    v_min3_f32 v193, v193, v49, v50
    v_max_f32 v192, v192, v51
    v_min_f32 v193, v193, v51
    v_sub_f32 v112, v32, v192
    v_sub_f32 v132, v193, v32
    v_sub_f32 v113, v33, v192
    v_sub_f32 v133, v193, v33
    v_sub_f32 v114, v34, v192
    v_sub_f32 v134, v193, v34
    v_sub_f32 v115, v35, v192
    v_sub_f32 v135, v193, v35
    v_sub_f32 v116, v36, v192
    v_sub_f32 v136, v193, v36
    v_sub_f32 v117, v37, v192
    v_sub_f32 v137, v193, v37
    v_sub_f32 v118, v38, v192
    v_sub_f32 v138, v193, v38
    v_sub_f32 v119, v39, v192
    v_sub_f32 v139, v193, v39
    v_sub_f32 v120, v40, v192
    v_sub_f32 v140, v193, v40
    v_sub_f32 v121, v41, v192
    v_sub_f32 v141, v193, v41
    v_sub_f32 v122, v42, v192
    v_sub_f32 v142, v193, v42
    v_sub_f32 v123, v43, v192
    v_sub_f32 v143, v193, v43
    v_sub_f32 v124, v44, v192
    v_sub_f32 v144, v193, v44
    v_sub_f32 v125, v45, v192
    v_sub_f32 v145, v193, v45
    v_sub_f32 v126, v46, v192
    v_sub_f32 v146, v193, v46
    v_sub_f32 v127, v47, v192
    v_sub_f32 v147, v193, v47
    v_sub_f32 v128, v48, v192
    v_sub_f32 v148, v193, v48
    v_sub_f32 v129, v49, v192
    v_sub_f32 v149, v193, v49
    v_sub_f32 v130, v50, v192
    v_sub_f32 v150, v193, v50
    v_sub_f32 v131, v51, v192
    v_sub_f32 v151, v193, v51
    v_exp_f32 v112, v112
    v_exp_f32 v113, v113
    v_exp_f32 v114, v114
    v_exp_f32 v115, v115
    v_exp_f32 v116, v116
    v_exp_f32 v117, v117
    v_exp_f32 v118, v118
    v_exp_f32 v119, v119
    v_exp_f32 v120, v120
    v_exp_f32 v121, v121
    v_exp_f32 v122, v122
    v_exp_f32 v123, v123
    v_exp_f32 v124, v124
    v_exp_f32 v125, v125
    v_exp_f32 v126, v126
    v_exp_f32 v127, v127
    v_exp_f32 v128, v128
    v_exp_f32 v129, v129
    v_exp_f32 v130, v130
    v_exp_f32 v131, v131
    v_exp_f32 v132, v132
    v_exp_f32 v133, v133
    v_exp_f32 v134, v134
    v_exp_f32 v135, v135
    v_exp_f32 v136, v136
    v_exp_f32 v137, v137
    v_exp_f32 v138, v138
    v_exp_f32 v139, v139
    v_exp_f32 v140, v140
    v_exp_f32 v141, v141
    v_exp_f32 v142, v142
    v_exp_f32 v143, v143
    v_exp_f32 v144, v144
    v_exp_f32 v145, v145
    v_exp_f32 v146, v146
    v_exp_f32 v147, v147
    v_exp_f32 v148, v148
    v_exp_f32 v149, v149
    v_exp_f32 v150, v150
    v_exp_f32 v151, v151
    v_pk_add_f32 v[192:193], v[112:113], v[114:115]
    v_pk_add_f32 v[194:195], v[132:133], v[134:135]
    v_pk_add_f32 v[192:193], v[192:193], v[116:117]
    v_pk_add_f32 v[194:195], v[194:195], v[136:137]
    v_pk_add_f32 v[192:193], v[192:193], v[118:119]
    v_pk_add_f32 v[194:195], v[194:195], v[138:139]
    v_pk_add_f32 v[192:193], v[192:193], v[120:121]
    v_pk_add_f32 v[194:195], v[194:195], v[140:141]
    v_pk_add_f32 v[192:193], v[192:193], v[122:123]
    v_pk_add_f32 v[194:195], v[194:195], v[142:143]
    v_pk_add_f32 v[192:193], v[192:193], v[124:125]
    v_pk_add_f32 v[194:195], v[194:195], v[144:145]
    v_pk_add_f32 v[192:193], v[192:193], v[126:127]
    v_pk_add_f32 v[194:195], v[194:195], v[146:147]
    v_pk_add_f32 v[192:193], v[192:193], v[128:129]
    v_pk_add_f32 v[194:195], v[194:195], v[148:149]
    v_pk_add_f32 v[192:193], v[192:193], v[130:131]
    v_pk_add_f32 v[194:195], v[194:195], v[150:151]
    v_add_f32 v192, v192, v193
    v_add_f32 v194, v194, v195
    v_rcp_f32 v194, v194
    s_nop 0
    v_mul_f32 v194, v194, v192
    v_pk_mul_f32 v[132:133], v[132:133], v[194:195] op_sel_hi:[1,0]
    v_pk_mul_f32 v[134:135], v[134:135], v[194:195] op_sel_hi:[1,0]
    v_pk_mul_f32 v[136:137], v[136:137], v[194:195] op_sel_hi:[1,0]
    v_pk_mul_f32 v[138:139], v[138:139], v[194:195] op_sel_hi:[1,0]
    v_pk_mul_f32 v[140:141], v[140:141], v[194:195] op_sel_hi:[1,0]
    v_pk_mul_f32 v[142:143], v[142:143], v[194:195] op_sel_hi:[1,0]
    v_pk_mul_f32 v[144:145], v[144:145], v[194:195] op_sel_hi:[1,0]
    v_pk_mul_f32 v[146:147], v[146:147], v[194:195] op_sel_hi:[1,0]
    v_pk_mul_f32 v[148:149], v[148:149], v[194:195] op_sel_hi:[1,0]
    v_pk_mul_f32 v[150:151], v[150:151], v[194:195] op_sel_hi:[1,0]
    s_branch L_q0A_back
L_q1A_slow:
    v_max3_f32 v198, v52, v53, v54
    v_min3_f32 v199, v52, v53, v54
    v_max3_f32 v198, v198, v55, v56
    v_min3_f32 v199, v199, v55, v56
    v_max3_f32 v198, v198, v57, v58
    v_min3_f32 v199, v199, v57, v58
    v_max3_f32 v198, v198, v59, v60
    v_min3_f32 v199, v199, v59, v60
    v_max3_f32 v198, v198, v61, v62
    v_min3_f32 v199, v199, v61, v62
    v_max3_f32 v198, v198, v63, v64
    v_min3_f32 v199, v199, v63, v64
    v_max3_f32 v198, v198, v65, v66
    v_min3_f32 v199, v199, v65, v66
    v_max3_f32 v198, v198, v67, v68
    v_min3_f32 v199, v199, v67, v68
    v_max3_f32 v198, v198, v69, v70
    v_min3_f32 v199, v199, v69, v70
    v_max_f32 v198, v198, v71
    v_min_f32 v199, v199, v71
    v_sub_f32 v152, v52, v198
    v_sub_f32 v172, v199, v52
    v_sub_f32 v153, v53, v198
    v_sub_f32 v173, v199, v53
    v_sub_f32 v154, v54, v198
    v_sub_f32 v174, v199, v54
    v_sub_f32 v155, v55, v198
    v_sub_f32 v175, v199, v55
    v_sub_f32 v156, v56, v198
    v_sub_f32 v176, v199, v56
    v_sub_f32 v157, v57, v198
    v_sub_f32 v177, v199, v57
    v_sub_f32 v158, v58, v198
    v_sub_f32 v178, v199, v58
    v_sub_f32 v159, v59, v198
    v_sub_f32 v179, v199, v59
    v_sub_f32 v160, v60, v198
    v_sub_f32 v180, v199, v60
    v_sub_f32 v161, v61, v198
    v_sub_f32 v181, v199, v61
    v_sub_f32 v162, v62, v198
    v_sub_f32 v182, v199, v62
    v_sub_f32 v163, v63, v198
    v_sub_f32 v183, v199, v63
    v_sub_f32 v164, v64, v198
    v_sub_f32 v184, v199, v64
    v_sub_f32 v165, v65, v198
    v_sub_f32 v185, v199, v65
    v_sub_f32 v166, v66, v198
    v_sub_f32 v186, v199, v66
    v_sub_f32 v167, v67, v198
    v_sub_f32 v187, v199, v67
    v_sub_f32 v168, v68, v198
    v_sub_f32 v188, v199, v68
    v_sub_f32 v169, v69, v198
    v_sub_f32 v189, v199, v69
    v_sub_f32 v170, v70, v198
    v_sub_f32 v190, v199, v70
    v_sub_f32 v171, v71, v198
    v_sub_f32 v191, v199, v71
    v_exp_f32 v152, v152
    v_exp_f32 v153, v153
    v_exp_f32 v154, v154
    v_exp_f32 v155, v155
    v_exp_f32 v156, v156
    v_exp_f32 v157, v157
    v_exp_f32 v158, v158
    v_exp_f32 v159, v159
    v_exp_f32 v160, v160
    v_exp_f32 v161, v161
    v_exp_f32 v162, v162
    v_exp_f32 v163, v163
    v_exp_f32 v164, v164
    v_exp_f32 v165, v165
    v_exp_f32 v166, v166
    v_exp_f32 v167, v167
    v_exp_f32 v168, v168
    v_exp_f32 v169, v169
    v_exp_f32 v170, v170
    v_exp_f32 v171, v171
    v_exp_f32 v172, v172
    v_exp_f32 v173, v173
    v_exp_f32 v174, v174
    v_exp_f32 v175, v175
    v_exp_f32 v176, v176
    v_exp_f32 v177, v177
    v_exp_f32 v178, v178
    v_exp_f32 v179, v179
    v_exp_f32 v180, v180
    v_exp_f32 v181, v181
    v_exp_f32 v182, v182
    v_exp_f32 v183, v183
    v_exp_f32 v184, v184
    v_exp_f32 v185, v185
    v_exp_f32 v186, v186
    v_exp_f32 v187, v187
    v_exp_f32 v188, v188
    v_exp_f32 v189, v189
    v_exp_f32 v190, v190
    v_exp_f32 v191, v191
    v_pk_add_f32 v[198:199], v[152:153], v[154:155]
    v_pk_add_f32 v[200:201], v[172:173], v[174:175]
    v_pk_add_f32 v[198:199], v[198:199], v[156:157]
    v_pk_add_f32 v[200:201], v[200:201], v[176:177]
    v_pk_add_f32 v[198:199], v[198:199], v[158:159]
    v_pk_add_f32 v[200:201], v[200:201], v[178:179]
    v_pk_add_f32 v[198:199], v[198:199], v[160:161]
    v_pk_add_f32 v[200:201], v[200:201], v[180:181]
    v_pk_add_f32 v[198:199], v[198:199], v[162:163]
    v_pk_add_f32 v[200:201], v[200:201], v[182:183]
    v_pk_add_f32 v[198:199], v[198:199], v[164:165]
    v_pk_add_f32 v[200:201], v[200:201], v[184:185]
    v_pk_add_f32 v[198:199], v[198:199], v[166:167]
    v_pk_add_f32 v[200:201], v[200:201], v[186:187]
    v_pk_add_f32 v[198:199], v[198:199], v[168:169]
    v_pk_add_f32 v[200:201], v[200:201], v[188:189]
    v_pk_add_f32 v[198:199], v[198:199], v[170:171]
    v_pk_add_f32 v[200:201], v[200:201], v[190:191]
    v_add_f32 v198, v198, v199
    v_add_f32 v200, v200, v201
    v_rcp_f32 v200, v200
    s_nop 0
    v_mul_f32 v200, v200, v198
    v_pk_mul_f32 v[172:173], v[172:173], v[200:201] op_sel_hi:[1,0]
    v_pk_mul_f32 v[174:175], v[174:175], v[200:201] op_sel_hi:[1,0]
    v_pk_mul_f32 v[176:177], v[176:177], v[200:201] op_sel_hi:[1,0]
    v_pk_mul_f32 v[178:179], v[178:179], v[200:201] op_sel_hi:[1,0]
    v_pk_mul_f32 v[180:181], v[180:181], v[200:201] op_sel_hi:[1,0]
    v_pk_mul_f32 v[182:183], v[182:183], v[200:201] op_sel_hi:[1,0]
    v_pk_mul_f32 v[184:185], v[184:185], v[200:201] op_sel_hi:[1,0]
    v_pk_mul_f32 v[186:187], v[186:187], v[200:201] op_sel_hi:[1,0]
    v_pk_mul_f32 v[188:189], v[188:189], v[200:201] op_sel_hi:[1,0]
    v_pk_mul_f32 v[190:191], v[190:191], v[200:201] op_sel_hi:[1,0]
    s_branch L_q1A_back
L_h2A_retry:
    s_mov_b32 s52, 0
L_h2A_loop:
    buffer_load_dwordx4 v[208:211], v25, s[20:23], s71 offen offset:0 sc1
    buffer_load_dwordx4 v[212:215], v25, s[20:23], s71 offen offset:1024 sc1
    buffer_load_dwordx4 v[216:219], v25, s[20:23], s71 offen offset:2048 sc1
    buffer_load_dwordx4 v[220:223], v231, s[20:23], s71 offen offset:0 sc1
    s_waitcnt vmcnt(0)
    v_xor_b32 v204, s32, v208
    v_bitop3_b32 v204, v204, v209, s38 bitop3:0xf6
    v_bitop3_b32 v204, v204, v210, s32 bitop3:0xf6
    v_bitop3_b32 v204, v204, v211, s38 bitop3:0xf6
    v_bitop3_b32 v204, v204, v212, s32 bitop3:0xf6
    v_bitop3_b32 v204, v204, v213, s38 bitop3:0xf6
    v_bitop3_b32 v204, v204, v214, s32 bitop3:0xf6
    v_bitop3_b32 v204, v204, v215, s38 bitop3:0xf6
    v_bitop3_b32 v204, v204, v216, s32 bitop3:0xf6
    v_bitop3_b32 v204, v204, v217, s38 bitop3:0xf6
    v_bitop3_b32 v204, v204, v218, s32 bitop3:0xf6
    v_bitop3_b32 v204, v204, v219, s38 bitop3:0xf6
    v_bitop3_b32 v204, v204, v220, s32 bitop3:0xf6
    v_bitop3_b32 v204, v204, v221, s38 bitop3:0xf6
    v_bitop3_b32 v204, v204, v222, s32 bitop3:0xf6
    v_bitop3_b32 v204, v204, v223, s38 bitop3:0xf6
    v_and_b32 v204, 0xffff, v204
    v_cmp_ne_u32 vcc, 0, v204
    s_nop 3
    s_cbranch_vccz L_h2A_redo
    s_add_u32 s52, s52, 1
    s_cmp_lt_u32 s52, 100000
    s_cbranch_scc1 L_h2A_loop
L_h2A_redo:
    v_perm_b32 v120, v209, v208, s75
    v_perm_b32 v121, v211, v210, s75
    ds_write_b64 v232, v[120:121]
    v_perm_b32 v122, v213, v212, s75
    v_perm_b32 v123, v215, v214, s75
    ds_write_b64 v233, v[122:123]
    v_perm_b32 v124, v217, v216, s75
    v_perm_b32 v125, v219, v218, s75
    ds_write_b64 v234, v[124:125]
    v_perm_b32 v126, v221, v220, s75
    v_perm_b32 v127, v223, v222, s75
    ds_write_b64 v235, v[126:127]
    s_branch L_h2A_ok
L_f0As_retry:
    s_mov_b32 s52, 0
L_f0As_loop:
    buffer_load_dword v251, v250, s[20:23], s59 offen offset:0 sc1
    s_waitcnt vmcnt(0)
    v_cmp_ne_u32 vcc, s32, v251
    s_nop 3
    s_cbranch_vccz L_f0As_ok
    s_add_u32 s52, s52, 1
    s_cmp_lt_u32 s52, 100000
    s_cbranch_scc1 L_f0As_loop
    s_branch L_f0As_ok
L_f1As_retry:
    s_mov_b32 s52, 0
L_f1As_loop:
    buffer_load_dword v251, v250, s[20:23], s59 offen offset:32 sc1
    s_waitcnt vmcnt(0)
    v_cmp_ne_u32 vcc, s32, v251
    s_nop 3
    s_cbranch_vccz L_f1As_ok
    s_add_u32 s52, s52, 1
    s_cmp_lt_u32 s52, 100000
    s_cbranch_scc1 L_f1As_loop
    s_branch L_f1As_ok
L_d0As_retry:
    s_mov_b32 s52, 0
L_d0As_loop:
    buffer_load_dword v251, v250, s[20:23], s59 offen offset:64 sc1
    s_waitcnt vmcnt(0)
    v_cmp_ne_u32 vcc, s32, v251
    s_nop 3
    s_cbranch_vccz L_d0As_ok
    s_add_u32 s52, s52, 1
    s_cmp_lt_u32 s52, 100000
    s_cbranch_scc1 L_d0As_loop
    s_branch L_d0As_ok
L_d1As_retry:
    s_mov_b32 s52, 0
L_d1As_loop:
    buffer_load_dword v251, v250, s[20:23], s59 offen offset:96 sc1
    s_waitcnt vmcnt(0)
    v_cmp_ne_u32 vcc, s32, v251
    s_nop 3
    s_cbranch_vccz L_d1As_ok
    s_add_u32 s52, s52, 1
    s_cmp_lt_u32 s52, 100000
    s_cbranch_scc1 L_d1As_loop
    s_branch L_d1As_ok
L_tailAs:
    ds_read_b128 a[40:43], v236 offset:1600
    ds_read_b128 a[44:47], v236 offset:1616
    ds_read_b128 a[48:51], v236 offset:1632
    ds_read_b128 a[52:55], v236 offset:1648
    ds_read_b128 a[56:59], v236 offset:1664
    ds_read_b128 a[60:63], v236 offset:0
    ds_read_b128 a[64:67], v236 offset:16
    ds_read_b128 a[68:71], v236 offset:32
    ds_read_b128 a[72:75], v236 offset:48
    ds_read_b128 a[76:79], v236 offset:64
    v_mov_b32 v224, v192
    v_mov_b32 v225, v198
    s_waitcnt lgkmcnt(9)
    v_mfma_f32_16x16x32_bf16 v[92:95], a[40:43], v[32:35], 0
    s_waitcnt lgkmcnt(8)
    ds_read_b128 a[80:83], v236 offset:320
    v_mfma_f32_16x16x32_bf16 v[92:95], a[44:47], v[36:39], v[92:95]
    s_waitcnt lgkmcnt(8)
    ds_read_b128 a[84:87], v236 offset:336
    v_mfma_f32_16x16x32_bf16 v[92:95], a[48:51], v[40:43], v[92:95]
    s_waitcnt lgkmcnt(8)
    ds_read_b128 a[88:91], v236 offset:352
    v_mfma_f32_16x16x32_bf16 v[92:95], a[52:55], v[44:47], v[92:95]
    s_waitcnt lgkmcnt(8)
    ds_read_b128 a[92:95], v236 offset:368
    v_mfma_f32_16x16x32_bf16 v[92:95], a[56:59], v[48:51], v[92:95]
    s_waitcnt lgkmcnt(8)
    ds_read_b128 a[96:99], v236 offset:384
    v_mfma_f32_16x16x32_bf16 v[72:75], a[60:63], v[32:35], 0
    s_waitcnt lgkmcnt(8)
    ds_read_b128 a[100:103], v236 offset:640
    v_mfma_f32_16x16x32_bf16 v[72:75], a[64:67], v[36:39], v[72:75]
    s_waitcnt lgkmcnt(8)
    ds_read_b128 a[104:107], v236 offset:656
    v_mfma_f32_16x16x32_bf16 v[72:75], a[68:71], v[40:43], v[72:75]
    s_waitcnt lgkmcnt(8)
    ds_read_b128 a[108:111], v236 offset:672
    v_mfma_f32_16x16x32_bf16 v[72:75], a[72:75], v[44:47], v[72:75]
    s_waitcnt lgkmcnt(8)
    ds_read_b128 a[112:115], v236 offset:688
    v_fmac_f32 v92, 0x358637bd, v224
    v_mfma_f32_16x16x32_bf16 v[72:75], a[76:79], v[48:51], v[72:75]
    s_waitcnt lgkmcnt(8)
    ds_read_b128 a[116:119], v236 offset:704
    v_rcp_f32 v92, v92
    v_mfma_f32_16x16x32_bf16 v[76:79], a[80:83], v[32:35], 0
    s_waitcnt lgkmcnt(8)
    ds_read_b128 a[120:123], v236 offset:960
    v_mfma_f32_16x16x32_bf16 v[76:79], a[84:87], v[36:39], v[76:79]
    s_waitcnt lgkmcnt(8)
    ds_read_b128 a[124:127], v236 offset:976
    v_mfma_f32_16x16x32_bf16 v[76:79], a[88:91], v[40:43], v[76:79]
    s_waitcnt lgkmcnt(8)
    ds_read_b128 a[128:131], v236 offset:992
    v_mfma_f32_16x16x32_bf16 v[76:79], a[92:95], v[44:47], v[76:79]
    s_waitcnt lgkmcnt(8)
    ds_read_b128 a[132:135], v236 offset:1008
    v_mul_f32 v72, v72, v92
    v_mfma_f32_16x16x32_bf16 v[76:79], a[96:99], v[48:51], v[76:79]
    s_waitcnt lgkmcnt(8)
    ds_read_b128 a[136:139], v236 offset:1024
    v_mul_f32 v73, v73, v92
    v_mfma_f32_16x16x32_bf16 v[80:83], a[100:103], v[32:35], 0
    s_waitcnt lgkmcnt(8)
    ds_read_b128 a[140:143], v236 offset:1280
    v_mul_f32 v74, v74, v92
    v_mfma_f32_16x16x32_bf16 v[80:83], a[104:107], v[36:39], v[80:83]
    s_waitcnt lgkmcnt(8)
    ds_read_b128 a[144:147], v236 offset:1296
    v_mul_f32 v75, v75, v92
    v_mfma_f32_16x16x32_bf16 v[80:83], a[108:111], v[40:43], v[80:83]
    s_waitcnt lgkmcnt(8)
    ds_read_b128 a[148:151], v236 offset:1312
    v_cvt_pk_bf16_f32 v176, v72, v73
    v_mfma_f32_16x16x32_bf16 v[80:83], a[112:115], v[44:47], v[80:83]
    s_waitcnt lgkmcnt(8)
    ds_read_b128 a[152:155], v236 offset:1328
    v_cvt_pk_bf16_f32 v177, v74, v75
    v_mfma_f32_16x16x32_bf16 v[80:83], a[116:119], v[48:51], v[80:83]
    s_waitcnt lgkmcnt(8)
    ds_read_b128 a[156:159], v236 offset:1344
    v_mul_f32 v76, v76, v92
    v_mfma_f32_16x16x32_bf16 v[84:87], a[120:123], v[32:35], 0
    s_waitcnt lgkmcnt(8)
    v_mul_f32 v77, v77, v92
    v_mul_f32 v78, v78, v92
    v_mfma_f32_16x16x32_bf16 v[84:87], a[124:127], v[36:39], v[84:87]
    s_waitcnt lgkmcnt(7)
    v_mul_f32 v79, v79, v92
    v_cvt_pk_bf16_f32 v178, v76, v77
    v_mfma_f32_16x16x32_bf16 v[84:87], a[128:131], v[40:43], v[84:87]
    s_waitcnt lgkmcnt(6)
    v_cvt_pk_bf16_f32 v179, v78, v79
    v_mfma_f32_16x16x32_bf16 v[84:87], a[132:135], v[44:47], v[84:87]
    s_waitcnt lgkmcnt(5)
    buffer_store_dwordx4 v[176:179], v7, s[28:31], s60 offen sc1
    v_mfma_f32_16x16x32_bf16 v[84:87], a[136:139], v[48:51], v[84:87]
    s_waitcnt lgkmcnt(4)
    v_mul_f32 v80, v80, v92
    v_mul_f32 v81, v81, v92
    v_mfma_f32_16x16x32_bf16 v[116:119], a[40:43], v[52:55], 0
    v_mul_f32 v82, v82, v92
    v_mul_f32 v83, v83, v92
    v_mfma_f32_16x16x32_bf16 v[116:119], a[44:47], v[56:59], v[116:119]
    v_cvt_pk_bf16_f32 v184, v80, v81
    v_cvt_pk_bf16_f32 v185, v82, v83
    v_mfma_f32_16x16x32_bf16 v[116:119], a[48:51], v[60:63], v[116:119]
    ds_read_b128 v[148:151], v25 offset:0
    v_mfma_f32_16x16x32_bf16 v[116:119], a[52:55], v[64:67], v[116:119]
    v_mul_f32 v84, v84, v92
    v_mul_f32 v85, v85, v92
    v_mfma_f32_16x16x32_bf16 v[116:119], a[56:59], v[68:71], v[116:119]
    v_mul_f32 v86, v86, v92
    v_mul_f32 v87, v87, v92
    v_mfma_f32_16x16x32_bf16 v[96:99], a[60:63], v[52:55], 0
    v_cvt_pk_bf16_f32 v186, v84, v85
    v_cvt_pk_bf16_f32 v187, v86, v87
    v_mfma_f32_16x16x32_bf16 v[96:99], a[64:67], v[56:59], v[96:99]
    buffer_store_dwordx4 v[184:187], v8, s[28:31], s60 offen sc1
    v_mfma_f32_16x16x32_bf16 v[96:99], a[68:71], v[60:63], v[96:99]
    ds_read_b128 v[152:155], v25 offset:1024
    v_mfma_f32_16x16x32_bf16 v[96:99], a[72:75], v[64:67], v[96:99]
    v_fmac_f32 v116, 0x358637bd, v225
    v_mfma_f32_16x16x32_bf16 v[96:99], a[76:79], v[68:71], v[96:99]
    v_rcp_f32 v116, v116
    v_mfma_f32_16x16x32_bf16 v[100:103], a[80:83], v[52:55], 0
    ds_read_b128 v[156:159], v25 offset:2048
    v_mfma_f32_16x16x32_bf16 v[100:103], a[84:87], v[56:59], v[100:103]
    ds_read_b128 v[160:163], v25 offset:3072
    v_mfma_f32_16x16x32_bf16 v[100:103], a[88:91], v[60:63], v[100:103]
    ds_read_b128 v[164:167], v25 offset:4096
    v_mfma_f32_16x16x32_bf16 v[100:103], a[92:95], v[64:67], v[100:103]
    v_mul_f32 v96, v96, v116
    v_mul_f32 v97, v97, v116
    v_mfma_f32_16x16x32_bf16 v[100:103], a[96:99], v[68:71], v[100:103]
    v_mul_f32 v98, v98, v116
    v_mul_f32 v99, v99, v116
    v_mfma_f32_16x16x32_bf16 v[104:107], a[100:103], v[52:55], 0
    v_cvt_pk_bf16_f32 v180, v96, v97
    v_cvt_pk_bf16_f32 v181, v98, v99
    v_mfma_f32_16x16x32_bf16 v[104:107], a[104:107], v[56:59], v[104:107]
    ds_read_b128 v[168:171], v25 offset:5120
    v_mfma_f32_16x16x32_bf16 v[104:107], a[108:111], v[60:63], v[104:107]
    v_mfma_f32_16x16x32_bf16 v[104:107], a[112:115], v[64:67], v[104:107]
    v_mul_f32 v100, v100, v116
    v_mul_f32 v101, v101, v116
    v_mfma_f32_16x16x32_bf16 v[104:107], a[116:119], v[68:71], v[104:107]
    v_mul_f32 v102, v102, v116
    v_mul_f32 v103, v103, v116
    v_mfma_f32_16x16x32_bf16 v[108:111], a[120:123], v[52:55], 0
    v_cvt_pk_bf16_f32 v182, v100, v101
    v_cvt_pk_bf16_f32 v183, v102, v103
    v_mfma_f32_16x16x32_bf16 v[108:111], a[124:127], v[56:59], v[108:111]
    buffer_store_dwordx4 v[180:183], v9, s[28:31], s60 offen sc1
    v_mfma_f32_16x16x32_bf16 v[108:111], a[128:131], v[60:63], v[108:111]
    v_mfma_f32_16x16x32_bf16 v[108:111], a[132:135], v[64:67], v[108:111]
    v_mul_f32 v104, v104, v116
    v_mul_f32 v105, v105, v116
    v_mfma_f32_16x16x32_bf16 v[108:111], a[136:139], v[68:71], v[108:111]
    v_mul_f32 v106, v106, v116
    v_mul_f32 v107, v107, v116
    v_mfma_f32_16x16x32_bf16 v[88:91], a[140:143], v[32:35], 0
    s_waitcnt lgkmcnt(9)
    v_cvt_pk_bf16_f32 v188, v104, v105
    v_cvt_pk_bf16_f32 v189, v106, v107
    v_mfma_f32_16x16x32_bf16 v[88:91], a[144:147], v[36:39], v[88:91]
    s_waitcnt lgkmcnt(8)
    v_mfma_f32_16x16x32_bf16 v[88:91], a[148:151], v[40:43], v[88:91]
    s_waitcnt lgkmcnt(7)
    v_mfma_f32_16x16x32_bf16 v[88:91], a[152:155], v[44:47], v[88:91]
    s_waitcnt lgkmcnt(6)
    s_waitcnt vmcnt(1)
    buffer_store_dword v254, v255, s[20:23], s59 offen offset:0 sc1
    v_mfma_f32_16x16x32_bf16 v[88:91], a[156:159], v[48:51], v[88:91]
    v_mul_f32 v108, v108, v116
    v_mul_f32 v109, v109, v116
    v_mfma_f32_16x16x32_bf16 v[112:115], a[140:143], v[52:55], 0
    v_mul_f32 v110, v110, v116
    v_mul_f32 v111, v111, v116
    v_mfma_f32_16x16x32_bf16 v[112:115], a[144:147], v[56:59], v[112:115]
    v_cvt_pk_bf16_f32 v190, v108, v109
    v_cvt_pk_bf16_f32 v191, v110, v111
    v_mfma_f32_16x16x32_bf16 v[112:115], a[148:151], v[60:63], v[112:115]
    buffer_store_dwordx4 v[188:191], v10, s[28:31], s60 offen sc1
    v_mfma_f32_16x16x32_bf16 v[112:115], a[152:155], v[64:67], v[112:115]
    v_mul_f32 v88, v88, v92
    v_mul_f32 v89, v89, v92
    v_mfma_f32_16x16x32_bf16 v[112:115], a[156:159], v[68:71], v[112:115]
    v_mul_f32 v90, v90, v92
    v_mul_f32 v91, v91, v92
    v_cvt_pk_bf16_f32 v192, v88, v89
    v_cvt_pk_bf16_f32 v193, v90, v91
    s_waitcnt lgkmcnt(5)
    v_mfma_f32_16x16x32_bf16 v[32:35], v[148:151], v[176:179], 0
    s_waitcnt lgkmcnt(4)
    ds_read_b128 v[172:175], v25 offset:6144
    v_mfma_f32_16x16x32_bf16 v[52:55], v[148:151], v[180:183], 0
    v_mfma_f32_16x16x32_bf16 v[36:39], v[152:155], v[176:179], 0
    s_waitcnt lgkmcnt(4)
    ds_read_b128 v[148:151], v25 offset:7168
    v_mfma_f32_16x16x32_bf16 v[56:59], v[152:155], v[180:183], 0
    v_mul_f32 v112, v112, v116
    v_mul_f32 v113, v113, v116
    v_mul_f32 v114, v114, v116
    v_mfma_f32_16x16x32_bf16 v[40:43], v[156:159], v[176:179], 0
    s_waitcnt lgkmcnt(4)
    ds_read_b128 v[152:155], v25 offset:8192
    v_mfma_f32_16x16x32_bf16 v[60:63], v[156:159], v[180:183], 0
    v_mul_f32 v115, v115, v116
    v_cvt_pk_bf16_f32 v194, v112, v113
    v_cvt_pk_bf16_f32 v195, v114, v115
    v_mfma_f32_16x16x32_bf16 v[44:47], v[160:163], v[176:179], 0
    s_waitcnt lgkmcnt(4)
    ds_read_b128 v[156:159], v25 offset:9216
    v_mfma_f32_16x16x32_bf16 v[64:67], v[160:163], v[180:183], 0
    buffer_store_dwordx4 v[192:195], v11, s[28:31], s60 offen sc1
    v_mfma_f32_16x16x32_bf16 v[48:51], v[164:167], v[176:179], 0
    s_waitcnt lgkmcnt(4)
    ds_read_b128 a[128:131], v25 offset:10240
    v_mfma_f32_16x16x32_bf16 v[68:71], v[164:167], v[180:183], 0
    buffer_load_dword v251, v250, s[20:23], s59 offen offset:0 sc1
    v_mfma_f32_16x16x32_bf16 v[32:35], v[168:171], v[184:187], v[32:35]
    s_waitcnt lgkmcnt(4)
    ds_read_b128 a[132:135], v25 offset:11264
    ds_read_b128 a[136:139], v25 offset:12288
    v_mfma_f32_16x16x32_bf16 v[52:55], v[168:171], v[188:191], v[52:55]
    v_mfma_f32_16x16x32_bf16 v[36:39], v[172:175], v[184:187], v[36:39]
    s_waitcnt lgkmcnt(5)
    ds_read_b128 a[140:143], v25 offset:13312
    ds_read_b128 a[144:147], v25 offset:14336
    v_mfma_f32_16x16x32_bf16 v[56:59], v[172:175], v[188:191], v[56:59]
    v_mfma_f32_16x16x32_bf16 v[40:43], v[148:151], v[184:187], v[40:43]
    s_waitcnt lgkmcnt(6)
    ds_read_b128 a[148:151], v25 offset:15360
    ds_read_b128 a[152:155], v25 offset:16384
    v_mfma_f32_16x16x32_bf16 v[60:63], v[148:151], v[188:191], v[60:63]
    v_mfma_f32_16x16x32_bf16 v[44:47], v[152:155], v[184:187], v[44:47]
    s_waitcnt lgkmcnt(7)
    ds_read_b128 a[156:159], v25 offset:17408
    ds_read_b128 a[160:163], v25 offset:18432
    v_mfma_f32_16x16x32_bf16 v[64:67], v[152:155], v[188:191], v[64:67]
    v_mfma_f32_16x16x32_bf16 v[48:51], v[156:159], v[184:187], v[48:51]
    s_waitcnt lgkmcnt(8)
    ds_read_b128 a[164:167], v25 offset:19456
    ds_read_b128 a[168:171], v25 offset:20480
    v_mfma_f32_16x16x32_bf16 v[68:71], v[156:159], v[188:191], v[68:71]
    s_waitcnt lgkmcnt(0)
    ds_read_b128 a[172:175], v25 offset:21504
    ds_read_b128 a[176:179], v25 offset:22528
    ds_read_b128 a[180:183], v25 offset:23552
    ds_read_b128 a[184:187], v25 offset:24576
    ds_read_b128 a[188:191], v25 offset:25600
    ds_read_b128 a[192:195], v25 offset:26624
    ds_read_b128 a[196:199], v25 offset:27648
    ds_read_b128 a[200:203], v25 offset:28672
    ds_read_b128 a[204:207], v25 offset:29696
    ds_read_b128 a[208:211], v25 offset:30720
    ds_read_b128 a[212:215], v25 offset:31744
    ds_read_b128 a[216:219], v25 offset:32768
    ds_read_b128 a[220:223], v25 offset:33792
    ds_read_b128 a[224:227], v25 offset:34816
    s_waitcnt vmcnt(1)
    buffer_store_dword v254, v255, s[20:23], s59 offen offset:32 sc1
    s_waitcnt vmcnt(1)
    v_cmp_ne_u32 vcc, s32, v251
    s_nop 3
    s_cbranch_vccnz L_f0As_retry
L_f0As_ok:
    buffer_load_dwordx4 a[16:19], v7, s[28:31], s61 offen sc1
    buffer_load_dwordx4 a[24:27], v8, s[28:31], s61 offen sc1
    buffer_load_dwordx4 a[32:35], v7, s[28:31], s62 offen sc1
    buffer_load_dwordx4 a[40:43], v8, s[28:31], s62 offen sc1
    buffer_load_dword v251, v250, s[20:23], s59 offen offset:32 sc1
    buffer_load_dwordx4 a[48:51], v7, s[28:31], s63 offen sc1
    buffer_load_dwordx4 a[56:59], v8, s[28:31], s63 offen sc1
    buffer_load_dwordx4 a[64:67], v7, s[28:31], s64 offen sc1
    s_waitcnt lgkmcnt(0)
    ds_read_b128 a[228:231], v25 offset:35840
    ds_read_b128 a[232:235], v25 offset:36864
    ds_read_b128 a[236:239], v25 offset:37888
    ds_read_b128 a[240:243], v25 offset:38912
    ds_read_b128 a[244:247], v25 offset:39936
    ds_read_b128 a[248:251], v25 offset:40960
    ds_read_b128 a[252:255], v25 offset:41984
    ds_read_b128 v[72:75], v25 offset:43008
    ds_read_b128 v[76:79], v25 offset:44032
    ds_read_b128 v[80:83], v25 offset:45056
    ds_read_b128 v[84:87], v25 offset:46080
    ds_read_b128 v[88:91], v25 offset:47104
    ds_read_b128 v[92:95], v25 offset:48128
    ds_read_b128 v[96:99], v25 offset:49152
    s_waitcnt vmcnt(7)
    v_mfma_f32_16x16x32_bf16 v[32:35], a[128:131], a[16:19], v[32:35]
    v_mfma_f32_16x16x32_bf16 v[36:39], a[132:135], a[16:19], v[36:39]
    v_mfma_f32_16x16x32_bf16 v[40:43], a[136:139], a[16:19], v[40:43]
    v_mfma_f32_16x16x32_bf16 v[44:47], a[140:143], a[16:19], v[44:47]
    v_mfma_f32_16x16x32_bf16 v[48:51], a[144:147], a[16:19], v[48:51]
    s_waitcnt vmcnt(6)
    buffer_load_dwordx4 a[72:75], v8, s[28:31], s64 offen sc1
    v_mfma_f32_16x16x32_bf16 v[32:35], a[148:151], a[24:27], v[32:35]
    s_waitcnt vmcnt(4)
    v_cmp_ne_u32 vcc, s32, v251
    v_mfma_f32_16x16x32_bf16 v[36:39], a[152:155], a[24:27], v[36:39]
    v_mfma_f32_16x16x32_bf16 v[40:43], a[156:159], a[24:27], v[40:43]
    s_nop 1
    s_cbranch_vccnz L_f1As_retry
L_f1As_ok:
    v_mfma_f32_16x16x32_bf16 v[44:47], a[160:163], a[24:27], v[44:47]
    v_mfma_f32_16x16x32_bf16 v[48:51], a[164:167], a[24:27], v[48:51]
    buffer_load_dwordx4 a[80:83], v7, s[28:31], s65 offen sc1
    v_mfma_f32_16x16x32_bf16 v[32:35], a[168:171], a[32:35], v[32:35]
    v_mfma_f32_16x16x32_bf16 v[36:39], a[172:175], a[32:35], v[36:39]
    v_mfma_f32_16x16x32_bf16 v[40:43], a[176:179], a[32:35], v[40:43]
    v_mfma_f32_16x16x32_bf16 v[44:47], a[180:183], a[32:35], v[44:47]
    buffer_load_dwordx4 a[84:87], v9, s[28:31], s65 offen sc1
    v_mfma_f32_16x16x32_bf16 v[48:51], a[184:187], a[32:35], v[48:51]
    v_mfma_f32_16x16x32_bf16 v[32:35], a[188:191], a[40:43], v[32:35]
    v_mfma_f32_16x16x32_bf16 v[36:39], a[192:195], a[40:43], v[36:39]
    v_mfma_f32_16x16x32_bf16 v[40:43], a[196:199], a[40:43], v[40:43]
    v_mfma_f32_16x16x32_bf16 v[44:47], a[200:203], a[40:43], v[44:47]
    buffer_load_dwordx4 a[88:91], v8, s[28:31], s65 offen sc1
    v_mfma_f32_16x16x32_bf16 v[48:51], a[204:207], a[40:43], v[48:51]
    s_waitcnt vmcnt(6)
    v_mfma_f32_16x16x32_bf16 v[32:35], a[208:211], a[48:51], v[32:35]
    v_mfma_f32_16x16x32_bf16 v[36:39], a[212:215], a[48:51], v[36:39]
    v_mfma_f32_16x16x32_bf16 v[40:43], a[216:219], a[48:51], v[40:43]
    buffer_load_dwordx4 a[92:95], v10, s[28:31], s65 offen sc1
    v_mfma_f32_16x16x32_bf16 v[44:47], a[220:223], a[48:51], v[44:47]
    v_mfma_f32_16x16x32_bf16 v[48:51], a[224:227], a[48:51], v[48:51]
    s_waitcnt vmcnt(6) lgkmcnt(13)
    v_mfma_f32_16x16x32_bf16 v[32:35], a[228:231], a[56:59], v[32:35]
    s_waitcnt lgkmcnt(12)
    v_mfma_f32_16x16x32_bf16 v[36:39], a[232:235], a[56:59], v[36:39]
    s_waitcnt lgkmcnt(11)
    v_mfma_f32_16x16x32_bf16 v[40:43], a[236:239], a[56:59], v[40:43]
    s_waitcnt lgkmcnt(10)
    ds_read_b128 v[100:103], v25 offset:50176
    buffer_load_dwordx4 a[96:99], v7, s[28:31], s66 offen sc1
    v_mfma_f32_16x16x32_bf16 v[44:47], a[240:243], a[56:59], v[44:47]
    s_waitcnt lgkmcnt(10)
    ds_read_b128 v[160:163], v12 offset:0
    v_mfma_f32_16x16x32_bf16 v[48:51], a[244:247], a[56:59], v[48:51]
    s_waitcnt vmcnt(6) lgkmcnt(10)
    v_mfma_f32_16x16x32_bf16 v[32:35], a[248:251], a[64:67], v[32:35]
    s_waitcnt lgkmcnt(9)
    ds_read_b128 v[164:167], v12 offset:1024
    v_mfma_f32_16x16x32_bf16 v[36:39], a[252:255], a[64:67], v[36:39]
    s_waitcnt lgkmcnt(9)
    v_mfma_f32_16x16x32_bf16 v[40:43], v[72:75], a[64:67], v[40:43]
    s_waitcnt lgkmcnt(8)
    ds_read_b128 v[168:171], v12 offset:2048
    buffer_load_dwordx4 a[100:103], v9, s[28:31], s66 offen sc1
    v_mfma_f32_16x16x32_bf16 v[44:47], v[76:79], a[64:67], v[44:47]
    s_waitcnt lgkmcnt(8)
    v_mfma_f32_16x16x32_bf16 v[48:51], v[80:83], a[64:67], v[48:51]
    s_waitcnt vmcnt(6) lgkmcnt(7)
    ds_read_b128 v[172:175], v12 offset:3072
    v_mfma_f32_16x16x32_bf16 v[32:35], v[84:87], a[72:75], v[32:35]
    s_waitcnt lgkmcnt(7)
    v_mfma_f32_16x16x32_bf16 v[36:39], v[88:91], a[72:75], v[36:39]
    s_waitcnt lgkmcnt(6)
    ds_read_b128 v[148:151], v12 offset:4096
    buffer_load_dwordx4 a[104:107], v8, s[28:31], s66 offen sc1
    v_mfma_f32_16x16x32_bf16 v[40:43], v[92:95], a[72:75], v[40:43]
    s_waitcnt lgkmcnt(6)
    v_mfma_f32_16x16x32_bf16 v[44:47], v[96:99], a[72:75], v[44:47]
    s_waitcnt lgkmcnt(5)
    ds_read_b128 v[152:155], v12 offset:5120
    v_mfma_f32_16x16x32_bf16 v[48:51], v[100:103], a[72:75], v[48:51]
    s_waitcnt vmcnt(5) lgkmcnt(5)
    v_mfma_f32_16x16x32_bf16 v[32:35], v[160:163], a[80:83], v[32:35]
    s_waitcnt lgkmcnt(4)
    ds_read_b128 v[156:159], v12 offset:6144
    v_mfma_f32_16x16x32_bf16 v[52:55], v[160:163], a[84:87], v[52:55]
    buffer_load_dwordx4 a[108:111], v10, s[28:31], s66 offen sc1
    v_mfma_f32_16x16x32_bf16 v[36:39], v[164:167], a[80:83], v[36:39]
    s_waitcnt lgkmcnt(4)
    ds_read_b128 v[160:163], v12 offset:7168
    v_mfma_f32_16x16x32_bf16 v[56:59], v[164:167], a[84:87], v[56:59]
    v_mfma_f32_16x16x32_bf16 v[40:43], v[168:171], a[80:83], v[40:43]
    s_waitcnt lgkmcnt(4)
    ds_read_b128 v[164:167], v12 offset:8192
    v_mfma_f32_16x16x32_bf16 v[60:63], v[168:171], a[84:87], v[60:63]
    buffer_load_dwordx4 a[112:115], v7, s[28:31], s67 offen sc1
    v_mfma_f32_16x16x32_bf16 v[44:47], v[172:175], a[80:83], v[44:47]
    s_waitcnt lgkmcnt(4)
    ds_read_b128 v[168:171], v12 offset:9216
    v_mfma_f32_16x16x32_bf16 v[64:67], v[172:175], a[84:87], v[64:67]
    v_mfma_f32_16x16x32_bf16 v[48:51], v[148:151], a[80:83], v[48:51]
    s_waitcnt vmcnt(5) lgkmcnt(4)
    ds_read_b128 v[172:175], v226 offset:0
    v_mfma_f32_16x16x32_bf16 v[68:71], v[148:151], a[84:87], v[68:71]
    v_mfma_f32_16x16x32_bf16 v[32:35], v[152:155], a[88:91], v[32:35]
    s_waitcnt lgkmcnt(4)
    ds_read_b128 v[148:151], v226 offset:1024
    v_mfma_f32_16x16x32_bf16 v[52:55], v[152:155], a[92:95], v[52:55]
    buffer_load_dwordx4 a[116:119], v9, s[28:31], s67 offen sc1
    v_mfma_f32_16x16x32_bf16 v[36:39], v[156:159], a[88:91], v[36:39]
    s_waitcnt lgkmcnt(4)
    ds_read_b128 v[152:155], v226 offset:2048
    v_mfma_f32_16x16x32_bf16 v[56:59], v[156:159], a[92:95], v[56:59]
    v_mfma_f32_16x16x32_bf16 v[40:43], v[160:163], a[88:91], v[40:43]
    s_waitcnt lgkmcnt(4)
    ds_read_b128 v[156:159], v226 offset:3072
    v_mfma_f32_16x16x32_bf16 v[60:63], v[160:163], a[92:95], v[60:63]
    buffer_load_dwordx4 a[120:123], v8, s[28:31], s67 offen sc1
    v_mfma_f32_16x16x32_bf16 v[44:47], v[164:167], a[88:91], v[44:47]
    s_waitcnt lgkmcnt(4)
    ds_read_b128 v[160:163], v226 offset:4096
    v_mfma_f32_16x16x32_bf16 v[64:67], v[164:167], a[92:95], v[64:67]
    v_mfma_f32_16x16x32_bf16 v[48:51], v[168:171], a[88:91], v[48:51]
    s_waitcnt vmcnt(5) lgkmcnt(4)
    ds_read_b128 v[164:167], v226 offset:5120
    v_mfma_f32_16x16x32_bf16 v[68:71], v[168:171], a[92:95], v[68:71]
    buffer_load_dwordx4 a[124:127], v10, s[28:31], s67 offen sc1
    v_mfma_f32_16x16x32_bf16 v[32:35], v[172:175], a[96:99], v[32:35]
    s_waitcnt lgkmcnt(4)
    ds_read_b128 v[168:171], v226 offset:6144
    v_mfma_f32_16x16x32_bf16 v[52:55], v[172:175], a[100:103], v[52:55]
    v_mfma_f32_16x16x32_bf16 v[36:39], v[148:151], a[96:99], v[36:39]
    s_waitcnt lgkmcnt(4)
    ds_read_b128 v[172:175], v226 offset:7168
    v_mfma_f32_16x16x32_bf16 v[56:59], v[148:151], a[100:103], v[56:59]
    v_mfma_f32_16x16x32_bf16 v[40:43], v[152:155], a[96:99], v[40:43]
    s_waitcnt lgkmcnt(4)
    ds_read_b128 v[148:151], v226 offset:8192
    v_mfma_f32_16x16x32_bf16 v[60:63], v[152:155], a[100:103], v[60:63]
    buffer_load_dwordx4 v[196:199], v11, s[28:31], s61 offen sc1
    v_mfma_f32_16x16x32_bf16 v[44:47], v[156:159], a[96:99], v[44:47]
    s_waitcnt lgkmcnt(4)
    ds_read_b128 v[152:155], v226 offset:9216
    v_mfma_f32_16x16x32_bf16 v[64:67], v[156:159], a[100:103], v[64:67]
    v_mfma_f32_16x16x32_bf16 v[48:51], v[160:163], a[96:99], v[48:51]
    s_waitcnt vmcnt(5) lgkmcnt(4)
    ds_read_b128 v[156:159], v226 offset:10240
    v_mfma_f32_16x16x32_bf16 v[68:71], v[160:163], a[100:103], v[68:71]
    buffer_load_dwordx4 v[200:203], v11, s[28:31], s62 offen sc1
    v_mfma_f32_16x16x32_bf16 v[32:35], v[164:167], a[104:107], v[32:35]
    s_waitcnt lgkmcnt(4)
    ds_read_b128 v[160:163], v226 offset:11264
    v_mfma_f32_16x16x32_bf16 v[52:55], v[164:167], a[108:111], v[52:55]
    v_mfma_f32_16x16x32_bf16 v[36:39], v[168:171], a[104:107], v[36:39]
    s_waitcnt lgkmcnt(4)
    ds_read_b128 v[164:167], v226 offset:12288
    v_mfma_f32_16x16x32_bf16 v[56:59], v[168:171], a[108:111], v[56:59]
    buffer_load_dwordx4 v[204:207], v11, s[28:31], s63 offen sc1
    v_mfma_f32_16x16x32_bf16 v[40:43], v[172:175], a[104:107], v[40:43]
    s_waitcnt lgkmcnt(4)
    ds_read_b128 v[168:171], v226 offset:13312
    v_mfma_f32_16x16x32_bf16 v[60:63], v[172:175], a[108:111], v[60:63]
    v_mfma_f32_16x16x32_bf16 v[44:47], v[148:151], a[104:107], v[44:47]
    s_waitcnt lgkmcnt(4)
    ds_read_b128 v[172:175], v226 offset:14336
    v_mfma_f32_16x16x32_bf16 v[64:67], v[148:151], a[108:111], v[64:67]
    v_mfma_f32_16x16x32_bf16 v[48:51], v[152:155], a[104:107], v[48:51]
    s_waitcnt vmcnt(5) lgkmcnt(4)
    ds_read_b128 v[148:151], v226 offset:15360
    v_mfma_f32_16x16x32_bf16 v[68:71], v[152:155], a[108:111], v[68:71]
    buffer_load_dwordx4 v[208:211], v11, s[28:31], s64 offen sc1
    v_mfma_f32_16x16x32_bf16 v[32:35], v[156:159], a[112:115], v[32:35]
    s_waitcnt lgkmcnt(4)
    ds_read_b128 v[152:155], v226 offset:16384
    v_mfma_f32_16x16x32_bf16 v[52:55], v[156:159], a[116:119], v[52:55]
    v_mfma_f32_16x16x32_bf16 v[36:39], v[160:163], a[112:115], v[36:39]
    s_waitcnt lgkmcnt(4)
    ds_read_b128 v[156:159], v226 offset:17408
    v_mfma_f32_16x16x32_bf16 v[56:59], v[160:163], a[116:119], v[56:59]
    buffer_load_dwordx4 v[212:215], v11, s[28:31], s65 offen sc1
    v_mfma_f32_16x16x32_bf16 v[40:43], v[164:167], a[112:115], v[40:43]
    s_waitcnt lgkmcnt(4)
    ds_read_b128 v[160:163], v226 offset:18432
    v_mfma_f32_16x16x32_bf16 v[60:63], v[164:167], a[116:119], v[60:63]
    v_mfma_f32_16x16x32_bf16 v[44:47], v[168:171], a[112:115], v[44:47]
    s_waitcnt lgkmcnt(4)
    ds_read_b128 v[164:167], v226 offset:19456
    v_mfma_f32_16x16x32_bf16 v[64:67], v[168:171], a[116:119], v[64:67]
    buffer_load_dwordx4 v[216:219], v11, s[28:31], s66 offen sc1
    v_mfma_f32_16x16x32_bf16 v[48:51], v[172:175], a[112:115], v[48:51]
    s_waitcnt vmcnt(6) lgkmcnt(4)
    ds_read_b128 v[168:171], v226 offset:20480
    v_mfma_f32_16x16x32_bf16 v[68:71], v[172:175], a[116:119], v[68:71]
    v_mfma_f32_16x16x32_bf16 v[32:35], v[148:151], a[120:123], v[32:35]
    s_waitcnt lgkmcnt(4)
    ds_read_b128 v[172:175], v226 offset:21504
    v_mfma_f32_16x16x32_bf16 v[52:55], v[148:151], a[124:127], v[52:55]
    buffer_load_dwordx4 v[220:223], v11, s[28:31], s67 offen sc1
    v_mfma_f32_16x16x32_bf16 v[36:39], v[152:155], a[120:123], v[36:39]
    s_waitcnt lgkmcnt(4)
    ds_read_b128 v[148:151], v226 offset:22528
    v_mfma_f32_16x16x32_bf16 v[56:59], v[152:155], a[124:127], v[56:59]
    v_mfma_f32_16x16x32_bf16 v[40:43], v[156:159], a[120:123], v[40:43]
    s_waitcnt lgkmcnt(4)
    ds_read_b128 v[152:155], v226 offset:23552
    v_mfma_f32_16x16x32_bf16 v[60:63], v[156:159], a[124:127], v[60:63]
    v_mfma_f32_16x16x32_bf16 v[44:47], v[160:163], a[120:123], v[44:47]
    s_waitcnt vmcnt(6) lgkmcnt(4)
    ds_read_b128 v[156:159], v226 offset:24576
    v_mfma_f32_16x16x32_bf16 v[64:67], v[160:163], a[124:127], v[64:67]
    v_swap_b32 v194, v196
    v_swap_b32 v195, v197
    v_mfma_f32_16x16x32_bf16 v[48:51], v[164:167], a[120:123], v[48:51]
    s_waitcnt lgkmcnt(4)
    ds_read_b128 v[160:163], v226 offset:25600
    v_mfma_f32_16x16x32_bf16 v[68:71], v[164:167], a[124:127], v[68:71]
    buffer_load_dwordx4 a[20:23], v9, s[28:31], s61 offen sc1
    v_mfma_f32_16x16x32_bf16 v[32:35], v[168:171], v[192:195], v[32:35]
    s_waitcnt lgkmcnt(4)
    ds_read_b128 v[164:167], v226 offset:26624
    v_mfma_f32_16x16x32_bf16 v[52:55], v[168:171], v[196:199], v[52:55]
    buffer_load_dwordx4 a[28:31], v10, s[28:31], s61 offen sc1
    v_mfma_f32_16x16x32_bf16 v[36:39], v[172:175], v[192:195], v[36:39]
    s_waitcnt lgkmcnt(4)
    ds_read_b128 v[168:171], v226 offset:27648
    v_mfma_f32_16x16x32_bf16 v[56:59], v[172:175], v[196:199], v[56:59]
    v_mfma_f32_16x16x32_bf16 v[40:43], v[148:151], v[192:195], v[40:43]
    s_waitcnt lgkmcnt(4)
    ds_read_b128 v[172:175], v226 offset:28672
    v_mfma_f32_16x16x32_bf16 v[60:63], v[148:151], v[196:199], v[60:63]
    buffer_load_dwordx4 a[36:39], v9, s[28:31], s62 offen sc1
    v_mfma_f32_16x16x32_bf16 v[44:47], v[152:155], v[192:195], v[44:47]
    s_waitcnt vmcnt(7) lgkmcnt(4)
    ds_read_b128 v[148:151], v226 offset:29696
    v_mfma_f32_16x16x32_bf16 v[64:67], v[152:155], v[196:199], v[64:67]
    v_swap_b32 v202, v204
    v_swap_b32 v203, v205
    v_mfma_f32_16x16x32_bf16 v[48:51], v[156:159], v[192:195], v[48:51]
    s_waitcnt lgkmcnt(4)
    ds_read_b128 v[152:155], v226 offset:30720
    v_mfma_f32_16x16x32_bf16 v[68:71], v[156:159], v[196:199], v[68:71]
    v_mfma_f32_16x16x32_bf16 v[32:35], v[160:163], v[200:203], v[32:35]
    s_waitcnt lgkmcnt(4)
    ds_read_b128 v[156:159], v226 offset:31744
    v_mfma_f32_16x16x32_bf16 v[52:55], v[160:163], v[204:207], v[52:55]
    buffer_load_dwordx4 a[44:47], v10, s[28:31], s62 offen sc1
    v_mfma_f32_16x16x32_bf16 v[36:39], v[164:167], v[200:203], v[36:39]
    s_waitcnt lgkmcnt(4)
    ds_read_b128 v[160:163], v226 offset:32768
    v_mfma_f32_16x16x32_bf16 v[56:59], v[164:167], v[204:207], v[56:59]
    v_mfma_f32_16x16x32_bf16 v[40:43], v[168:171], v[200:203], v[40:43]
    s_waitcnt lgkmcnt(4)
    ds_read_b128 v[164:167], v226 offset:33792
    v_mfma_f32_16x16x32_bf16 v[60:63], v[168:171], v[204:207], v[60:63]
    buffer_load_dwordx4 a[52:55], v9, s[28:31], s63 offen sc1
    v_mfma_f32_16x16x32_bf16 v[44:47], v[172:175], v[200:203], v[44:47]
    s_waitcnt vmcnt(7) lgkmcnt(4)
    ds_read_b128 v[168:171], v226 offset:34816
    v_mfma_f32_16x16x32_bf16 v[64:67], v[172:175], v[204:207], v[64:67]
    v_swap_b32 v210, v212
    v_swap_b32 v211, v213
    v_mfma_f32_16x16x32_bf16 v[48:51], v[148:151], v[200:203], v[48:51]
    s_waitcnt vmcnt(5) lgkmcnt(4)
    ds_read_b128 v[172:175], v226 offset:35840
    v_mfma_f32_16x16x32_bf16 v[68:71], v[148:151], v[204:207], v[68:71]
    buffer_store_dword v254, v255, s[20:23], s59 offen offset:64 sc1
    v_mfma_f32_16x16x32_bf16 v[32:35], v[152:155], v[208:211], v[32:35]
    s_waitcnt lgkmcnt(4)
    ds_read_b128 v[148:151], v226 offset:36864
    v_mfma_f32_16x16x32_bf16 v[52:55], v[152:155], v[212:215], v[52:55]
    buffer_load_dwordx4 a[60:63], v10, s[28:31], s63 offen sc1
    v_mfma_f32_16x16x32_bf16 v[36:39], v[156:159], v[208:211], v[36:39]
    s_waitcnt lgkmcnt(4)
    ds_read_b128 v[152:155], v226 offset:37888
    v_mfma_f32_16x16x32_bf16 v[56:59], v[156:159], v[212:215], v[56:59]
    v_mfma_f32_16x16x32_bf16 v[40:43], v[160:163], v[208:211], v[40:43]
    s_waitcnt lgkmcnt(4)
    ds_read_b128 v[156:159], v226 offset:38912
    v_mfma_f32_16x16x32_bf16 v[60:63], v[160:163], v[212:215], v[60:63]
    buffer_load_dwordx4 a[68:71], v9, s[28:31], s64 offen sc1
    v_mfma_f32_16x16x32_bf16 v[44:47], v[164:167], v[208:211], v[44:47]
    s_waitcnt lgkmcnt(4)
    ds_read_b128 v[160:163], v226 offset:39936
    v_mfma_f32_16x16x32_bf16 v[64:67], v[164:167], v[212:215], v[64:67]
    v_swap_b32 v218, v220
    v_swap_b32 v219, v221
    v_mfma_f32_16x16x32_bf16 v[48:51], v[168:171], v[208:211], v[48:51]
    s_waitcnt lgkmcnt(4)
    v_mfma_f32_16x16x32_bf16 v[68:71], v[168:171], v[212:215], v[68:71]
    buffer_load_dwordx4 a[76:79], v10, s[28:31], s64 offen sc1
    v_mfma_f32_16x16x32_bf16 v[32:35], v[172:175], v[216:219], v[32:35]
    s_waitcnt lgkmcnt(3)
    v_mfma_f32_16x16x32_bf16 v[52:55], v[172:175], v[220:223], v[52:55]
    v_mfma_f32_16x16x32_bf16 v[36:39], v[148:151], v[216:219], v[36:39]
    s_waitcnt lgkmcnt(2)
    v_mfma_f32_16x16x32_bf16 v[56:59], v[148:151], v[220:223], v[56:59]
    v_mfma_f32_16x16x32_bf16 v[40:43], v[152:155], v[216:219], v[40:43]
    s_waitcnt lgkmcnt(1)
    v_mfma_f32_16x16x32_bf16 v[60:63], v[152:155], v[220:223], v[60:63]
    v_mfma_f32_16x16x32_bf16 v[44:47], v[156:159], v[216:219], v[44:47]
    s_waitcnt lgkmcnt(0)
    v_mfma_f32_16x16x32_bf16 v[64:67], v[156:159], v[220:223], v[64:67]
    v_mfma_f32_16x16x32_bf16 v[48:51], v[160:163], v[216:219], v[48:51]
    s_waitcnt vmcnt(8)
    v_mfma_f32_16x16x32_bf16 v[68:71], v[160:163], v[220:223], v[68:71]
    v_mfma_f32_16x16x32_bf16 v[52:55], a[128:131], a[20:23], v[52:55]
    buffer_load_dword v251, v250, s[20:23], s59 offen offset:64 sc1
    v_mfma_f32_16x16x32_bf16 v[56:59], a[132:135], a[20:23], v[56:59]
    v_mfma_f32_16x16x32_bf16 v[60:63], a[136:139], a[20:23], v[60:63]
    v_mfma_f32_16x16x32_bf16 v[64:67], a[140:143], a[20:23], v[64:67]
    v_cvt_pk_bf16_f32 v120, v32, v33
    v_cvt_pk_bf16_f32 v121, v34, v35
    v_mfma_f32_16x16x32_bf16 v[68:71], a[144:147], a[20:23], v[68:71]
    s_waitcnt vmcnt(8)
    ds_write_b64 v239, v[120:121] offset:0
    v_mfma_f32_16x16x32_bf16 v[52:55], a[148:151], a[28:31], v[52:55]
    v_cvt_pk_bf16_f32 v122, v36, v37
    v_cvt_pk_bf16_f32 v123, v38, v39
    v_mfma_f32_16x16x32_bf16 v[56:59], a[152:155], a[28:31], v[56:59]
    ds_write_b64 v239, v[122:123] offset:8
    v_mfma_f32_16x16x32_bf16 v[60:63], a[156:159], a[28:31], v[60:63]
    v_cvt_pk_bf16_f32 v124, v40, v41
    v_cvt_pk_bf16_f32 v125, v42, v43
    v_mfma_f32_16x16x32_bf16 v[64:67], a[160:163], a[28:31], v[64:67]
    ds_write_b64 v239, v[124:125] offset:16
    v_mfma_f32_16x16x32_bf16 v[68:71], a[164:167], a[28:31], v[68:71]
    s_waitcnt vmcnt(7)
    v_cvt_pk_bf16_f32 v126, v44, v45
    v_cvt_pk_bf16_f32 v127, v46, v47
    v_mfma_f32_16x16x32_bf16 v[52:55], a[168:171], a[36:39], v[52:55]
    ds_write_b64 v239, v[126:127] offset:24
    v_mfma_f32_16x16x32_bf16 v[56:59], a[172:175], a[36:39], v[56:59]
    v_cvt_pk_bf16_f32 v128, v48, v49
    v_cvt_pk_bf16_f32 v129, v50, v51
    v_mfma_f32_16x16x32_bf16 v[60:63], a[176:179], a[36:39], v[60:63]
    s_waitcnt vmcnt(1)
    ds_write_b64 v239, v[128:129] offset:32
    buffer_store_dword v254, v255, s[20:23], s59 offen offset:96 sc1
    v_mfma_f32_16x16x32_bf16 v[64:67], a[180:183], a[36:39], v[64:67]
    ds_read_b128 v[136:139], v240
    ds_read_b128 v[140:143], v241
    v_mfma_f32_16x16x32_bf16 v[68:71], a[184:187], a[36:39], v[68:71]
    ds_read_b128 v[144:147], v242
    v_mfma_f32_16x16x32_bf16 v[52:55], a[188:191], a[44:47], v[52:55]
    v_mfma_f32_16x16x32_bf16 v[56:59], a[192:195], a[44:47], v[56:59]
    v_mfma_f32_16x16x32_bf16 v[60:63], a[196:199], a[44:47], v[60:63]
    v_mfma_f32_16x16x32_bf16 v[64:67], a[200:203], a[44:47], v[64:67]
    v_mfma_f32_16x16x32_bf16 v[68:71], a[204:207], a[44:47], v[68:71]
    v_mfma_f32_16x16x32_bf16 v[52:55], a[208:211], a[52:55], v[52:55]
    v_mfma_f32_16x16x32_bf16 v[56:59], a[212:215], a[52:55], v[56:59]
    v_mfma_f32_16x16x32_bf16 v[60:63], a[216:219], a[52:55], v[60:63]
    s_waitcnt vmcnt(1)
    v_cmp_ne_u32 vcc, s32, v251
    v_mfma_f32_16x16x32_bf16 v[64:67], a[220:223], a[52:55], v[64:67]
    v_mfma_f32_16x16x32_bf16 v[68:71], a[224:227], a[52:55], v[68:71]
    s_nop 1
    s_cbranch_vccnz L_d0As_retry
L_d0As_ok:
    v_mfma_f32_16x16x32_bf16 v[52:55], a[228:231], a[60:63], v[52:55]
    s_waitcnt lgkmcnt(2)
    buffer_store_dwordx4 v[136:139], v245, s[24:27], s73 offen
    v_mfma_f32_16x16x32_bf16 v[52:55], a[248:251], a[68:71], v[52:55]
    v_mfma_f32_16x16x32_bf16 v[52:55], v[84:87], a[76:79], v[52:55]
    s_waitcnt lgkmcnt(1)
    buffer_store_dwordx4 v[140:143], v246, s[24:27], s73 offen
    v_mfma_f32_16x16x32_bf16 v[56:59], a[232:235], a[60:63], v[56:59]
    v_mfma_f32_16x16x32_bf16 v[56:59], a[252:255], a[68:71], v[56:59]
    s_waitcnt lgkmcnt(0)
    buffer_store_dwordx4 v[144:147], v247, s[24:27], s73 offen
    v_mfma_f32_16x16x32_bf16 v[56:59], v[88:91], a[76:79], v[56:59]
    v_mfma_f32_16x16x32_bf16 v[60:63], a[236:239], a[60:63], v[60:63]
    v_cvt_pk_bf16_f32 v120, v52, v53
    v_cvt_pk_bf16_f32 v121, v54, v55
    v_mfma_f32_16x16x32_bf16 v[60:63], v[72:75], a[68:71], v[60:63]
    ds_write_b64 v239, v[120:121] offset:0
    buffer_load_dword v251, v250, s[20:23], s59 offen offset:96 sc1
    v_mfma_f32_16x16x32_bf16 v[60:63], v[92:95], a[76:79], v[60:63]
    v_mfma_f32_16x16x32_bf16 v[64:67], a[240:243], a[60:63], v[64:67]
    v_cvt_pk_bf16_f32 v122, v56, v57
    v_cvt_pk_bf16_f32 v123, v58, v59
    v_mfma_f32_16x16x32_bf16 v[64:67], v[76:79], a[68:71], v[64:67]
    s_or_b32 s42, s4, s51
    ds_write_b64 v239, v[122:123] offset:8
    v_mfma_f32_16x16x32_bf16 v[64:67], v[96:99], a[76:79], v[64:67]
    s_cmp_lg_u32 s42, 0
    v_mfma_f32_16x16x32_bf16 v[68:71], a[244:247], a[60:63], v[68:71]
    s_cselect_b32 s42, 33554432, 0
    v_cvt_pk_bf16_f32 v124, v60, v61
    v_cvt_pk_bf16_f32 v125, v62, v63
    v_mfma_f32_16x16x32_bf16 v[68:71], v[80:83], a[68:71], v[68:71]
    ds_write_b64 v239, v[124:125] offset:16
    buffer_store_dword v254, v255, s[20:23], s42 offen offset:0 sc1
    v_mfma_f32_16x16x32_bf16 v[68:71], v[100:103], a[76:79], v[68:71]
    s_add_u32 s73, s73, 40960
    v_cvt_pk_bf16_f32 v126, v64, v65
    v_cvt_pk_bf16_f32 v127, v66, v67
    ds_write_b64 v239, v[126:127] offset:24
    s_waitcnt vmcnt(1)
    v_cmp_ne_u32 vcc, s32, v251
    s_nop 1
    v_cvt_pk_bf16_f32 v128, v68, v69
    v_cvt_pk_bf16_f32 v129, v70, v71
    ds_write_b64 v239, v[128:129] offset:32
    ds_read_b128 v[136:139], v240
    ds_read_b128 v[140:143], v241
    ds_read_b128 v[144:147], v242
    s_cbranch_vccnz L_d1As_retry
L_d1As_ok:
    s_waitcnt lgkmcnt(2)
    buffer_store_dwordx4 v[136:139], v245, s[24:27], s73 offen
    s_waitcnt lgkmcnt(1)
    buffer_store_dwordx4 v[140:143], v246, s[24:27], s73 offen
    s_waitcnt lgkmcnt(0)
    buffer_store_dwordx4 v[144:147], v247, s[24:27], s73 offen
    s_endpgm
L_f0A_retry:
    s_mov_b32 s52, 0
L_f0A_loop:
    buffer_load_dword v251, v250, s[20:23], s59 offen offset:0 sc1
    s_waitcnt vmcnt(0)
    v_cmp_ne_u32 vcc, s32, v251
    s_nop 3
    s_cbranch_vccz L_f0A_ok
    s_add_u32 s52, s52, 1
    s_cmp_lt_u32 s52, 100000
    s_cbranch_scc1 L_f0A_loop
    s_branch L_f0A_ok
L_f1A_retry:
    s_mov_b32 s52, 0
L_f1A_loop:
    buffer_load_dword v251, v250, s[20:23], s59 offen offset:32 sc1
    s_waitcnt vmcnt(0)
    v_cmp_ne_u32 vcc, s32, v251
    s_nop 3
    s_cbranch_vccz L_f1A_ok
    s_add_u32 s52, s52, 1
    s_cmp_lt_u32 s52, 100000
    s_cbranch_scc1 L_f1A_loop
    s_branch L_f1A_ok
L_d0A_retry:
    s_mov_b32 s52, 0
L_d0A_loop:
    buffer_load_dword v251, v250, s[20:23], s59 offen offset:64 sc1
    s_waitcnt vmcnt(0)
    v_cmp_ne_u32 vcc, s32, v251
    s_nop 3
    s_cbranch_vccz L_d0A_ok
    s_add_u32 s52, s52, 1
    s_cmp_lt_u32 s52, 100000
    s_cbranch_scc1 L_d0A_loop
    s_branch L_d0A_ok
L_d1A_retry:
    s_mov_b32 s52, 0
L_d1A_loop:
    buffer_load_dword v251, v250, s[20:23], s59 offen offset:96 sc1
    s_waitcnt vmcnt(0)
    v_cmp_ne_u32 vcc, s32, v251
    s_nop 3
    s_cbranch_vccz L_d1A_ok
    s_add_u32 s52, s52, 1
    s_cmp_lt_u32 s52, 100000
    s_cbranch_scc1 L_d1A_loop
    s_branch L_d1A_ok
L_exit:
    s_endpgm
.p2align 12
L_setupB:
    s_load_dword s32, s[86:87], 128
    s_load_dword s90, s[86:87], 0
    s_load_dwordx2 s[82:83], s[0:1], 24
    s_cmp_ge_u32 s42, 10
    s_cselect_b32 s44, 10, 0
    s_sub_u32 s42, s42, s44
    s_mul_i32 s44, s42, 245760
    s_add_u32 s34, s44, s43
    s_add_u32 s42, s42, 2
    s_cmp_ge_u32 s42, 10
    s_cselect_b32 s44, 10, 0
    s_sub_u32 s42, s42, s44
    s_mul_i32 s44, s42, 245760
    s_add_u32 s35, s44, s43
    s_add_u32 s42, s42, 2
    s_cmp_ge_u32 s42, 10
    s_cselect_b32 s44, 10, 0
    s_sub_u32 s42, s42, s44
    s_mul_i32 s44, s42, 245760
    s_add_u32 s36, s44, s43
    s_add_u32 s42, s42, 2
    s_cmp_ge_u32 s42, 10
    s_cselect_b32 s44, 10, 0
    s_sub_u32 s42, s42, s44
    s_mul_i32 s44, s42, 245760
    s_add_u32 s37, s44, s43
    s_add_u32 s42, s42, 2
    s_mov_b32 s20, s86
    s_mov_b32 s21, s87
    s_mov_b32 s22, 33554432
    s_mov_b32 s23, 0x20000
    s_mov_b32 s24, s84
    s_mov_b32 s25, s85
    s_mov_b32 s26, 5242880
    s_mov_b32 s27, 0x20000
    s_lshl_b32 s51, s5, 2
    s_add_u32 s51, s51, s7
    v_lshlrev_b32 v25, 4, v1
    v_lshrrev_b32 v112, 4, v1
    v_and_b32 v113, 15, v1
    v_bfe_u32 v114, v1, 2, 2
    v_and_b32 v115, 3, v1
    v_lshrrev_b32 v116, 1, v113
    v_xor_b32 v116, v116, v112
    v_lshlrev_b32 v117, 7, v113
    v_lshl_add_u32 v116, v116, 4, v117
    v_add_u32 v21, s41, v116
    v_xor_b32 v116, 64, v116
    v_add_u32 v22, s41, v116
    v_lshrrev_b32 v116, 2, v1
    v_mul_u32_u24 v117, 160, v116
    v_mul_u32_u24 v118, 40, v115
    v_add_u32 v23, v117, v118
    v_add_u32 v24, 51200, v23
    v_mul_u32_u24 v117, 120, v113
    v_mul_u32_u24 v118, 3840, v112
    v_add3_u32 v26, v117, v118, s41
    v_mul_u32_u24 v118, 40, v112
    v_mul_u32_u24 v119, 160, v113
    v_lshrrev_b32 v120, 3, v113
    v_lshl_add_u32 v119, v120, 4, v119
    s_mul_i32 s44, s7, 2592
    s_add_u32 s44, s44, 153088
    v_add3_u32 v239, v119, v118, s44
    v_and_b32 v117, 7, v116
    v_lshrrev_b32 v118, 5, v1
    v_lshlrev_b32 v118, 1, v118
    v_lshl_add_u32 v117, v117, 2, v118
    v_mul_u32_u24 v117, 120, v117
    s_mul_i32 s42, s7, 3840
    s_add_u32 s42, s42, 102400
    v_add_u32 v30, s42, v117
    v_lshl_add_u32 v28, v115, 3, v30
    s_mov_b32 s54, 0x3fb8aa3b
    s_mov_b32 s55, 0xbfb8aa3b
    s_mov_b32 s75, 0x07060302
    s_and_b32 s45, s5, 1
    v_lshrrev_b32 v117, 3, v126
    v_min_u32 v117, 1, v117
    v_and_b32 v118, 63, v1
    v_add_lshl_u32 v117, v117, v118, 4
    v_add_u32 v117, 0, v117
    v_add_u32 v240, s44, v117
    v_mul_u32_u24 v117, 2560, v126
    v_lshl_add_u32 v245, v125, 4, v117
    v_lshrrev_b32 v117, 3, v131
    v_min_u32 v117, 1, v117
    v_and_b32 v118, 63, v1
    v_add_lshl_u32 v117, v117, v118, 4
    v_add_u32 v117, 1024, v117
    v_add_u32 v241, s44, v117
    v_mul_u32_u24 v117, 2560, v131
    v_lshl_add_u32 v246, v130, 4, v117
    v_lshrrev_b32 v117, 3, v136
    v_min_u32 v117, 1, v117
    v_and_b32 v118, 31, v1
    v_add_lshl_u32 v117, v117, v118, 4
    v_add_u32 v117, 2048, v117
    s_add_u32 m0, s41, 4096
    s_add_u32 s58, s39, s38
    buffer_load_dwordx4 v17, s[8:11], s58 offen lds
    s_add_u32 s39, s39, 128
    v_add_u32 v242, s44, v117
    v_mul_u32_u24 v117, 2560, v136
    v_lshl_add_u32 v247, v135, 4, v117
    v_lshrrev_b32 v117, 5, v1
    v_lshl_or_b32 v247, v117, 30, v247
    v_mov_b32 v117, 2304
    v_cmp_gt_u32 vcc, 16, v1
    v_mov_b32 v118, 1024
    s_nop 0
    v_cndmask_b32 v117, v117, v118, vcc
    v_add_u32 v8, v117, v25
    v_mov_b32 v7, v25
    v_add_u32 v9, 40960, v25
    v_add_u32 v10, 40960, v8
    v_lshrrev_b32 v116, 5, v1
    v_mul_u32_u24 v116, 40448, v116
    v_add_u32 v117, 3328, v25
    v_add_u32 v11, v116, v117
    v_add_u32 v12, 51200, v25
    v_add_u32 v226, 112128, v25
    v_min_u32 v13, 39, v1
    v_lshlrev_b32 v13, 3, v13
    v_and_b32 v116, 1, v126
    v_mul_u32_u24 v116, 2560, v116
    v_lshrrev_b32 v117, 1, v126
    v_mul_u32_u24 v117, 40960, v117
    v_lshlrev_b32 v118, 7, v125
    v_add3_u32 v253, v116, v117, v118
    s_lshl_b32 s42, s45, 1
    s_xor_b32 s42, s42, s7
    s_mul_i32 s42, s42, 5120
    s_mul_i32 s44, s5, 102400
    s_add_u32 s44, s44, 7110656
    s_add_u32 s42, s42, s44
    s_lshr_b32 s52, s5, 1
    s_add_u32 s43, s52, s7
    s_and_b32 s43, s43, 3
    s_add_u32 s43, s43, 16
    s_mul_i32 s43, s43, 5120
    s_add_u32 s50, s43, s44
    s_lshr_b32 s91, s5, 2
    s_lshl_b32 s91, s91, 9
    s_add_u32 s91, s91, 50176
    s_mul_i32 s44, s5, 160
    s_lshl_b32 s73, s38, 1
    s_add_u32 s73, s73, s44
    s_add_u32 s73, s73, 1280
    s_lshl_b32 s56, s38, 1
    s_add_u32 s56, s56, 1280
    s_add_u32 s43, s52, 0
    s_and_b32 s43, s43, 3
    s_mul_i32 s44, s43, 20480
    s_add_u32 s46, s44, s42
    s_lshl_b32 s43, s43, 1
    s_add_u32 s43, s43, s45
    s_mul_i32 s44, s43, 5120
    s_add_u32 s60, s44, s56
    s_xor_b32 s43, s43, 1
    s_mul_i32 s44, s43, 5120
    s_add_u32 s61, s44, s56
    s_add_u32 s43, s52, 1
    buffer_load_dwordx4 v18, s[8:11], s58 offen offset:1024 lds
    s_cmp_eq_u32 s39, 1280
    s_cselect_b32 s39, 0, s39
    s_and_b32 s43, s43, 3
    s_mul_i32 s44, s43, 20480
    s_add_u32 s47, s44, s42
    s_lshl_b32 s43, s43, 1
    s_add_u32 s43, s43, s45
    s_mul_i32 s44, s43, 5120
    s_add_u32 s62, s44, s56
    s_xor_b32 s43, s43, 1
    s_mul_i32 s44, s43, 5120
    s_add_u32 s63, s44, s56
    s_add_u32 s43, s52, 2
    s_and_b32 s43, s43, 3
    s_mul_i32 s44, s43, 20480
    s_add_u32 s48, s44, s42
    s_lshl_b32 s43, s43, 1
    s_add_u32 s43, s43, s45
    s_mul_i32 s44, s43, 5120
    s_add_u32 s64, s44, s56
    s_xor_b32 s43, s43, 1
    s_mul_i32 s44, s43, 5120
    s_add_u32 s65, s44, s56
    s_add_u32 s43, s52, 3
    s_and_b32 s43, s43, 3
    s_mul_i32 s44, s43, 20480
    s_add_u32 s49, s44, s42
    s_lshl_b32 s43, s43, 1
    s_add_u32 s43, s43, s45
    s_mul_i32 s44, s43, 5120
    s_add_u32 s66, s44, s56
    s_xor_b32 s43, s43, 1
    s_mul_i32 s44, s43, 5120
    s_add_u32 s67, s44, s56
    s_lshl_b32 s42, s4, 2
    s_add_u32 s42, s42, s7
    s_lshl_b32 s59, s42, 7
    s_add_u32 s59, s59, 12288
    s_lshl_b32 s42, s51, 16
    s_add_u32 s42, s42, 3145728
    s_lshl_b32 s43, s4, 12
    s_add_u32 s68, s42, s43
    s_min_u32 s43, s4, 14
    s_lshl_b32 s43, s43, 7
    s_add_u32 s69, s42, s43
    s_lshl_b32 s42, s51, 12
    s_add_u32 s71, s42, 5373952
    s_add_u32 s70, s71, s43
    s_lshr_b32 s43, s4, 2
    s_lshl_b32 s43, s43, 18
    s_add_u32 s71, s71, s43
    v_mul_u32_u24 v116, 16, v112
    v_add_lshl_u32 v228, v116, v113, 4
    v_mul_u32_u24 v116, 4, v112
    v_add_lshl_u32 v117, v116, v113, 4
    v_lshrrev_b32 v116, 2, v113
    v_lshl_or_b32 v14, v116, 28, v117
    v_lshrrev_b32 v116, 1, v112
    v_lshl_or_b32 v15, v116, 30, v228
    v_lshl_or_b32 v16, v116, 30, v14
    v_cmp_gt_u32 vcc, 4, v113
    s_nop 1
    v_cndmask_b32 v237, 0, -1, vcc
    buffer_load_dwordx4 v19, s[8:11], s58 offen offset:2048 lds
    v_mov_b32 v116, 0x3f803f80
    v_cmp_eq_u32 vcc, 4, v113
    s_nop 1
    v_cndmask_b32 v238, 0, v116, vcc
    v_and_b32 v116, 7, v1
    v_lshlrev_b32 v250, 2, v116
    s_lshl_b32 s42, s5, 2
    v_min_u32 v255, 1, v1
    v_lshlrev_b32 v255, 30, v255
    v_or_b32 v255, s42, v255
    v_lshlrev_b32 v252, 3, v0
    v_add_u32 v252, 110080, v252
    v_lshrrev_b32 v117, 3, v1
    v_lshlrev_b32 v117, 12, v117
    v_lshl_add_u32 v229, v116, 4, v117
    v_lshl_add_u32 v230, v112, 5, v250
    s_mul_i32 s42, s7, 1152
    s_add_u32 s42, s42, 102400
    v_add_u32 v116, 0, v1
    v_lshrrev_b32 v117, 3, v116
    v_and_b32 v118, 1, v116
    v_lshl_add_u32 v117, v117, 1, v118
    v_bfe_u32 v118, v116, 1, 2
    v_cmp_gt_u32 vcc, 24, v117
    v_lshrrev_b32 v119, 2, v117
    v_subrev_u32 v120, 24, v117
    v_cndmask_b32 v119, v120, v119, vcc
    v_and_b32 v117, 3, v117
    v_cndmask_b32 v117, 4, v117, vcc
    v_mov_b32 v120, 0
    v_sub_u32 v117, v117, v120
    v_lshl_add_u32 v119, v119, 2, v118
    v_mul_u32_u24 v119, 48, v119
    v_lshl_add_u32 v119, v117, 3, v119
    v_add_u32 v232, s42, v119
    v_add_u32 v116, 64, v1
    v_subrev_u32 v117, 64, v116
    v_cmp_gt_u32 vcc, 120, v116
    s_nop 1
    v_cndmask_b32 v116, v117, v116, vcc
    v_lshlrev_b32 v231, 4, v116
    v_lshrrev_b32 v117, 3, v116
    v_and_b32 v118, 1, v116
    v_lshl_add_u32 v117, v117, 1, v118
    v_bfe_u32 v118, v116, 1, 2
    v_cmp_gt_u32 vcc, 24, v117
    v_lshrrev_b32 v119, 2, v117
    v_subrev_u32 v120, 24, v117
    v_cndmask_b32 v119, v120, v119, vcc
    v_and_b32 v117, 3, v117
    v_cndmask_b32 v117, 4, v117, vcc
    v_mov_b32 v120, 0
    v_sub_u32 v117, v117, v120
    v_lshl_add_u32 v119, v119, 2, v118
    v_mul_u32_u24 v119, 48, v119
    v_lshl_add_u32 v119, v117, 3, v119
    v_add_u32 v233, s42, v119
    v_cmp_eq_u32 vcc, v112, v114
    v_mul_u32_u24 v116, 1152, v112
    v_mul_u32_u24 v117, 48, v115
    v_add_u32 v116, v116, v117
    v_add_u32 v116, 102400, v116
    buffer_load_dwordx4 v20, s[8:11], s58 offen offset:3072 lds
    v_mov_b32 v117, 110144
    v_cndmask_b32 v236, v117, v116, vcc
    v_mov_b32 v212, 0x358637bd
    v_mov_b32 v213, 0x358637bd
    v_mov_b32 v214, 0x358637bd
    v_mov_b32 v215, 0x358637bd
    v_mov_b32 v31, 0xb5c1a2a0
    s_lshr_b32 s43, s4, 2
    s_mul_i32 s42, s43, 3
    s_add_u32 s42, s42, s7
    s_sub_u32 s42, s42, 2
    s_cmp_eq_u32 s43, 0
    s_cselect_b32 s42, 0, s42
    s_cselect_b32 s43, 1, 3
    s_cmp_lt_u32 s7, s43
    s_cselect_b32 s92, 1, 0
    s_lshl_b32 s42, s42, 5
    s_lshr_b32 s43, s2, 3
    s_add_u32 s42, s42, s43
    s_waitcnt lgkmcnt(0)
    s_cmp_lt_u32 s42, 160
    s_cselect_b32 s16, s82, s80
    s_cselect_b32 s17, s83, s81
    s_cselect_b32 s90, s90, s32
    s_cselect_b32 s43, 0, 160
    s_cselect_b32 s6, 0, 819200
    s_cselect_b32 s72, 0, 1024
    s_mov_b32 s18, 819200
    s_mov_b32 s19, 0x20000
    s_add_u32 s90, s90, 0x9e3779b1
    s_sub_u32 s42, s42, s43
    s_and_b32 s43, s42, 1
    s_mul_i32 s3, s43, 640
    s_mul_i32 s44, s43, 409600
    s_add_u32 s6, s6, s44
    s_lshl_b32 s44, s43, 9
    s_add_u32 s72, s72, s44
    s_lshr_b32 s43, s42, 1
    s_lshl_b32 s44, s43, 2
    s_add_u32 s72, s72, s44
    s_add_u32 s72, s72, 49152
    s_and_b32 s43, s43, 3
    s_mul_i32 s44, s43, 25600
    s_add_u32 s3, s3, s44
    s_lshl_b32 s44, s43, 8
    s_add_u32 s6, s6, s44
    s_lshr_b32 s43, s42, 3
    s_mul_i32 s44, s43, 5120
    s_add_u32 s6, s6, s44
    s_add_u32 s6, s6, 6291456
    s_lshr_b32 s44, s43, 1
    s_mul_i32 s44, s44, 80
    s_and_b32 s45, s43, 1
    s_lshl_b32 s45, s45, 3
    s_add_u32 s44, s44, s45
    s_mul_i32 s45, s43, 160
    s_sub_u32 s45, s45, 2544
    s_cmp_ge_u32 s43, 16
    s_cselect_b32 s44, s45, s44
    s_cselect_b32 s45, 1, 0
    s_mul_i32 s44, s44, 1280
    s_add_u32 s3, s3, s44
    s_mul_i32 s43, s45, 97280
    s_add_u32 s44, s40, 81920
    v_lshrrev_b32 v116, 2, v126
    v_mul_u32_u24 v117, 640, v116
    v_lshrrev_b32 v116, 2, v116
    v_mul_u32_u24 v116, s43, v116
    v_add3_u32 v152, v116, v117, v25
    v_lshrrev_b32 v116, 2, v131
    v_mul_u32_u24 v117, 640, v116
    v_lshrrev_b32 v116, 2, v116
    v_mul_u32_u24 v116, s43, v116
    v_add3_u32 v153, v116, v117, v25
    v_lshrrev_b32 v116, 2, v136
    v_mul_u32_u24 v117, 640, v116
    v_lshrrev_b32 v116, 2, v116
    v_mul_u32_u24 v116, s43, v116
    v_add3_u32 v154, v116, v117, v25
    v_lshrrev_b32 v116, 2, v141
    v_mul_u32_u24 v117, 640, v116
    v_lshrrev_b32 v116, 2, v116
    v_mul_u32_u24 v116, s43, v116
    v_add3_u32 v155, v116, v117, v25
    v_lshrrev_b32 v116, 2, v146
    v_mul_u32_u24 v117, 640, v116
    v_lshrrev_b32 v116, 2, v116
    v_mul_u32_u24 v116, s43, v116
    v_add3_u32 v156, v116, v117, v25
    v_add_u32 v156, 4096, v156
    v_mul_u32_u24 v119, 640, v114
    v_mul_u32_u24 v120, 40, v115
    v_add3_u32 v119, v119, v120, s44
    v_add_u32 v116, 0, v112
    v_mul_u32_u24 v117, 13108, v116
    v_lshrrev_b32 v117, 16, v117
    v_mul_u32_u24 v118, 120, v117
    v_lshl_add_u32 v118, v116, 3, v118
    v_add_u32 v118, v118, v119
    v_and_b32 v120, s45, v117
    v_mul_u32_u24 v120, 2560, v120
    v_add_u32 v157, v118, v120
    v_sub_u32 v118, v118, v120
    v_add_u32 v158, 2560, v118
    v_mul_u32_u24 v117, 97280, v117
    v_lshl_add_u32 v117, v116, 10, v117
    v_lshl_add_u32 v192, v113, 4, v117
    v_add_u32 v116, 4, v112
    v_mul_u32_u24 v117, 13108, v116
    v_lshrrev_b32 v117, 16, v117
    v_mul_u32_u24 v118, 120, v117
    v_lshl_add_u32 v118, v116, 3, v118
    v_add_u32 v118, v118, v119
    v_and_b32 v120, s45, v117
    v_mul_u32_u24 v120, 2560, v120
    v_add_u32 v159, v118, v120
    s_add_u32 m0, s40, 20480
    s_add_u32 s57, s34, 1280
    buffer_load_dwordx4 v2, s[12:15], s57 offen lds
    v_sub_u32 v118, v118, v120
    v_add_u32 v160, 2560, v118
    v_mul_u32_u24 v117, 97280, v117
    v_lshl_add_u32 v117, v116, 10, v117
    v_lshl_add_u32 v193, v113, 4, v117
    v_add_u32 v116, 8, v112
    v_mul_u32_u24 v117, 13108, v116
    v_lshrrev_b32 v117, 16, v117
    v_mul_u32_u24 v118, 120, v117
    v_lshl_add_u32 v118, v116, 3, v118
    v_add_u32 v118, v118, v119
    v_and_b32 v120, s45, v117
    v_mul_u32_u24 v120, 2560, v120
    v_add_u32 v161, v118, v120
    v_sub_u32 v118, v118, v120
    v_add_u32 v162, 2560, v118
    v_mul_u32_u24 v117, 97280, v117
    v_lshl_add_u32 v117, v116, 10, v117
    v_lshl_add_u32 v194, v113, 4, v117
    v_add_u32 v116, 12, v112
    v_mul_u32_u24 v117, 13108, v116
    v_lshrrev_b32 v117, 16, v117
    v_mul_u32_u24 v118, 120, v117
    v_lshl_add_u32 v118, v116, 3, v118
    v_add_u32 v118, v118, v119
    v_and_b32 v120, s45, v117
    v_mul_u32_u24 v120, 2560, v120
    v_add_u32 v163, v118, v120
    v_sub_u32 v118, v118, v120
    v_add_u32 v164, 2560, v118
    v_mul_u32_u24 v117, 97280, v117
    v_lshl_add_u32 v117, v116, 10, v117
    v_lshl_add_u32 v195, v113, 4, v117
    v_add_u32 v116, 16, v112
    v_mul_u32_u24 v117, 13108, v116
    v_lshrrev_b32 v117, 16, v117
    v_mul_u32_u24 v118, 120, v117
    v_lshl_add_u32 v118, v116, 3, v118
    v_add_u32 v118, v118, v119
    v_and_b32 v120, s45, v117
    v_mul_u32_u24 v120, 2560, v120
    v_add_u32 v165, v118, v120
    v_sub_u32 v118, v118, v120
    v_add_u32 v166, 2560, v118
    v_mul_u32_u24 v117, 97280, v117
    v_lshl_add_u32 v117, v116, 10, v117
    v_lshl_add_u32 v196, v113, 4, v117
    s_mov_b64 exec, 0
    s_cmp_eq_u32 s7, 0
    s_cbranch_scc1 L_hop0B
    s_cmp_eq_u32 s7, 1
    s_cbranch_scc1 L_hop1B
    s_cmp_eq_u32 s7, 2
    s_cbranch_scc1 L_hop2B
    s_branch L_hop3B
L_hopretB:
    s_mov_b64 exec, -1
    buffer_load_dwordx4 v3, s[12:15], s57 offen offset:1024 lds
    buffer_load_dwordx4 v4, s[12:15], s57 offen offset:2048 lds
    buffer_load_dwordx4 v5, s[12:15], s57 offen offset:3072 lds
    s_add_u32 m0, s40, 24576
    s_nop 0
    buffer_load_dwordx4 v6, s[12:15], s57 offen lds
    s_add_u32 m0, s41, 8192
    s_add_u32 s58, s39, s38
    buffer_load_dwordx4 v17, s[8:11], s58 offen lds
    s_add_u32 s39, s39, 128
    buffer_load_dwordx4 v18, s[8:11], s58 offen offset:1024 lds
    s_cmp_eq_u32 s39, 1280
    s_cselect_b32 s39, 0, s39
    buffer_load_dwordx4 v19, s[8:11], s58 offen offset:2048 lds
    buffer_load_dwordx4 v20, s[8:11], s58 offen offset:3072 lds
    s_getreg_b32 s42, hwreg(HW_REG_XCC_ID, 0, 4)
    s_waitcnt lgkmcnt(0)
    s_add_u32 s32, s32, 0x9e3779b1
    s_lshl_b32 s42, s42, 28
    s_xor_b32 s74, s42, s32
    v_mov_b32 v254, s32
    v_and_b32 v27, 1, v1
    v_lshlrev_b32 v27, 4, v27
    v_lshrrev_b32 v27, v27, v254
    v_mov_b32 v29, s74
    s_add_u32 s93, s59, 28672
    s_branch L_mainB
.p2align 12
L_mainB:
L_hop0B:
    s_cbranch_execz L_hop4B
    s_waitcnt vmcnt(13)
    s_barrier
    ds_read_b128 a[0:3], v21 offset:0
    ds_read_b128 a[4:7], v21 offset:2048
    ds_read_b128 a[8:11], v22 offset:0
    ds_read_b128 a[12:15], v22 offset:2048
    ds_read_b64_tr_b16 a[220:221], v23 offset:0
    ds_read_b64_tr_b16 a[222:223], v23 offset:2560
    ds_read_b64_tr_b16 a[224:225], v23 offset:8
    ds_read_b64_tr_b16 a[226:227], v23 offset:2568
    ds_read_b64_tr_b16 a[228:229], v23 offset:16
    ds_read_b64_tr_b16 a[230:231], v23 offset:2576
    ds_read_b64_tr_b16 a[232:233], v23 offset:24
    ds_read_b64_tr_b16 a[234:235], v23 offset:2584
    ds_read_b64_tr_b16 a[236:237], v23 offset:32
    ds_read_b64_tr_b16 a[238:239], v23 offset:2592
    s_waitcnt lgkmcnt(8)
    v_mfma_f32_16x16x32_bf16 v[32:35], a[220:223], a[0:3], v[212:215]
    s_waitcnt lgkmcnt(6)
    ds_read_b64_tr_b16 a[240:241], v23 offset:5120
    ds_read_b64_tr_b16 a[242:243], v23 offset:7680
    v_mfma_f32_16x16x32_bf16 v[52:55], a[220:223], a[4:7], v[212:215]
    s_add_u32 m0, s41, 0
    s_add_u32 s58, s39, s38
    buffer_load_dwordx4 v17, s[8:11], s58 offen lds
    s_add_u32 s39, s39, 128
    v_mfma_f32_16x16x32_bf16 v[36:39], a[224:227], a[0:3], v[212:215]
    s_waitcnt lgkmcnt(6)
    ds_read_b64_tr_b16 a[220:221], v23 offset:5128
    ds_read_b64_tr_b16 a[222:223], v23 offset:7688
    v_mfma_f32_16x16x32_bf16 v[56:59], a[224:227], a[4:7], v[212:215]
    buffer_load_dwordx4 v18, s[8:11], s58 offen offset:1024 lds
    s_cmp_eq_u32 s39, 1280
    s_cselect_b32 s39, 0, s39
    v_mfma_f32_16x16x32_bf16 v[40:43], a[228:231], a[0:3], v[212:215]
    s_waitcnt lgkmcnt(6)
    ds_read_b64_tr_b16 a[224:225], v23 offset:5136
    ds_read_b64_tr_b16 a[226:227], v23 offset:7696
    v_mfma_f32_16x16x32_bf16 v[60:63], a[228:231], a[4:7], v[212:215]
    v_mfma_f32_16x16x32_bf16 v[44:47], a[232:235], a[0:3], v[212:215]
    s_waitcnt lgkmcnt(6)
    ds_read_b64_tr_b16 a[228:229], v23 offset:5144
    ds_read_b64_tr_b16 a[230:231], v23 offset:7704
    v_mfma_f32_16x16x32_bf16 v[64:67], a[232:235], a[4:7], v[212:215]
    buffer_load_dwordx4 v19, s[8:11], s58 offen offset:2048 lds
    v_mfma_f32_16x16x32_bf16 v[48:51], a[236:239], a[0:3], v[212:215]
    s_waitcnt lgkmcnt(6)
    ds_read_b64_tr_b16 a[232:233], v23 offset:5152
    ds_read_b64_tr_b16 a[234:235], v23 offset:7712
    v_mfma_f32_16x16x32_bf16 v[68:71], a[236:239], a[4:7], v[212:215]
    buffer_load_dwordx4 v20, s[8:11], s58 offen offset:3072 lds
    v_mfma_f32_16x16x32_bf16 v[32:35], a[240:243], a[8:11], v[32:35]
    s_waitcnt lgkmcnt(6)
    ds_read_b64_tr_b16 a[236:237], v23 offset:10240
    ds_read_b64_tr_b16 a[238:239], v23 offset:12800
    v_mfma_f32_16x16x32_bf16 v[52:55], a[240:243], a[12:15], v[52:55]
    s_waitcnt vmcnt(13)
    ds_read_b128 a[16:19], v21 offset:4096
    ds_read_b128 a[20:23], v21 offset:6144
    v_mfma_f32_16x16x32_bf16 v[36:39], a[220:223], a[8:11], v[36:39]
    s_waitcnt lgkmcnt(8)
    ds_read_b64_tr_b16 a[240:241], v23 offset:10248
    ds_read_b64_tr_b16 a[242:243], v23 offset:12808
    v_mfma_f32_16x16x32_bf16 v[56:59], a[220:223], a[12:15], v[56:59]
    s_add_u32 m0, s40, 40960
    s_add_u32 s57, s35, 1280
    buffer_load_dwordx4 v2, s[12:15], s57 offen lds
    ds_read_b128 a[24:27], v22 offset:4096
    ds_read_b128 a[28:31], v22 offset:6144
    v_mfma_f32_16x16x32_bf16 v[40:43], a[224:227], a[8:11], v[40:43]
    s_waitcnt lgkmcnt(10)
    ds_read_b64_tr_b16 a[220:221], v23 offset:10256
    ds_read_b64_tr_b16 a[222:223], v23 offset:12816
    v_mfma_f32_16x16x32_bf16 v[60:63], a[224:227], a[12:15], v[60:63]
    buffer_load_dwordx4 v3, s[12:15], s57 offen offset:1024 lds
    v_mfma_f32_16x16x32_bf16 v[44:47], a[228:231], a[8:11], v[44:47]
    s_waitcnt lgkmcnt(10)
    ds_read_b64_tr_b16 a[224:225], v23 offset:10264
    ds_read_b64_tr_b16 a[226:227], v23 offset:12824
    v_mfma_f32_16x16x32_bf16 v[64:67], a[228:231], a[12:15], v[64:67]
    v_mfma_f32_16x16x32_bf16 v[48:51], a[232:235], a[8:11], v[48:51]
    s_waitcnt lgkmcnt(4)
    ds_read_b64_tr_b16 a[228:229], v23 offset:10272
    ds_read_b64_tr_b16 a[230:231], v23 offset:12832
    v_mfma_f32_16x16x32_bf16 v[68:71], a[232:235], a[12:15], v[68:71]
    buffer_load_dwordx4 v4, s[12:15], s57 offen offset:2048 lds
    v_mfma_f32_16x16x32_bf16 v[32:35], a[236:239], a[16:19], v[32:35]
    s_nop 0
    ds_read_b64_tr_b16 a[232:233], v23 offset:15360
    ds_read_b64_tr_b16 a[234:235], v23 offset:17920
    v_mfma_f32_16x16x32_bf16 v[52:55], a[236:239], a[20:23], v[52:55]
    buffer_load_dwordx4 v5, s[12:15], s57 offen offset:3072 lds
    s_add_u32 m0, s40, 45056
    v_mfma_f32_16x16x32_bf16 v[36:39], a[240:243], a[16:19], v[36:39]
    s_waitcnt lgkmcnt(6)
    ds_read_b64_tr_b16 a[236:237], v23 offset:15368
    ds_read_b64_tr_b16 a[238:239], v23 offset:17928
    v_mfma_f32_16x16x32_bf16 v[56:59], a[240:243], a[20:23], v[56:59]
    v_mfma_f32_16x16x32_bf16 v[40:43], a[220:223], a[16:19], v[40:43]
    s_waitcnt lgkmcnt(6)
    ds_read_b64_tr_b16 a[240:241], v23 offset:15376
    ds_read_b64_tr_b16 a[242:243], v23 offset:17936
    v_mfma_f32_16x16x32_bf16 v[60:63], a[220:223], a[20:23], v[60:63]
    buffer_load_dwordx4 v6, s[12:15], s57 offen lds
    v_mfma_f32_16x16x32_bf16 v[44:47], a[224:227], a[16:19], v[44:47]
    s_waitcnt lgkmcnt(6)
    ds_read_b64_tr_b16 a[220:221], v23 offset:15384
    ds_read_b64_tr_b16 a[222:223], v23 offset:17944
    v_mfma_f32_16x16x32_bf16 v[64:67], a[224:227], a[20:23], v[64:67]
    s_add_u32 m0, s41, 4096
    s_add_u32 s58, s39, s38
    buffer_load_dwordx4 v17, s[8:11], s58 offen lds
    s_add_u32 s39, s39, 128
    v_mfma_f32_16x16x32_bf16 v[48:51], a[228:231], a[16:19], v[48:51]
    s_waitcnt lgkmcnt(6)
    ds_read_b64_tr_b16 a[224:225], v23 offset:15392
    ds_read_b64_tr_b16 a[226:227], v23 offset:17952
    v_mfma_f32_16x16x32_bf16 v[68:71], a[228:231], a[20:23], v[68:71]
    v_mfma_f32_16x16x32_bf16 v[32:35], a[232:235], a[24:27], v[32:35]
    s_waitcnt lgkmcnt(6)
    s_waitcnt vmcnt(14)
    s_barrier
    ds_read_b64_tr_b16 a[228:229], v23 offset:20480
    ds_read_b64_tr_b16 a[230:231], v23 offset:23040
    v_mfma_f32_16x16x32_bf16 v[52:55], a[232:235], a[28:31], v[52:55]
    buffer_load_dwordx4 v18, s[8:11], s58 offen offset:1024 lds
    s_cmp_eq_u32 s39, 1280
    s_cselect_b32 s39, 0, s39
    s_waitcnt vmcnt(11)
    ds_read_b128 a[32:35], v21 offset:8192
    ds_read_b128 a[36:39], v21 offset:10240
    v_mfma_f32_16x16x32_bf16 v[36:39], a[236:239], a[24:27], v[36:39]
    s_waitcnt lgkmcnt(8)
    ds_read_b64_tr_b16 a[232:233], v23 offset:20488
    ds_read_b64_tr_b16 a[234:235], v23 offset:23048
    v_mfma_f32_16x16x32_bf16 v[56:59], a[236:239], a[28:31], v[56:59]
    buffer_load_dwordx4 v19, s[8:11], s58 offen offset:2048 lds
    ds_read_b128 a[40:43], v22 offset:8192
    ds_read_b128 a[44:47], v22 offset:10240
    v_mfma_f32_16x16x32_bf16 v[40:43], a[240:243], a[24:27], v[40:43]
    s_waitcnt lgkmcnt(10)
    ds_read_b64_tr_b16 a[236:237], v23 offset:20496
    ds_read_b64_tr_b16 a[238:239], v23 offset:23056
    v_mfma_f32_16x16x32_bf16 v[60:63], a[240:243], a[28:31], v[60:63]
    v_mfma_f32_16x16x32_bf16 v[44:47], a[220:223], a[24:27], v[44:47]
    s_waitcnt lgkmcnt(10)
    ds_read_b64_tr_b16 a[240:241], v23 offset:20504
    ds_read_b64_tr_b16 a[242:243], v23 offset:23064
    v_mfma_f32_16x16x32_bf16 v[64:67], a[220:223], a[28:31], v[64:67]
    buffer_load_dwordx4 v20, s[8:11], s58 offen offset:3072 lds
    v_mfma_f32_16x16x32_bf16 v[48:51], a[224:227], a[24:27], v[48:51]
    s_waitcnt lgkmcnt(4)
    ds_read_b64_tr_b16 a[220:221], v23 offset:20512
    ds_read_b64_tr_b16 a[222:223], v23 offset:23072
    v_mfma_f32_16x16x32_bf16 v[68:71], a[224:227], a[28:31], v[68:71]
    s_cmp_eq_u32 s92, 0
    s_cbranch_scc1 L_u1B
    s_add_u32 m0, s40, 81920
    s_nop 0
    buffer_load_dwordx4 v152, s[16:19], s3 offen lds
    buffer_load_dwordx4 v153, s[16:19], s3 offen offset:1024 lds
    buffer_load_dwordx4 v154, s[16:19], s3 offen offset:2048 lds
    buffer_load_dwordx4 v155, s[16:19], s3 offen offset:3072 lds
    s_add_u32 m0, s40, 86016
    s_nop 0
    buffer_load_dwordx4 v156, s[16:19], s3 offen lds
L_u1B:
    v_mfma_f32_16x16x32_bf16 v[32:35], a[228:231], a[32:35], v[32:35]
    s_nop 0
    ds_read_b64_tr_b16 a[224:225], v23 offset:25600
    ds_read_b64_tr_b16 a[226:227], v23 offset:28160
    v_mfma_f32_16x16x32_bf16 v[52:55], a[228:231], a[36:39], v[52:55]
    v_mfma_f32_16x16x32_bf16 v[36:39], a[232:235], a[32:35], v[36:39]
    s_waitcnt lgkmcnt(6)
    ds_read_b64_tr_b16 a[228:229], v23 offset:25608
    ds_read_b64_tr_b16 a[230:231], v23 offset:28168
    v_mfma_f32_16x16x32_bf16 v[56:59], a[232:235], a[36:39], v[56:59]
    s_add_u32 m0, s41, 8192
    s_add_u32 s58, s39, s38
    buffer_load_dwordx4 v17, s[8:11], s58 offen lds
    s_add_u32 s39, s39, 128
    v_mfma_f32_16x16x32_bf16 v[40:43], a[236:239], a[32:35], v[40:43]
    s_waitcnt lgkmcnt(6)
    ds_read_b64_tr_b16 a[232:233], v23 offset:25616
    ds_read_b64_tr_b16 a[234:235], v23 offset:28176
    v_mfma_f32_16x16x32_bf16 v[60:63], a[236:239], a[36:39], v[60:63]
    buffer_load_dwordx4 v18, s[8:11], s58 offen offset:1024 lds
    s_cmp_eq_u32 s39, 1280
    s_cselect_b32 s39, 0, s39
    v_mfma_f32_16x16x32_bf16 v[44:47], a[240:243], a[32:35], v[44:47]
    s_waitcnt lgkmcnt(6)
    ds_read_b64_tr_b16 a[236:237], v23 offset:25624
    ds_read_b64_tr_b16 a[238:239], v23 offset:28184
    v_mfma_f32_16x16x32_bf16 v[64:67], a[240:243], a[36:39], v[64:67]
    v_mfma_f32_16x16x32_bf16 v[48:51], a[220:223], a[32:35], v[48:51]
    s_waitcnt lgkmcnt(6)
    ds_read_b64_tr_b16 a[240:241], v23 offset:25632
    ds_read_b64_tr_b16 a[242:243], v23 offset:28192
    v_mfma_f32_16x16x32_bf16 v[68:71], a[220:223], a[36:39], v[68:71]
    buffer_load_dwordx4 v19, s[8:11], s58 offen offset:2048 lds
    v_mfma_f32_16x16x32_bf16 v[32:35], a[224:227], a[40:43], v[32:35]
    s_waitcnt lgkmcnt(6)
    ds_read_b64_tr_b16 a[220:221], v23 offset:30720
    ds_read_b64_tr_b16 a[222:223], v23 offset:33280
    v_mfma_f32_16x16x32_bf16 v[52:55], a[224:227], a[44:47], v[52:55]
    buffer_load_dwordx4 v20, s[8:11], s58 offen offset:3072 lds
    s_waitcnt vmcnt(13)
    ds_read_b128 a[48:51], v21 offset:0
    ds_read_b128 a[52:55], v21 offset:2048
    v_mfma_f32_16x16x32_bf16 v[36:39], a[228:231], a[40:43], v[36:39]
    s_waitcnt lgkmcnt(8)
    ds_read_b64_tr_b16 a[224:225], v23 offset:30728
    ds_read_b64_tr_b16 a[226:227], v23 offset:33288
    v_mfma_f32_16x16x32_bf16 v[56:59], a[228:231], a[44:47], v[56:59]
    ds_read_b128 a[56:59], v22 offset:0
    ds_read_b128 a[60:63], v22 offset:2048
    v_mfma_f32_16x16x32_bf16 v[40:43], a[232:235], a[40:43], v[40:43]
    s_waitcnt lgkmcnt(10)
    ds_read_b64_tr_b16 a[228:229], v23 offset:30736
    ds_read_b64_tr_b16 a[230:231], v23 offset:33296
    v_mfma_f32_16x16x32_bf16 v[60:63], a[232:235], a[44:47], v[60:63]
    s_add_u32 m0, s40, 61440
    s_add_u32 s57, s36, 1280
    buffer_load_dwordx4 v2, s[12:15], s57 offen lds
    v_mfma_f32_16x16x32_bf16 v[44:47], a[236:239], a[40:43], v[44:47]
    s_waitcnt lgkmcnt(10)
    ds_read_b64_tr_b16 a[232:233], v23 offset:30744
    ds_read_b64_tr_b16 a[234:235], v23 offset:33304
    v_mfma_f32_16x16x32_bf16 v[64:67], a[236:239], a[44:47], v[64:67]
    buffer_load_dwordx4 v3, s[12:15], s57 offen offset:1024 lds
    v_mfma_f32_16x16x32_bf16 v[48:51], a[240:243], a[40:43], v[48:51]
    s_waitcnt lgkmcnt(4)
    ds_read_b64_tr_b16 a[236:237], v23 offset:30752
    ds_read_b64_tr_b16 a[238:239], v23 offset:33312
    v_mfma_f32_16x16x32_bf16 v[68:71], a[240:243], a[44:47], v[68:71]
    v_mfma_f32_16x16x32_bf16 v[32:35], a[220:223], a[48:51], v[32:35]
    s_nop 0
    ds_read_b64_tr_b16 a[240:241], v23 offset:35840
    ds_read_b64_tr_b16 a[242:243], v23 offset:38400
    v_mfma_f32_16x16x32_bf16 v[52:55], a[220:223], a[52:55], v[52:55]
    buffer_load_dwordx4 v4, s[12:15], s57 offen offset:2048 lds
    v_mfma_f32_16x16x32_bf16 v[36:39], a[224:227], a[48:51], v[36:39]
    s_waitcnt lgkmcnt(6)
    ds_read_b64_tr_b16 a[220:221], v23 offset:35848
    ds_read_b64_tr_b16 a[222:223], v23 offset:38408
    v_mfma_f32_16x16x32_bf16 v[56:59], a[224:227], a[52:55], v[56:59]
    buffer_load_dwordx4 v5, s[12:15], s57 offen offset:3072 lds
    s_add_u32 m0, s40, 65536
    v_mfma_f32_16x16x32_bf16 v[40:43], a[228:231], a[48:51], v[40:43]
    s_waitcnt lgkmcnt(6)
    ds_read_b64_tr_b16 a[224:225], v23 offset:35856
    ds_read_b64_tr_b16 a[226:227], v23 offset:38416
    v_mfma_f32_16x16x32_bf16 v[60:63], a[228:231], a[52:55], v[60:63]
    v_mfma_f32_16x16x32_bf16 v[44:47], a[232:235], a[48:51], v[44:47]
    s_waitcnt lgkmcnt(6)
    ds_read_b64_tr_b16 a[228:229], v23 offset:35864
    ds_read_b64_tr_b16 a[230:231], v23 offset:38424
    v_mfma_f32_16x16x32_bf16 v[64:67], a[232:235], a[52:55], v[64:67]
    buffer_load_dwordx4 v6, s[12:15], s57 offen lds
    v_mfma_f32_16x16x32_bf16 v[48:51], a[236:239], a[48:51], v[48:51]
    s_waitcnt lgkmcnt(6)
    ds_read_b64_tr_b16 a[232:233], v23 offset:35872
    ds_read_b64_tr_b16 a[234:235], v23 offset:38432
    v_mfma_f32_16x16x32_bf16 v[68:71], a[236:239], a[52:55], v[68:71]
    s_add_u32 m0, s41, 0
    s_add_u32 s58, s39, s38
    buffer_load_dwordx4 v17, s[8:11], s58 offen lds
    s_add_u32 s39, s39, 128
    v_mfma_f32_16x16x32_bf16 v[32:35], a[240:243], a[56:59], v[32:35]
    s_waitcnt lgkmcnt(6)
    s_waitcnt vmcnt(14)
    s_barrier
    ds_read_b64_tr_b16 a[236:237], v23 offset:40960
    ds_read_b64_tr_b16 a[238:239], v23 offset:43520
    v_mfma_f32_16x16x32_bf16 v[52:55], a[240:243], a[60:63], v[52:55]
    s_waitcnt vmcnt(10)
    ds_read_b128 a[64:67], v21 offset:4096
    ds_read_b128 a[68:71], v21 offset:6144
    v_mfma_f32_16x16x32_bf16 v[36:39], a[220:223], a[56:59], v[36:39]
    s_waitcnt lgkmcnt(8)
    ds_read_b64_tr_b16 a[240:241], v23 offset:40968
    ds_read_b64_tr_b16 a[242:243], v23 offset:43528
    v_mfma_f32_16x16x32_bf16 v[56:59], a[220:223], a[60:63], v[56:59]
    buffer_load_dwordx4 v18, s[8:11], s58 offen offset:1024 lds
    s_cmp_eq_u32 s39, 1280
    s_cselect_b32 s39, 0, s39
    ds_read_b128 a[72:75], v22 offset:4096
    ds_read_b128 a[76:79], v22 offset:6144
    v_mfma_f32_16x16x32_bf16 v[40:43], a[224:227], a[56:59], v[40:43]
    s_waitcnt lgkmcnt(10)
    ds_read_b64_tr_b16 a[220:221], v23 offset:40976
    ds_read_b64_tr_b16 a[222:223], v23 offset:43536
    v_mfma_f32_16x16x32_bf16 v[60:63], a[224:227], a[60:63], v[60:63]
    buffer_load_dwordx4 v19, s[8:11], s58 offen offset:2048 lds
    v_mfma_f32_16x16x32_bf16 v[44:47], a[228:231], a[56:59], v[44:47]
    s_waitcnt lgkmcnt(10)
    ds_read_b64_tr_b16 a[224:225], v23 offset:40984
    ds_read_b64_tr_b16 a[226:227], v23 offset:43544
    v_mfma_f32_16x16x32_bf16 v[64:67], a[228:231], a[60:63], v[64:67]
    v_mfma_f32_16x16x32_bf16 v[48:51], a[232:235], a[56:59], v[48:51]
    s_waitcnt lgkmcnt(4)
    ds_read_b64_tr_b16 a[228:229], v23 offset:40992
    ds_read_b64_tr_b16 a[230:231], v23 offset:43552
    v_mfma_f32_16x16x32_bf16 v[68:71], a[232:235], a[60:63], v[68:71]
    buffer_load_dwordx4 v20, s[8:11], s58 offen offset:3072 lds
    v_mfma_f32_16x16x32_bf16 v[32:35], a[236:239], a[64:67], v[32:35]
    s_nop 0
    ds_read_b64_tr_b16 a[232:233], v23 offset:46080
    ds_read_b64_tr_b16 a[234:235], v23 offset:48640
    v_mfma_f32_16x16x32_bf16 v[52:55], a[236:239], a[68:71], v[52:55]
    s_add_u32 m0, s41, 4096
    s_add_u32 s58, s39, s38
    buffer_load_dwordx4 v17, s[8:11], s58 offen lds
    s_add_u32 s39, s39, 128
    v_mfma_f32_16x16x32_bf16 v[36:39], a[240:243], a[64:67], v[36:39]
    s_waitcnt lgkmcnt(6)
    ds_read_b64_tr_b16 a[236:237], v23 offset:46088
    ds_read_b64_tr_b16 a[238:239], v23 offset:48648
    v_mfma_f32_16x16x32_bf16 v[56:59], a[240:243], a[68:71], v[56:59]
    v_mfma_f32_16x16x32_bf16 v[40:43], a[220:223], a[64:67], v[40:43]
    s_waitcnt lgkmcnt(6)
    ds_read_b64_tr_b16 a[240:241], v23 offset:46096
    ds_read_b64_tr_b16 a[242:243], v23 offset:48656
    v_mfma_f32_16x16x32_bf16 v[60:63], a[220:223], a[68:71], v[60:63]
    buffer_load_dwordx4 v18, s[8:11], s58 offen offset:1024 lds
    s_cmp_eq_u32 s39, 1280
    s_cselect_b32 s39, 0, s39
    v_mfma_f32_16x16x32_bf16 v[44:47], a[224:227], a[64:67], v[44:47]
    s_waitcnt lgkmcnt(6)
    ds_read_b64_tr_b16 a[220:221], v23 offset:46104
    ds_read_b64_tr_b16 a[222:223], v23 offset:48664
    v_mfma_f32_16x16x32_bf16 v[64:67], a[224:227], a[68:71], v[64:67]
    buffer_load_dwordx4 v19, s[8:11], s58 offen offset:2048 lds
    v_mfma_f32_16x16x32_bf16 v[48:51], a[228:231], a[64:67], v[48:51]
    s_waitcnt lgkmcnt(6)
    ds_read_b64_tr_b16 a[224:225], v23 offset:46112
    ds_read_b64_tr_b16 a[226:227], v23 offset:48672
    v_mfma_f32_16x16x32_bf16 v[68:71], a[228:231], a[68:71], v[68:71]
    s_cmp_eq_u32 s92, 0
    s_cbranch_scc1 L_u2rB
    s_waitcnt vmcnt(16) lgkmcnt(0)
    ds_read_b64_tr_b16 v[172:173], v157
    ds_read_b64_tr_b16 v[174:175], v158
    ds_read_b64_tr_b16 v[176:177], v159
    ds_read_b64_tr_b16 v[178:179], v160
    ds_read_b64_tr_b16 v[180:181], v161
    ds_read_b64_tr_b16 v[182:183], v162
    ds_read_b64_tr_b16 v[184:185], v163
    ds_read_b64_tr_b16 v[186:187], v164
    ds_read_b64_tr_b16 v[188:189], v165
    ds_read_b64_tr_b16 v[190:191], v166
    s_waitcnt lgkmcnt(0)
L_u2rB:
    v_mfma_f32_16x16x32_bf16 v[32:35], a[232:235], a[72:75], v[32:35]
    s_waitcnt lgkmcnt(6)
    ds_read_b64_tr_b16 a[228:229], v24 offset:0
    ds_read_b64_tr_b16 a[230:231], v24 offset:2560
    v_mfma_f32_16x16x32_bf16 v[52:55], a[232:235], a[76:79], v[52:55]
    buffer_load_dwordx4 v20, s[8:11], s58 offen offset:3072 lds
    s_waitcnt vmcnt(13)
    ds_read_b128 a[80:83], v21 offset:8192
    ds_read_b128 a[84:87], v21 offset:10240
    v_mfma_f32_16x16x32_bf16 v[36:39], a[236:239], a[72:75], v[36:39]
    s_waitcnt lgkmcnt(8)
    ds_read_b64_tr_b16 a[232:233], v24 offset:8
    ds_read_b64_tr_b16 a[234:235], v24 offset:2568
    v_mfma_f32_16x16x32_bf16 v[56:59], a[236:239], a[76:79], v[56:59]
    s_add_u32 m0, s40, 81920
    s_add_u32 s57, s37, 1280
    buffer_load_dwordx4 v2, s[12:15], s57 offen lds
    ds_read_b128 a[88:91], v22 offset:8192
    ds_read_b128 a[92:95], v22 offset:10240
    v_mfma_f32_16x16x32_bf16 v[40:43], a[240:243], a[72:75], v[40:43]
    s_waitcnt lgkmcnt(10)
    ds_read_b64_tr_b16 a[236:237], v24 offset:16
    ds_read_b64_tr_b16 a[238:239], v24 offset:2576
    v_mfma_f32_16x16x32_bf16 v[60:63], a[240:243], a[76:79], v[60:63]
    v_mfma_f32_16x16x32_bf16 v[44:47], a[220:223], a[72:75], v[44:47]
    s_waitcnt lgkmcnt(10)
    ds_read_b64_tr_b16 a[240:241], v24 offset:24
    ds_read_b64_tr_b16 a[242:243], v24 offset:2584
    v_mfma_f32_16x16x32_bf16 v[64:67], a[220:223], a[76:79], v[64:67]
    buffer_load_dwordx4 v3, s[12:15], s57 offen offset:1024 lds
    v_mfma_f32_16x16x32_bf16 v[48:51], a[224:227], a[72:75], v[48:51]
    s_waitcnt lgkmcnt(4)
    ds_read_b64_tr_b16 a[220:221], v24 offset:32
    ds_read_b64_tr_b16 a[222:223], v24 offset:2592
    v_mfma_f32_16x16x32_bf16 v[68:71], a[224:227], a[76:79], v[68:71]
    buffer_load_dwordx4 v4, s[12:15], s57 offen offset:2048 lds
    v_mfma_f32_16x16x32_bf16 v[32:35], a[228:231], a[80:83], v[32:35]
    s_nop 0
    ds_read_b64_tr_b16 a[224:225], v24 offset:5120
    ds_read_b64_tr_b16 a[226:227], v24 offset:7680
    v_mfma_f32_16x16x32_bf16 v[52:55], a[228:231], a[84:87], v[52:55]
    v_mfma_f32_16x16x32_bf16 v[36:39], a[232:235], a[80:83], v[36:39]
    s_waitcnt lgkmcnt(6)
    ds_read_b64_tr_b16 a[228:229], v24 offset:5128
    ds_read_b64_tr_b16 a[230:231], v24 offset:7688
    v_mfma_f32_16x16x32_bf16 v[56:59], a[232:235], a[84:87], v[56:59]
    buffer_load_dwordx4 v5, s[12:15], s57 offen offset:3072 lds
    s_add_u32 m0, s40, 86016
    v_mfma_f32_16x16x32_bf16 v[40:43], a[236:239], a[80:83], v[40:43]
    s_waitcnt lgkmcnt(6)
    ds_read_b64_tr_b16 a[232:233], v24 offset:5136
    ds_read_b64_tr_b16 a[234:235], v24 offset:7696
    v_mfma_f32_16x16x32_bf16 v[60:63], a[236:239], a[84:87], v[60:63]
    buffer_load_dwordx4 v6, s[12:15], s57 offen lds
    v_mfma_f32_16x16x32_bf16 v[44:47], a[240:243], a[80:83], v[44:47]
    s_waitcnt lgkmcnt(6)
    ds_read_b64_tr_b16 a[236:237], v24 offset:5144
    ds_read_b64_tr_b16 a[238:239], v24 offset:7704
    v_mfma_f32_16x16x32_bf16 v[64:67], a[240:243], a[84:87], v[64:67]
    v_mfma_f32_16x16x32_bf16 v[48:51], a[220:223], a[80:83], v[48:51]
    s_waitcnt lgkmcnt(6)
    ds_read_b64_tr_b16 a[240:241], v24 offset:5152
    ds_read_b64_tr_b16 a[242:243], v24 offset:7712
    v_mfma_f32_16x16x32_bf16 v[68:71], a[220:223], a[84:87], v[68:71]
    s_add_u32 m0, s41, 8192
    s_add_u32 s58, s39, s38
    buffer_load_dwordx4 v17, s[8:11], s58 offen lds
    s_add_u32 s39, s39, 128
    v_mfma_f32_16x16x32_bf16 v[32:35], a[224:227], a[88:91], v[32:35]
    s_waitcnt lgkmcnt(6)
    s_waitcnt vmcnt(14)
    s_barrier
    ds_read_b64_tr_b16 a[220:221], v24 offset:10240
    ds_read_b64_tr_b16 a[222:223], v24 offset:12800
    v_mfma_f32_16x16x32_bf16 v[52:55], a[224:227], a[92:95], v[52:55]
    buffer_load_dwordx4 v18, s[8:11], s58 offen offset:1024 lds
    s_cmp_eq_u32 s39, 1280
    s_cselect_b32 s39, 0, s39
    s_waitcnt vmcnt(11)
    ds_read_b128 a[96:99], v21 offset:0
    ds_read_b128 a[100:103], v21 offset:2048
    v_mfma_f32_16x16x32_bf16 v[36:39], a[228:231], a[88:91], v[36:39]
    s_waitcnt lgkmcnt(8)
    ds_read_b64_tr_b16 a[224:225], v24 offset:10248
    ds_read_b64_tr_b16 a[226:227], v24 offset:12808
    v_mfma_f32_16x16x32_bf16 v[56:59], a[228:231], a[92:95], v[56:59]
    ds_read_b128 a[104:107], v22 offset:0
    ds_read_b128 a[108:111], v22 offset:2048
    v_mfma_f32_16x16x32_bf16 v[40:43], a[232:235], a[88:91], v[40:43]
    s_waitcnt lgkmcnt(10)
    ds_read_b64_tr_b16 a[228:229], v24 offset:10256
    ds_read_b64_tr_b16 a[230:231], v24 offset:12816
    v_mfma_f32_16x16x32_bf16 v[60:63], a[232:235], a[92:95], v[60:63]
    buffer_load_dwordx4 v19, s[8:11], s58 offen offset:2048 lds
    v_mfma_f32_16x16x32_bf16 v[44:47], a[236:239], a[88:91], v[44:47]
    s_waitcnt lgkmcnt(10)
    ds_read_b64_tr_b16 a[232:233], v24 offset:10264
    ds_read_b64_tr_b16 a[234:235], v24 offset:12824
    v_mfma_f32_16x16x32_bf16 v[64:67], a[236:239], a[92:95], v[64:67]
    buffer_load_dwordx4 v20, s[8:11], s58 offen offset:3072 lds
    v_mfma_f32_16x16x32_bf16 v[48:51], a[240:243], a[88:91], v[48:51]
    s_waitcnt lgkmcnt(4)
    ds_read_b64_tr_b16 a[236:237], v24 offset:10272
    ds_read_b64_tr_b16 a[238:239], v24 offset:12832
    v_mfma_f32_16x16x32_bf16 v[68:71], a[240:243], a[92:95], v[68:71]
    v_mfma_f32_16x16x32_bf16 v[32:35], a[220:223], a[96:99], v[32:35]
    s_nop 0
    ds_read_b64_tr_b16 a[240:241], v24 offset:15360
    ds_read_b64_tr_b16 a[242:243], v24 offset:17920
    v_mfma_f32_16x16x32_bf16 v[52:55], a[220:223], a[100:103], v[52:55]
    s_add_u32 m0, s41, 0
    s_add_u32 s58, s39, s38
    buffer_load_dwordx4 v17, s[8:11], s58 offen lds
    s_add_u32 s39, s39, 128
    v_mfma_f32_16x16x32_bf16 v[36:39], a[224:227], a[96:99], v[36:39]
    s_waitcnt lgkmcnt(6)
    ds_read_b64_tr_b16 a[220:221], v24 offset:15368
    ds_read_b64_tr_b16 a[222:223], v24 offset:17928
    v_mfma_f32_16x16x32_bf16 v[56:59], a[224:227], a[100:103], v[56:59]
    buffer_load_dwordx4 v18, s[8:11], s58 offen offset:1024 lds
    s_cmp_eq_u32 s39, 1280
    s_cselect_b32 s39, 0, s39
    v_mfma_f32_16x16x32_bf16 v[40:43], a[228:231], a[96:99], v[40:43]
    s_waitcnt lgkmcnt(6)
    ds_read_b64_tr_b16 a[224:225], v24 offset:15376
    ds_read_b64_tr_b16 a[226:227], v24 offset:17936
    v_mfma_f32_16x16x32_bf16 v[60:63], a[228:231], a[100:103], v[60:63]
    v_mfma_f32_16x16x32_bf16 v[44:47], a[232:235], a[96:99], v[44:47]
    s_waitcnt lgkmcnt(6)
    ds_read_b64_tr_b16 a[228:229], v24 offset:15384
    ds_read_b64_tr_b16 a[230:231], v24 offset:17944
    v_mfma_f32_16x16x32_bf16 v[64:67], a[232:235], a[100:103], v[64:67]
    buffer_load_dwordx4 v19, s[8:11], s58 offen offset:2048 lds
    v_mfma_f32_16x16x32_bf16 v[48:51], a[236:239], a[96:99], v[48:51]
    s_waitcnt lgkmcnt(6)
    ds_read_b64_tr_b16 a[232:233], v24 offset:15392
    ds_read_b64_tr_b16 a[234:235], v24 offset:17952
    v_mfma_f32_16x16x32_bf16 v[68:71], a[236:239], a[100:103], v[68:71]
    buffer_load_dwordx4 v20, s[8:11], s58 offen offset:3072 lds
    v_mfma_f32_16x16x32_bf16 v[32:35], a[240:243], a[104:107], v[32:35]
    s_waitcnt lgkmcnt(6)
    ds_read_b64_tr_b16 a[236:237], v24 offset:20480
    ds_read_b64_tr_b16 a[238:239], v24 offset:23040
    v_mfma_f32_16x16x32_bf16 v[52:55], a[240:243], a[108:111], v[52:55]
    s_waitcnt vmcnt(13)
    ds_read_b128 a[112:115], v21 offset:4096
    ds_read_b128 a[116:119], v21 offset:6144
    v_mfma_f32_16x16x32_bf16 v[36:39], a[220:223], a[104:107], v[36:39]
    s_waitcnt lgkmcnt(8)
    ds_read_b64_tr_b16 a[240:241], v24 offset:20488
    ds_read_b64_tr_b16 a[242:243], v24 offset:23048
    v_mfma_f32_16x16x32_bf16 v[56:59], a[220:223], a[108:111], v[56:59]
    s_add_u32 m0, s40, 0
    s_add_u32 s57, s37, 2560
    buffer_load_dwordx4 v2, s[12:15], s57 offen lds
    ds_read_b128 a[120:123], v22 offset:4096
    ds_read_b128 a[124:127], v22 offset:6144
    v_mfma_f32_16x16x32_bf16 v[40:43], a[224:227], a[104:107], v[40:43]
    s_waitcnt lgkmcnt(10)
    ds_read_b64_tr_b16 a[220:221], v24 offset:20496
    ds_read_b64_tr_b16 a[222:223], v24 offset:23056
    v_mfma_f32_16x16x32_bf16 v[60:63], a[224:227], a[108:111], v[60:63]
    buffer_load_dwordx4 v3, s[12:15], s57 offen offset:1024 lds
    v_mfma_f32_16x16x32_bf16 v[44:47], a[228:231], a[104:107], v[44:47]
    s_waitcnt lgkmcnt(10)
    ds_read_b64_tr_b16 a[224:225], v24 offset:20504
    ds_read_b64_tr_b16 a[226:227], v24 offset:23064
    v_mfma_f32_16x16x32_bf16 v[64:67], a[228:231], a[108:111], v[64:67]
    v_mfma_f32_16x16x32_bf16 v[48:51], a[232:235], a[104:107], v[48:51]
    s_waitcnt lgkmcnt(4)
    ds_read_b64_tr_b16 a[228:229], v24 offset:20512
    ds_read_b64_tr_b16 a[230:231], v24 offset:23072
    v_mfma_f32_16x16x32_bf16 v[68:71], a[232:235], a[108:111], v[68:71]
    buffer_load_dwordx4 v4, s[12:15], s57 offen offset:2048 lds
    v_mfma_f32_16x16x32_bf16 v[32:35], a[236:239], a[112:115], v[32:35]
    s_nop 0
    ds_read_b64_tr_b16 a[232:233], v24 offset:25600
    ds_read_b64_tr_b16 a[234:235], v24 offset:28160
    v_mfma_f32_16x16x32_bf16 v[52:55], a[236:239], a[116:119], v[52:55]
    v_mfma_f32_16x16x32_bf16 v[36:39], a[240:243], a[112:115], v[36:39]
    s_waitcnt lgkmcnt(6)
    ds_read_b64_tr_b16 a[236:237], v24 offset:25608
    ds_read_b64_tr_b16 a[238:239], v24 offset:28168
    v_mfma_f32_16x16x32_bf16 v[56:59], a[240:243], a[116:119], v[56:59]
    v_mfma_f32_16x16x32_bf16 v[40:43], a[220:223], a[112:115], v[40:43]
    s_waitcnt lgkmcnt(6)
    ds_read_b64_tr_b16 a[240:241], v24 offset:25616
    ds_read_b64_tr_b16 a[242:243], v24 offset:28176
    v_mfma_f32_16x16x32_bf16 v[60:63], a[220:223], a[116:119], v[60:63]
    buffer_load_dwordx4 v5, s[12:15], s57 offen offset:3072 lds
    s_add_u32 m0, s40, 4096
    v_mfma_f32_16x16x32_bf16 v[44:47], a[224:227], a[112:115], v[44:47]
    s_waitcnt lgkmcnt(6)
    ds_read_b64_tr_b16 a[220:221], v24 offset:25624
    ds_read_b64_tr_b16 a[222:223], v24 offset:28184
    v_mfma_f32_16x16x32_bf16 v[64:67], a[224:227], a[116:119], v[64:67]
    v_mfma_f32_16x16x32_bf16 v[48:51], a[228:231], a[112:115], v[48:51]
    s_waitcnt lgkmcnt(6)
    ds_read_b64_tr_b16 a[224:225], v24 offset:25632
    ds_read_b64_tr_b16 a[226:227], v24 offset:28192
    v_mfma_f32_16x16x32_bf16 v[68:71], a[228:231], a[116:119], v[68:71]
    v_mfma_f32_16x16x32_bf16 v[32:35], a[232:235], a[120:123], v[32:35]
    s_waitcnt lgkmcnt(6)
    s_waitcnt vmcnt(12)
    s_barrier
    ds_read_b64_tr_b16 a[228:229], v24 offset:30720
    ds_read_b64_tr_b16 a[230:231], v24 offset:33280
    v_mfma_f32_16x16x32_bf16 v[52:55], a[232:235], a[124:127], v[52:55]
    buffer_load_dwordx4 v6, s[12:15], s57 offen lds
    s_waitcnt vmcnt(9)
    ds_read_b128 a[128:131], v21 offset:8192
    ds_read_b128 a[132:135], v21 offset:10240
    v_mfma_f32_16x16x32_bf16 v[36:39], a[236:239], a[120:123], v[36:39]
    s_waitcnt lgkmcnt(8)
    ds_read_b64_tr_b16 a[232:233], v24 offset:30728
    ds_read_b64_tr_b16 a[234:235], v24 offset:33288
    v_mfma_f32_16x16x32_bf16 v[56:59], a[236:239], a[124:127], v[56:59]
    ds_read_b128 a[136:139], v22 offset:8192
    ds_read_b128 a[140:143], v22 offset:10240
    v_mfma_f32_16x16x32_bf16 v[40:43], a[240:243], a[120:123], v[40:43]
    s_waitcnt lgkmcnt(10)
    ds_read_b64_tr_b16 a[236:237], v24 offset:30736
    ds_read_b64_tr_b16 a[238:239], v24 offset:33296
    v_mfma_f32_16x16x32_bf16 v[60:63], a[240:243], a[124:127], v[60:63]
L_hop1B:
    s_cbranch_execz L_hop5B
    v_mfma_f32_16x16x32_bf16 v[44:47], a[220:223], a[120:123], v[44:47]
    s_waitcnt lgkmcnt(10)
    ds_read_b64_tr_b16 a[240:241], v24 offset:30744
    ds_read_b64_tr_b16 a[242:243], v24 offset:33304
    v_mfma_f32_16x16x32_bf16 v[64:67], a[220:223], a[124:127], v[64:67]
    s_add_u32 m0, s40, 20480
    s_add_u32 s57, s36, 2560
    buffer_load_dwordx4 v2, s[12:15], s57 offen lds
    v_mfma_f32_16x16x32_bf16 v[48:51], a[224:227], a[120:123], v[48:51]
    s_waitcnt lgkmcnt(4)
    ds_read_b64_tr_b16 a[220:221], v24 offset:30752
    ds_read_b64_tr_b16 a[222:223], v24 offset:33312
    v_mfma_f32_16x16x32_bf16 v[68:71], a[224:227], a[124:127], v[68:71]
    v_mfma_f32_16x16x32_bf16 v[32:35], a[228:231], a[128:131], v[32:35]
    s_nop 0
    ds_read_b64_tr_b16 a[224:225], v24 offset:35840
    ds_read_b64_tr_b16 a[226:227], v24 offset:38400
    v_mfma_f32_16x16x32_bf16 v[52:55], a[228:231], a[132:135], v[52:55]
    v_mfma_f32_16x16x32_bf16 v[36:39], a[232:235], a[128:131], v[36:39]
    s_waitcnt lgkmcnt(6)
    ds_read_b64_tr_b16 a[228:229], v24 offset:35848
    ds_read_b64_tr_b16 a[230:231], v24 offset:38408
    v_mfma_f32_16x16x32_bf16 v[56:59], a[232:235], a[132:135], v[56:59]
    buffer_load_dwordx4 v3, s[12:15], s57 offen offset:1024 lds
    v_mfma_f32_16x16x32_bf16 v[40:43], a[236:239], a[128:131], v[40:43]
    s_waitcnt lgkmcnt(6)
    ds_read_b64_tr_b16 a[232:233], v24 offset:35856
    ds_read_b64_tr_b16 a[234:235], v24 offset:38416
    v_mfma_f32_16x16x32_bf16 v[60:63], a[236:239], a[132:135], v[60:63]
    v_mfma_f32_16x16x32_bf16 v[44:47], a[240:243], a[128:131], v[44:47]
    s_waitcnt lgkmcnt(6)
    ds_read_b64_tr_b16 a[236:237], v24 offset:35864
    ds_read_b64_tr_b16 a[238:239], v24 offset:38424
    v_mfma_f32_16x16x32_bf16 v[64:67], a[240:243], a[132:135], v[64:67]
    v_mfma_f32_16x16x32_bf16 v[48:51], a[220:223], a[128:131], v[48:51]
    s_waitcnt lgkmcnt(6)
    ds_read_b64_tr_b16 a[240:241], v24 offset:35872
    ds_read_b64_tr_b16 a[242:243], v24 offset:38432
    v_mfma_f32_16x16x32_bf16 v[68:71], a[220:223], a[132:135], v[68:71]
    buffer_load_dwordx4 v4, s[12:15], s57 offen offset:2048 lds
    v_mfma_f32_16x16x32_bf16 v[32:35], a[224:227], a[136:139], v[32:35]
    s_waitcnt lgkmcnt(6)
    ds_read_b64_tr_b16 a[220:221], v24 offset:40960
    ds_read_b64_tr_b16 a[222:223], v24 offset:43520
    v_mfma_f32_16x16x32_bf16 v[52:55], a[224:227], a[140:143], v[52:55]
    s_waitcnt vmcnt(8)
    ds_read_b128 a[144:147], v21 offset:0
    ds_read_b128 a[148:151], v21 offset:2048
    v_mfma_f32_16x16x32_bf16 v[36:39], a[228:231], a[136:139], v[36:39]
    s_waitcnt lgkmcnt(8)
    ds_read_b64_tr_b16 a[224:225], v24 offset:40968
    ds_read_b64_tr_b16 a[226:227], v24 offset:43528
    v_mfma_f32_16x16x32_bf16 v[56:59], a[228:231], a[140:143], v[56:59]
    ds_read_b128 a[152:155], v22 offset:0
    ds_read_b128 a[156:159], v22 offset:2048
    v_mfma_f32_16x16x32_bf16 v[40:43], a[232:235], a[136:139], v[40:43]
    s_waitcnt lgkmcnt(10)
    ds_read_b64_tr_b16 a[228:229], v24 offset:40976
    ds_read_b64_tr_b16 a[230:231], v24 offset:43536
    v_mfma_f32_16x16x32_bf16 v[60:63], a[232:235], a[140:143], v[60:63]
    buffer_load_dwordx4 v5, s[12:15], s57 offen offset:3072 lds
    s_add_u32 m0, s40, 24576
    v_mfma_f32_16x16x32_bf16 v[44:47], a[236:239], a[136:139], v[44:47]
    s_waitcnt lgkmcnt(10)
    ds_read_b64_tr_b16 a[232:233], v24 offset:40984
    ds_read_b64_tr_b16 a[234:235], v24 offset:43544
    v_mfma_f32_16x16x32_bf16 v[64:67], a[236:239], a[140:143], v[64:67]
    v_mfma_f32_16x16x32_bf16 v[48:51], a[240:243], a[136:139], v[48:51]
    s_waitcnt lgkmcnt(4)
    ds_read_b64_tr_b16 a[236:237], v24 offset:40992
    ds_read_b64_tr_b16 a[238:239], v24 offset:43552
    v_mfma_f32_16x16x32_bf16 v[68:71], a[240:243], a[140:143], v[68:71]
    v_mfma_f32_16x16x32_bf16 v[32:35], a[220:223], a[144:147], v[32:35]
    s_nop 0
    ds_read_b64_tr_b16 a[240:241], v24 offset:46080
    ds_read_b64_tr_b16 a[242:243], v24 offset:48640
    v_mfma_f32_16x16x32_bf16 v[52:55], a[220:223], a[148:151], v[52:55]
    buffer_load_dwordx4 v6, s[12:15], s57 offen lds
    s_cmp_eq_u32 s92, 0
    s_cbranch_scc1 L_u2aB
    buffer_store_dwordx4 v[172:175], v192, s[20:23], s6 offen sc1
L_u2aB:
    v_mfma_f32_16x16x32_bf16 v[36:39], a[224:227], a[144:147], v[36:39]
    s_waitcnt lgkmcnt(6)
    ds_read_b64_tr_b16 a[220:221], v24 offset:46088
    ds_read_b64_tr_b16 a[222:223], v24 offset:48648
    v_mfma_f32_16x16x32_bf16 v[56:59], a[224:227], a[148:151], v[56:59]
    v_mfma_f32_16x16x32_bf16 v[40:43], a[228:231], a[144:147], v[40:43]
    s_waitcnt lgkmcnt(6)
    ds_read_b64_tr_b16 a[224:225], v24 offset:46096
    ds_read_b64_tr_b16 a[226:227], v24 offset:48656
    v_mfma_f32_16x16x32_bf16 v[60:63], a[228:231], a[148:151], v[60:63]
    v_mfma_f32_16x16x32_bf16 v[44:47], a[232:235], a[144:147], v[44:47]
    s_waitcnt lgkmcnt(6)
    ds_read_b64_tr_b16 a[228:229], v24 offset:46104
    ds_read_b64_tr_b16 a[230:231], v24 offset:48664
    v_mfma_f32_16x16x32_bf16 v[64:67], a[232:235], a[148:151], v[64:67]
    s_add_u32 m0, s40, 40960
    s_add_u32 s57, s35, 2560
    buffer_load_dwordx4 v2, s[12:15], s57 offen lds
    v_mfma_f32_16x16x32_bf16 v[48:51], a[236:239], a[144:147], v[48:51]
    s_waitcnt lgkmcnt(6)
    ds_read_b64_tr_b16 a[232:233], v24 offset:46112
    ds_read_b64_tr_b16 a[234:235], v24 offset:48672
    v_mfma_f32_16x16x32_bf16 v[68:71], a[236:239], a[148:151], v[68:71]
    s_cmp_eq_u32 s92, 0
    s_cbranch_scc1 L_u2bB
    buffer_store_dwordx4 v[176:179], v193, s[20:23], s6 offen sc1
L_u2bB:
    v_mfma_f32_16x16x32_bf16 v[32:35], a[240:243], a[152:155], v[32:35]
    s_waitcnt lgkmcnt(6)
    v_mfma_f32_16x16x32_bf16 v[52:55], a[240:243], a[156:159], v[52:55]
    v_mfma_f32_16x16x32_bf16 v[36:39], a[220:223], a[152:155], v[36:39]
    s_waitcnt lgkmcnt(4)
    v_mfma_f32_16x16x32_bf16 v[56:59], a[220:223], a[156:159], v[56:59]
    buffer_load_dwordx4 v3, s[12:15], s57 offen offset:1024 lds
    v_mfma_f32_16x16x32_bf16 v[40:43], a[224:227], a[152:155], v[40:43]
    s_waitcnt lgkmcnt(2)
    v_mfma_f32_16x16x32_bf16 v[60:63], a[224:227], a[156:159], v[60:63]
    v_mfma_f32_16x16x32_bf16 v[44:47], a[228:231], a[152:155], v[44:47]
    s_waitcnt lgkmcnt(0)
    v_mfma_f32_16x16x32_bf16 v[64:67], a[228:231], a[156:159], v[64:67]
    s_cmp_eq_u32 s92, 0
    s_cbranch_scc1 L_u2cB
    buffer_store_dwordx4 v[180:183], v194, s[20:23], s6 offen sc1
L_u2cB:
    v_mfma_f32_16x16x32_bf16 v[48:51], a[232:235], a[152:155], v[48:51]
    v_mfma_f32_16x16x32_bf16 v[68:71], a[232:235], a[156:159], v[68:71]
    buffer_load_dwordx4 v4, s[12:15], s57 offen offset:2048 lds
    s_waitcnt vmcnt(8)
    s_barrier
    ds_read_b64_tr_b16 a[236:237], v23 offset:0
    ds_read_b64_tr_b16 a[238:239], v23 offset:2560
    ds_read_b64_tr_b16 a[240:241], v23 offset:8
    ds_read_b64_tr_b16 a[242:243], v23 offset:2568
    ds_read_b64_tr_b16 a[220:221], v23 offset:16
    ds_read_b64_tr_b16 a[222:223], v23 offset:2576
    ds_read_b64_tr_b16 a[224:225], v23 offset:24
    ds_read_b64_tr_b16 a[226:227], v23 offset:2584
    ds_read_b64_tr_b16 a[228:229], v23 offset:32
    ds_read_b64_tr_b16 a[230:231], v23 offset:2592
    s_waitcnt lgkmcnt(8)
    v_mfma_f32_16x16x32_bf16 v[72:75], a[236:239], a[128:131], 0
    s_waitcnt lgkmcnt(6)
    ds_read_b64_tr_b16 a[232:233], v23 offset:5120
    ds_read_b64_tr_b16 a[234:235], v23 offset:7680
    v_mfma_f32_16x16x32_bf16 v[92:95], a[236:239], a[132:135], 0
    buffer_load_dwordx4 v5, s[12:15], s57 offen offset:3072 lds
    s_add_u32 m0, s40, 45056
    v_fma_f32 v112, v32, s54, v31
    v_fma_f32 v113, v33, s54, v31
    v_mfma_f32_16x16x32_bf16 v[76:79], a[240:243], a[128:131], 0
    s_waitcnt lgkmcnt(6)
    ds_read_b64_tr_b16 a[236:237], v23 offset:5128
    ds_read_b64_tr_b16 a[238:239], v23 offset:7688
    v_mfma_f32_16x16x32_bf16 v[96:99], a[240:243], a[132:135], 0
    v_fma_f32 v114, v34, s54, v31
    v_fma_f32 v115, v35, s54, v31
    v_fma_f32 v116, v36, s54, v31
    v_fma_f32 v117, v37, s54, v31
    v_mfma_f32_16x16x32_bf16 v[80:83], a[220:223], a[128:131], 0
    s_waitcnt lgkmcnt(6)
    ds_read_b64_tr_b16 a[240:241], v23 offset:5136
    ds_read_b64_tr_b16 a[242:243], v23 offset:7696
    v_mfma_f32_16x16x32_bf16 v[100:103], a[220:223], a[132:135], 0
    s_cmp_eq_u32 s92, 0
    s_cbranch_scc1 L_u2dB
    buffer_store_dwordx4 v[184:187], v195, s[20:23], s6 offen sc1
L_u2dB:
    v_fma_f32 v118, v38, s54, v31
    v_fma_f32 v119, v39, s54, v31
    v_fma_f32 v120, v40, s54, v31
    v_fma_f32 v121, v41, s54, v31
    v_mfma_f32_16x16x32_bf16 v[84:87], a[224:227], a[128:131], 0
    s_waitcnt lgkmcnt(6)
    ds_read_b64_tr_b16 a[220:221], v23 offset:5144
    ds_read_b64_tr_b16 a[222:223], v23 offset:7704
    v_mfma_f32_16x16x32_bf16 v[104:107], a[224:227], a[132:135], 0
    buffer_load_dwordx4 v6, s[12:15], s57 offen lds
    v_fma_f32 v122, v42, s54, v31
    v_fma_f32 v123, v43, s54, v31
    v_mfma_f32_16x16x32_bf16 v[88:91], a[228:231], a[128:131], 0
    s_waitcnt lgkmcnt(6)
    ds_read_b64_tr_b16 a[224:225], v23 offset:5152
    ds_read_b64_tr_b16 a[226:227], v23 offset:7712
    v_mfma_f32_16x16x32_bf16 v[108:111], a[228:231], a[132:135], 0
    v_fma_f32 v124, v44, s54, v31
    v_fma_f32 v125, v45, s54, v31
    v_fma_f32 v126, v46, s54, v31
    v_fma_f32 v127, v47, s54, v31
    v_mfma_f32_16x16x32_bf16 v[72:75], a[232:235], a[136:139], v[72:75]
    s_waitcnt lgkmcnt(6)
    ds_read_b64_tr_b16 a[228:229], v23 offset:10240
    ds_read_b64_tr_b16 a[230:231], v23 offset:12800
    v_mfma_f32_16x16x32_bf16 v[92:95], a[232:235], a[140:143], v[92:95]
    v_fma_f32 v128, v48, s54, v31
    v_fma_f32 v129, v49, s54, v31
    v_fma_f32 v130, v50, s54, v31
    v_fma_f32 v131, v51, s54, v31
    v_mfma_f32_16x16x32_bf16 v[76:79], a[236:239], a[136:139], v[76:79]
    s_waitcnt lgkmcnt(6)
    ds_read_b64_tr_b16 a[232:233], v23 offset:10248
    ds_read_b64_tr_b16 a[234:235], v23 offset:12808
    v_mfma_f32_16x16x32_bf16 v[96:99], a[236:239], a[140:143], v[96:99]
    s_add_u32 m0, s40, 61440
    s_add_u32 s57, s34, 2560
    buffer_load_dwordx4 v2, s[12:15], s57 offen lds
    s_cmp_eq_u32 s92, 0
    s_cbranch_scc1 L_u2B
    buffer_store_dwordx4 v[188:191], v196, s[20:23], s6 offen sc1
L_u2B:
    v_exp_f32 v112, v112 clamp
    v_mfma_f32_16x16x32_bf16 v[80:83], a[240:243], a[136:139], v[80:83]
    s_waitcnt lgkmcnt(6)
    ds_read_b64_tr_b16 a[236:237], v23 offset:10256
    ds_read_b64_tr_b16 a[238:239], v23 offset:12816
    v_mfma_f32_16x16x32_bf16 v[100:103], a[240:243], a[140:143], v[100:103]
    v_exp_f32 v113, v113 clamp
    v_exp_f32 v114, v114 clamp
    v_mfma_f32_16x16x32_bf16 v[84:87], a[220:223], a[136:139], v[84:87]
    s_waitcnt lgkmcnt(6)
    ds_read_b64_tr_b16 a[240:241], v23 offset:10264
    ds_read_b64_tr_b16 a[242:243], v23 offset:12824
    v_mfma_f32_16x16x32_bf16 v[104:107], a[220:223], a[140:143], v[104:107]
    v_exp_f32 v115, v115 clamp
    v_exp_f32 v116, v116 clamp
    v_mfma_f32_16x16x32_bf16 v[88:91], a[224:227], a[136:139], v[88:91]
    s_waitcnt lgkmcnt(6)
    ds_read_b64_tr_b16 a[220:221], v23 offset:10272
    ds_read_b64_tr_b16 a[222:223], v23 offset:12832
    v_mfma_f32_16x16x32_bf16 v[108:111], a[224:227], a[140:143], v[108:111]
    buffer_load_dwordx4 v3, s[12:15], s57 offen offset:1024 lds
    v_exp_f32 v117, v117 clamp
    v_mfma_f32_16x16x32_bf16 v[72:75], a[228:231], a[144:147], v[72:75]
    s_waitcnt lgkmcnt(6)
    ds_read_b64_tr_b16 a[224:225], v23 offset:15360
    ds_read_b64_tr_b16 a[226:227], v23 offset:17920
    v_mfma_f32_16x16x32_bf16 v[92:95], a[228:231], a[148:151], v[92:95]
    v_exp_f32 v118, v118 clamp
    v_exp_f32 v119, v119 clamp
    v_mfma_f32_16x16x32_bf16 v[76:79], a[232:235], a[144:147], v[76:79]
    s_waitcnt lgkmcnt(6)
    ds_read_b64_tr_b16 a[228:229], v23 offset:15368
    ds_read_b64_tr_b16 a[230:231], v23 offset:17928
    v_mfma_f32_16x16x32_bf16 v[96:99], a[232:235], a[148:151], v[96:99]
    v_exp_f32 v120, v120 clamp
    v_exp_f32 v121, v121 clamp
    v_mfma_f32_16x16x32_bf16 v[80:83], a[236:239], a[144:147], v[80:83]
    s_waitcnt lgkmcnt(6)
    ds_read_b64_tr_b16 a[232:233], v23 offset:15376
    ds_read_b64_tr_b16 a[234:235], v23 offset:17936
    v_mfma_f32_16x16x32_bf16 v[100:103], a[236:239], a[148:151], v[100:103]
    buffer_load_dwordx4 v4, s[12:15], s57 offen offset:2048 lds
    v_exp_f32 v122, v122 clamp
    v_mfma_f32_16x16x32_bf16 v[84:87], a[240:243], a[144:147], v[84:87]
    s_waitcnt lgkmcnt(6)
    ds_read_b64_tr_b16 a[236:237], v23 offset:15384
    ds_read_b64_tr_b16 a[238:239], v23 offset:17944
    v_mfma_f32_16x16x32_bf16 v[104:107], a[240:243], a[148:151], v[104:107]
    v_exp_f32 v123, v123 clamp
    v_exp_f32 v124, v124 clamp
    v_mfma_f32_16x16x32_bf16 v[88:91], a[220:223], a[144:147], v[88:91]
    s_waitcnt lgkmcnt(6)
    ds_read_b64_tr_b16 a[240:241], v23 offset:15392
    ds_read_b64_tr_b16 a[242:243], v23 offset:17952
    v_mfma_f32_16x16x32_bf16 v[108:111], a[220:223], a[148:151], v[108:111]
    v_exp_f32 v125, v125 clamp
    v_exp_f32 v126, v126 clamp
    v_mfma_f32_16x16x32_bf16 v[72:75], a[224:227], a[152:155], v[72:75]
    s_waitcnt lgkmcnt(6)
    s_waitcnt vmcnt(8)
    s_barrier
    ds_read_b64_tr_b16 a[220:221], v23 offset:20480
    ds_read_b64_tr_b16 a[222:223], v23 offset:23040
    v_mfma_f32_16x16x32_bf16 v[92:95], a[224:227], a[156:159], v[92:95]
    buffer_load_dwordx4 v5, s[12:15], s57 offen offset:3072 lds
    s_add_u32 m0, s40, 65536
    v_exp_f32 v127, v127 clamp
    v_mfma_f32_16x16x32_bf16 v[76:79], a[228:231], a[152:155], v[76:79]
    s_waitcnt lgkmcnt(6)
    ds_read_b64_tr_b16 a[224:225], v23 offset:20488
    ds_read_b64_tr_b16 a[226:227], v23 offset:23048
    v_mfma_f32_16x16x32_bf16 v[96:99], a[228:231], a[156:159], v[96:99]
    v_exp_f32 v128, v128 clamp
    v_exp_f32 v129, v129 clamp
    v_mfma_f32_16x16x32_bf16 v[80:83], a[232:235], a[152:155], v[80:83]
    s_waitcnt lgkmcnt(6)
    ds_read_b64_tr_b16 a[228:229], v23 offset:20496
    ds_read_b64_tr_b16 a[230:231], v23 offset:23056
    v_mfma_f32_16x16x32_bf16 v[100:103], a[232:235], a[156:159], v[100:103]
    buffer_store_dword v29, v255, s[20:23], s93 offen sc1
    v_exp_f32 v130, v130 clamp
    v_exp_f32 v131, v131 clamp
    v_mfma_f32_16x16x32_bf16 v[84:87], a[236:239], a[152:155], v[84:87]
    s_waitcnt lgkmcnt(6)
    ds_read_b64_tr_b16 a[232:233], v23 offset:20504
    ds_read_b64_tr_b16 a[234:235], v23 offset:23064
    v_mfma_f32_16x16x32_bf16 v[104:107], a[236:239], a[156:159], v[104:107]
    buffer_load_dwordx4 v6, s[12:15], s57 offen lds
    v_max_f32 v32, 0x358637bd, v32
    v_max_f32 v33, 0x358637bd, v33
    v_mfma_f32_16x16x32_bf16 v[88:91], a[240:243], a[152:155], v[88:91]
    s_waitcnt lgkmcnt(6)
    ds_read_b64_tr_b16 a[236:237], v23 offset:20512
    ds_read_b64_tr_b16 a[238:239], v23 offset:23072
    v_mfma_f32_16x16x32_bf16 v[108:111], a[240:243], a[156:159], v[108:111]
    v_max_f32 v34, 0x358637bd, v34
    v_max_f32 v35, 0x358637bd, v35
    v_max_f32 v36, 0x358637bd, v36
    v_max_f32 v37, 0x358637bd, v37
    v_mfma_f32_16x16x32_bf16 v[72:75], a[220:223], a[96:99], v[72:75]
    s_waitcnt lgkmcnt(6)
    ds_read_b64_tr_b16 a[240:241], v23 offset:25600
    ds_read_b64_tr_b16 a[242:243], v23 offset:28160
    v_mfma_f32_16x16x32_bf16 v[92:95], a[220:223], a[100:103], v[92:95]
    v_max_f32 v38, 0x358637bd, v38
    v_max_f32 v39, 0x358637bd, v39
    v_max_f32 v40, 0x358637bd, v40
    v_max_f32 v41, 0x358637bd, v41
    v_mfma_f32_16x16x32_bf16 v[76:79], a[224:227], a[96:99], v[76:79]
    s_waitcnt lgkmcnt(6)
    ds_read_b64_tr_b16 a[220:221], v23 offset:25608
    ds_read_b64_tr_b16 a[222:223], v23 offset:28168
    v_mfma_f32_16x16x32_bf16 v[96:99], a[224:227], a[100:103], v[96:99]
    s_add_u32 m0, s40, 81920
    s_add_u32 s57, s33, 2560
    buffer_load_dwordx4 v2, s[12:15], s57 offen lds
    v_max_f32 v42, 0x358637bd, v42
    v_max_f32 v43, 0x358637bd, v43
    v_mfma_f32_16x16x32_bf16 v[80:83], a[228:231], a[96:99], v[80:83]
    s_waitcnt lgkmcnt(6)
    ds_read_b64_tr_b16 a[224:225], v23 offset:25616
    ds_read_b64_tr_b16 a[226:227], v23 offset:28176
    v_mfma_f32_16x16x32_bf16 v[100:103], a[228:231], a[100:103], v[100:103]
    v_max_f32 v44, 0x358637bd, v44
    v_max_f32 v45, 0x358637bd, v45
    v_max_f32 v46, 0x358637bd, v46
    v_max_f32 v47, 0x358637bd, v47
    v_mfma_f32_16x16x32_bf16 v[84:87], a[232:235], a[96:99], v[84:87]
    s_waitcnt lgkmcnt(6)
    ds_read_b64_tr_b16 a[228:229], v23 offset:25624
    ds_read_b64_tr_b16 a[230:231], v23 offset:28184
    v_mfma_f32_16x16x32_bf16 v[104:107], a[232:235], a[100:103], v[104:107]
    v_max_f32 v48, 0x358637bd, v48
    v_max_f32 v49, 0x358637bd, v49
    v_max_f32 v50, 0x358637bd, v50
    v_max_f32 v51, 0x358637bd, v51
    v_mfma_f32_16x16x32_bf16 v[88:91], a[236:239], a[96:99], v[88:91]
    s_waitcnt lgkmcnt(6)
    ds_read_b64_tr_b16 a[232:233], v23 offset:25632
    ds_read_b64_tr_b16 a[234:235], v23 offset:28192
    v_mfma_f32_16x16x32_bf16 v[108:111], a[236:239], a[100:103], v[108:111]
    buffer_load_dwordx4 v3, s[12:15], s57 offen offset:1024 lds
    v_add_f32 v112, v112, v32
    v_add_f32 v113, v113, v33
    v_mfma_f32_16x16x32_bf16 v[72:75], a[240:243], a[104:107], v[72:75]
    s_waitcnt lgkmcnt(6)
    ds_read_b64_tr_b16 a[236:237], v23 offset:30720
    ds_read_b64_tr_b16 a[238:239], v23 offset:33280
    v_mfma_f32_16x16x32_bf16 v[92:95], a[240:243], a[108:111], v[92:95]
    v_add_f32 v114, v114, v34
    v_add_f32 v115, v115, v35
    v_add_f32 v116, v116, v36
    v_add_f32 v117, v117, v37
    v_mfma_f32_16x16x32_bf16 v[76:79], a[220:223], a[104:107], v[76:79]
    s_waitcnt lgkmcnt(6)
    ds_read_b64_tr_b16 a[240:241], v23 offset:30728
    ds_read_b64_tr_b16 a[242:243], v23 offset:33288
    v_mfma_f32_16x16x32_bf16 v[96:99], a[220:223], a[108:111], v[96:99]
    v_add_f32 v118, v118, v38
    v_add_f32 v119, v119, v39
    v_add_f32 v120, v120, v40
    v_add_f32 v121, v121, v41
    v_mfma_f32_16x16x32_bf16 v[80:83], a[224:227], a[104:107], v[80:83]
    s_waitcnt lgkmcnt(6)
    ds_read_b64_tr_b16 a[220:221], v23 offset:30736
    ds_read_b64_tr_b16 a[222:223], v23 offset:33296
    v_mfma_f32_16x16x32_bf16 v[100:103], a[224:227], a[108:111], v[100:103]
    buffer_load_dwordx4 v4, s[12:15], s57 offen offset:2048 lds
    v_add_f32 v122, v122, v42
    v_add_f32 v123, v123, v43
    v_mfma_f32_16x16x32_bf16 v[84:87], a[228:231], a[104:107], v[84:87]
    s_waitcnt lgkmcnt(6)
    ds_read_b64_tr_b16 a[224:225], v23 offset:30744
    ds_read_b64_tr_b16 a[226:227], v23 offset:33304
    v_mfma_f32_16x16x32_bf16 v[104:107], a[228:231], a[108:111], v[104:107]
    v_add_f32 v124, v124, v44
    v_add_f32 v125, v125, v45
    v_add_f32 v126, v126, v46
    v_add_f32 v127, v127, v47
    v_mfma_f32_16x16x32_bf16 v[88:91], a[232:235], a[104:107], v[88:91]
    s_waitcnt lgkmcnt(6)
    ds_read_b64_tr_b16 a[228:229], v23 offset:30752
    ds_read_b64_tr_b16 a[230:231], v23 offset:33312
    v_mfma_f32_16x16x32_bf16 v[108:111], a[232:235], a[108:111], v[108:111]
    v_add_f32 v128, v128, v48
    v_add_f32 v129, v129, v49
    v_add_f32 v130, v130, v50
    v_add_f32 v131, v131, v51
    v_mfma_f32_16x16x32_bf16 v[72:75], a[236:239], a[112:115], v[72:75]
    s_waitcnt lgkmcnt(6)
    ds_read_b64_tr_b16 a[232:233], v23 offset:35840
    ds_read_b64_tr_b16 a[234:235], v23 offset:38400
    v_mfma_f32_16x16x32_bf16 v[92:95], a[236:239], a[116:119], v[92:95]
    buffer_load_dwordx4 v5, s[12:15], s57 offen offset:3072 lds
    s_add_u32 m0, s40, 86016
    v_cvt_pk_bf16_f32 v32, v112, v113
    v_cvt_pk_bf16_f32 v33, v114, v115
    v_mfma_f32_16x16x32_bf16 v[76:79], a[240:243], a[112:115], v[76:79]
    s_waitcnt lgkmcnt(6)
    ds_read_b64_tr_b16 a[236:237], v23 offset:35848
    ds_read_b64_tr_b16 a[238:239], v23 offset:38408
    v_mfma_f32_16x16x32_bf16 v[96:99], a[240:243], a[116:119], v[96:99]
    ds_write_b64 v26, v[32:33] offset:0
    v_mfma_f32_16x16x32_bf16 v[80:83], a[220:223], a[112:115], v[80:83]
    s_waitcnt lgkmcnt(7)
    ds_read_b64_tr_b16 a[240:241], v23 offset:35856
    ds_read_b64_tr_b16 a[242:243], v23 offset:38416
    v_mfma_f32_16x16x32_bf16 v[100:103], a[220:223], a[116:119], v[100:103]
    v_cvt_pk_bf16_f32 v34, v116, v117
    v_cvt_pk_bf16_f32 v35, v118, v119
    v_mfma_f32_16x16x32_bf16 v[84:87], a[224:227], a[112:115], v[84:87]
    s_waitcnt lgkmcnt(7)
    ds_read_b64_tr_b16 a[220:221], v23 offset:35864
    ds_read_b64_tr_b16 a[222:223], v23 offset:38424
    v_mfma_f32_16x16x32_bf16 v[104:107], a[224:227], a[116:119], v[104:107]
    buffer_load_dwordx4 v6, s[12:15], s57 offen lds
    ds_write_b64 v26, v[34:35] offset:8
    v_mfma_f32_16x16x32_bf16 v[88:91], a[228:231], a[112:115], v[88:91]
    s_waitcnt lgkmcnt(8)
    ds_read_b64_tr_b16 a[224:225], v23 offset:35872
    ds_read_b64_tr_b16 a[226:227], v23 offset:38432
    v_mfma_f32_16x16x32_bf16 v[108:111], a[228:231], a[116:119], v[108:111]
    v_cvt_pk_bf16_f32 v36, v120, v121
    v_cvt_pk_bf16_f32 v37, v122, v123
    v_mfma_f32_16x16x32_bf16 v[72:75], a[232:235], a[120:123], v[72:75]
    s_waitcnt lgkmcnt(8)
    s_waitcnt vmcnt(11)
    s_barrier
    ds_read_b64_tr_b16 a[228:229], v23 offset:40960
    ds_read_b64_tr_b16 a[230:231], v23 offset:43520
    v_mfma_f32_16x16x32_bf16 v[92:95], a[232:235], a[124:127], v[92:95]
    ds_write_b64 v26, v[36:37] offset:16
    v_mfma_f32_16x16x32_bf16 v[76:79], a[236:239], a[120:123], v[76:79]
    s_waitcnt lgkmcnt(8)
    ds_read_b64_tr_b16 a[232:233], v23 offset:40968
    ds_read_b64_tr_b16 a[234:235], v23 offset:43528
    v_mfma_f32_16x16x32_bf16 v[96:99], a[236:239], a[124:127], v[96:99]
    s_add_u32 m0, s40, 0
    s_add_u32 s57, s37, 0
    buffer_load_dwordx4 v2, s[12:15], s57 offen lds
    v_cvt_pk_bf16_f32 v38, v124, v125
    v_cvt_pk_bf16_f32 v39, v126, v127
    v_mfma_f32_16x16x32_bf16 v[80:83], a[240:243], a[120:123], v[80:83]
    s_waitcnt lgkmcnt(8)
    ds_read_b64_tr_b16 a[236:237], v23 offset:40976
    ds_read_b64_tr_b16 a[238:239], v23 offset:43536
    v_mfma_f32_16x16x32_bf16 v[100:103], a[240:243], a[124:127], v[100:103]
    ds_write_b64 v26, v[38:39] offset:24
    v_mfma_f32_16x16x32_bf16 v[84:87], a[220:223], a[120:123], v[84:87]
    s_waitcnt lgkmcnt(8)
    ds_read_b64_tr_b16 a[240:241], v23 offset:40984
    ds_read_b64_tr_b16 a[242:243], v23 offset:43544
    v_mfma_f32_16x16x32_bf16 v[104:107], a[220:223], a[124:127], v[104:107]
    v_cvt_pk_bf16_f32 v40, v128, v129
    v_cvt_pk_bf16_f32 v41, v130, v131
    v_mfma_f32_16x16x32_bf16 v[88:91], a[224:227], a[120:123], v[88:91]
    s_waitcnt lgkmcnt(8)
    ds_read_b64_tr_b16 a[220:221], v23 offset:40992
    ds_read_b64_tr_b16 a[222:223], v23 offset:43552
    v_mfma_f32_16x16x32_bf16 v[108:111], a[224:227], a[124:127], v[108:111]
    buffer_load_dwordx4 v3, s[12:15], s57 offen offset:1024 lds
    ds_write_b64 v26, v[40:41] offset:32
    v_mfma_f32_16x16x32_bf16 v[72:75], a[228:231], a[64:67], v[72:75]
    s_waitcnt lgkmcnt(8)
    ds_read_b64_tr_b16 a[224:225], v23 offset:46080
    ds_read_b64_tr_b16 a[226:227], v23 offset:48640
    v_mfma_f32_16x16x32_bf16 v[92:95], a[228:231], a[68:71], v[92:95]
    s_cmp_eq_u32 s92, 0
    s_cbranch_scc1 L_u3B
    s_waitcnt vmcnt(12)
    v_mov_b32 v251, s90
    s_mov_b64 exec, 1
    buffer_store_dword v251, v25, s[20:23], s72 offen sc1
    s_mov_b64 exec, -1
L_u3B:
    v_fma_f32 v152, v52, s54, v31
    v_fma_f32 v153, v53, s54, v31
    v_fma_f32 v154, v54, s54, v31
    v_fma_f32 v155, v55, s54, v31
    v_mfma_f32_16x16x32_bf16 v[76:79], a[232:235], a[64:67], v[76:79]
    s_waitcnt lgkmcnt(8)
    ds_read_b64_tr_b16 a[228:229], v23 offset:46088
    ds_read_b64_tr_b16 a[230:231], v23 offset:48648
    v_mfma_f32_16x16x32_bf16 v[96:99], a[232:235], a[68:71], v[96:99]
    s_bfe_u32 s8, s32, 0x80000
    v_fma_f32 v156, v56, s54, v31
    v_fma_f32 v157, v57, s54, v31
    v_fma_f32 v158, v58, s54, v31
    v_fma_f32 v159, v59, s54, v31
    v_mfma_f32_16x16x32_bf16 v[80:83], a[236:239], a[64:67], v[80:83]
    s_waitcnt lgkmcnt(7)
    ds_read_b64_tr_b16 a[232:233], v23 offset:46096
    ds_read_b64_tr_b16 a[234:235], v23 offset:48656
    v_mfma_f32_16x16x32_bf16 v[100:103], a[236:239], a[68:71], v[100:103]
    buffer_load_dwordx4 v4, s[12:15], s57 offen offset:2048 lds
    s_bfe_u32 s9, s32, 0x80008
    v_fma_f32 v160, v60, s54, v31
    v_fma_f32 v161, v61, s54, v31
    v_mfma_f32_16x16x32_bf16 v[84:87], a[240:243], a[64:67], v[84:87]
    s_waitcnt lgkmcnt(7)
    ds_read_b64_tr_b16 a[236:237], v23 offset:46104
    ds_read_b64_tr_b16 a[238:239], v23 offset:48664
    v_mfma_f32_16x16x32_bf16 v[104:107], a[240:243], a[68:71], v[104:107]
    s_bfe_u32 s10, s32, 0x80010
    v_fma_f32 v162, v62, s54, v31
    v_fma_f32 v163, v63, s54, v31
    v_fma_f32 v164, v64, s54, v31
    v_fma_f32 v165, v65, s54, v31
    v_mfma_f32_16x16x32_bf16 v[88:91], a[220:223], a[64:67], v[88:91]
    s_waitcnt lgkmcnt(6)
    ds_read_b64_tr_b16 a[240:241], v23 offset:46112
    ds_read_b64_tr_b16 a[242:243], v23 offset:48672
    v_mfma_f32_16x16x32_bf16 v[108:111], a[220:223], a[68:71], v[108:111]
    s_bfe_u32 s11, s32, 0x80018
    v_fma_f32 v166, v66, s54, v31
    v_fma_f32 v167, v67, s54, v31
    v_fma_f32 v168, v68, s54, v31
    v_fma_f32 v169, v69, s54, v31
    v_mfma_f32_16x16x32_bf16 v[72:75], a[224:227], a[72:75], v[72:75]
    s_waitcnt lgkmcnt(6)
    ds_read_b64_tr_b16 a[220:221], v24 offset:0
    ds_read_b64_tr_b16 a[222:223], v24 offset:2560
    v_mfma_f32_16x16x32_bf16 v[92:95], a[224:227], a[76:79], v[92:95]
    buffer_load_dwordx4 v5, s[12:15], s57 offen offset:3072 lds
    s_add_u32 m0, s40, 4096
    s_lshr_b32 s38, s32, 16
    v_fma_f32 v170, v70, s54, v31
    v_fma_f32 v171, v71, s54, v31
    v_mfma_f32_16x16x32_bf16 v[76:79], a[228:231], a[72:75], v[76:79]
    s_waitcnt lgkmcnt(6)
    ds_read_b64_tr_b16 a[224:225], v24 offset:8
    ds_read_b64_tr_b16 a[226:227], v24 offset:2568
    v_mfma_f32_16x16x32_bf16 v[96:99], a[228:231], a[76:79], v[96:99]
    v_exp_f32 v152, v152 clamp
    v_exp_f32 v153, v153 clamp
    v_mfma_f32_16x16x32_bf16 v[80:83], a[232:235], a[72:75], v[80:83]
    s_waitcnt lgkmcnt(6)
    ds_read_b64_tr_b16 a[228:229], v24 offset:16
    ds_read_b64_tr_b16 a[230:231], v24 offset:2576
    v_mfma_f32_16x16x32_bf16 v[100:103], a[232:235], a[76:79], v[100:103]
    v_exp_f32 v154, v154 clamp
    v_exp_f32 v155, v155 clamp
    v_mfma_f32_16x16x32_bf16 v[84:87], a[236:239], a[72:75], v[84:87]
    s_waitcnt lgkmcnt(6)
    ds_read_b64_tr_b16 a[232:233], v24 offset:24
    ds_read_b64_tr_b16 a[234:235], v24 offset:2584
    v_mfma_f32_16x16x32_bf16 v[104:107], a[236:239], a[76:79], v[104:107]
    buffer_load_dwordx4 v6, s[12:15], s57 offen lds
    v_exp_f32 v156, v156 clamp
    v_mfma_f32_16x16x32_bf16 v[88:91], a[240:243], a[72:75], v[88:91]
    s_waitcnt lgkmcnt(6)
    ds_read_b64_tr_b16 a[236:237], v24 offset:32
    ds_read_b64_tr_b16 a[238:239], v24 offset:2592
    v_mfma_f32_16x16x32_bf16 v[108:111], a[240:243], a[76:79], v[108:111]
    v_exp_f32 v157, v157 clamp
    v_exp_f32 v158, v158 clamp
    v_mfma_f32_16x16x32_bf16 v[72:75], a[220:223], a[80:83], v[72:75]
    s_waitcnt lgkmcnt(6)
    ds_read_b64_tr_b16 a[240:241], v24 offset:5120
    ds_read_b64_tr_b16 a[242:243], v24 offset:7680
    v_mfma_f32_16x16x32_bf16 v[92:95], a[220:223], a[84:87], v[92:95]
    v_exp_f32 v159, v159 clamp
    v_exp_f32 v160, v160 clamp
    v_mfma_f32_16x16x32_bf16 v[76:79], a[224:227], a[80:83], v[76:79]
L_hop2B:
    s_cbranch_execz L_hopretB
    s_waitcnt lgkmcnt(6)
    ds_read_b64_tr_b16 a[220:221], v24 offset:5128
    ds_read_b64_tr_b16 a[222:223], v24 offset:7688
    v_mfma_f32_16x16x32_bf16 v[96:99], a[224:227], a[84:87], v[96:99]
    v_exp_f32 v161, v161 clamp
    v_exp_f32 v162, v162 clamp
    v_mfma_f32_16x16x32_bf16 v[80:83], a[228:231], a[80:83], v[80:83]
    s_waitcnt lgkmcnt(6)
    ds_read_b64_tr_b16 a[224:225], v24 offset:5136
    ds_read_b64_tr_b16 a[226:227], v24 offset:7696
    v_mfma_f32_16x16x32_bf16 v[100:103], a[228:231], a[84:87], v[100:103]
    v_exp_f32 v163, v163 clamp
    v_exp_f32 v164, v164 clamp
    v_mfma_f32_16x16x32_bf16 v[84:87], a[232:235], a[80:83], v[84:87]
    s_waitcnt lgkmcnt(6)
    ds_read_b64_tr_b16 a[228:229], v24 offset:5144
    ds_read_b64_tr_b16 a[230:231], v24 offset:7704
    v_mfma_f32_16x16x32_bf16 v[104:107], a[232:235], a[84:87], v[104:107]
    v_exp_f32 v165, v165 clamp
    v_exp_f32 v166, v166 clamp
    v_mfma_f32_16x16x32_bf16 v[88:91], a[236:239], a[80:83], v[88:91]
    s_waitcnt lgkmcnt(6)
    ds_read_b64_tr_b16 a[232:233], v24 offset:5152
    ds_read_b64_tr_b16 a[234:235], v24 offset:7712
    v_mfma_f32_16x16x32_bf16 v[108:111], a[236:239], a[84:87], v[108:111]
    v_exp_f32 v167, v167 clamp
    v_mfma_f32_16x16x32_bf16 v[72:75], a[240:243], a[88:91], v[72:75]
    s_waitcnt lgkmcnt(6)
    s_waitcnt vmcnt(10)
    s_barrier
    ds_read_b64_tr_b16 a[236:237], v24 offset:10240
    ds_read_b64_tr_b16 a[238:239], v24 offset:12800
    v_mfma_f32_16x16x32_bf16 v[92:95], a[240:243], a[92:95], v[92:95]
    v_exp_f32 v168, v168 clamp
    v_mfma_f32_16x16x32_bf16 v[76:79], a[220:223], a[88:91], v[76:79]
    s_waitcnt lgkmcnt(6)
    ds_read_b64_tr_b16 a[240:241], v24 offset:10248
    ds_read_b64_tr_b16 a[242:243], v24 offset:12808
    v_mfma_f32_16x16x32_bf16 v[96:99], a[220:223], a[92:95], v[96:99]
    v_exp_f32 v169, v169 clamp
    v_mfma_f32_16x16x32_bf16 v[80:83], a[224:227], a[88:91], v[80:83]
    s_waitcnt lgkmcnt(6)
    ds_read_b64_tr_b16 a[220:221], v24 offset:10256
    ds_read_b64_tr_b16 a[222:223], v24 offset:12816
    v_mfma_f32_16x16x32_bf16 v[100:103], a[224:227], a[92:95], v[100:103]
    s_add_u32 m0, s40, 20480
    s_add_u32 s57, s36, 0
    buffer_load_dwordx4 v2, s[12:15], s57 offen lds
    v_mfma_f32_16x16x32_bf16 v[84:87], a[228:231], a[88:91], v[84:87]
    s_waitcnt lgkmcnt(6)
    ds_read_b64_tr_b16 a[224:225], v24 offset:10264
    ds_read_b64_tr_b16 a[226:227], v24 offset:12824
    v_mfma_f32_16x16x32_bf16 v[104:107], a[228:231], a[92:95], v[104:107]
    v_exp_f32 v170, v170 clamp
    v_mfma_f32_16x16x32_bf16 v[88:91], a[232:235], a[88:91], v[88:91]
    s_waitcnt lgkmcnt(6)
    ds_read_b64_tr_b16 a[228:229], v24 offset:10272
    ds_read_b64_tr_b16 a[230:231], v24 offset:12832
    v_mfma_f32_16x16x32_bf16 v[108:111], a[232:235], a[92:95], v[108:111]
    v_exp_f32 v171, v171 clamp
    v_mfma_f32_16x16x32_bf16 v[72:75], a[236:239], a[32:35], v[72:75]
    s_waitcnt lgkmcnt(6)
    ds_read_b64_tr_b16 a[232:233], v24 offset:15360
    ds_read_b64_tr_b16 a[234:235], v24 offset:17920
    v_mfma_f32_16x16x32_bf16 v[92:95], a[236:239], a[36:39], v[92:95]
    buffer_load_dwordx4 v3, s[12:15], s57 offen offset:1024 lds
    v_mfma_f32_16x16x32_bf16 v[76:79], a[240:243], a[32:35], v[76:79]
    s_waitcnt lgkmcnt(6)
    ds_read_b64_tr_b16 a[236:237], v24 offset:15368
    ds_read_b64_tr_b16 a[238:239], v24 offset:17928
    v_mfma_f32_16x16x32_bf16 v[96:99], a[240:243], a[36:39], v[96:99]
    v_max_f32 v52, 0x358637bd, v52
    v_max_f32 v53, 0x358637bd, v53
    v_mfma_f32_16x16x32_bf16 v[80:83], a[220:223], a[32:35], v[80:83]
    s_waitcnt lgkmcnt(6)
    ds_read_b64_tr_b16 a[240:241], v24 offset:15376
    ds_read_b64_tr_b16 a[242:243], v24 offset:17936
    v_mfma_f32_16x16x32_bf16 v[100:103], a[220:223], a[36:39], v[100:103]
    v_max_f32 v54, 0x358637bd, v54
    v_max_f32 v55, 0x358637bd, v55
    v_mfma_f32_16x16x32_bf16 v[84:87], a[224:227], a[32:35], v[84:87]
    s_waitcnt lgkmcnt(6)
    ds_read_b64_tr_b16 a[220:221], v24 offset:15384
    ds_read_b64_tr_b16 a[222:223], v24 offset:17944
    v_mfma_f32_16x16x32_bf16 v[104:107], a[224:227], a[36:39], v[104:107]
    buffer_load_dwordx4 v4, s[12:15], s57 offen offset:2048 lds
    v_mfma_f32_16x16x32_bf16 v[88:91], a[228:231], a[32:35], v[88:91]
    s_waitcnt lgkmcnt(6)
    ds_read_b64_tr_b16 a[224:225], v24 offset:15392
    ds_read_b64_tr_b16 a[226:227], v24 offset:17952
    v_mfma_f32_16x16x32_bf16 v[108:111], a[228:231], a[36:39], v[108:111]
    v_max_f32 v56, 0x358637bd, v56
    v_max_f32 v57, 0x358637bd, v57
    v_mfma_f32_16x16x32_bf16 v[72:75], a[232:235], a[40:43], v[72:75]
    s_waitcnt lgkmcnt(6)
    ds_read_b64_tr_b16 a[228:229], v24 offset:20480
    ds_read_b64_tr_b16 a[230:231], v24 offset:23040
    v_mfma_f32_16x16x32_bf16 v[92:95], a[232:235], a[44:47], v[92:95]
    v_max_f32 v58, 0x358637bd, v58
    v_max_f32 v59, 0x358637bd, v59
    v_mfma_f32_16x16x32_bf16 v[76:79], a[236:239], a[40:43], v[76:79]
    s_waitcnt lgkmcnt(6)
    ds_read_b64_tr_b16 a[232:233], v24 offset:20488
    ds_read_b64_tr_b16 a[234:235], v24 offset:23048
    v_mfma_f32_16x16x32_bf16 v[96:99], a[236:239], a[44:47], v[96:99]
    buffer_load_dwordx4 v5, s[12:15], s57 offen offset:3072 lds
    s_add_u32 m0, s40, 24576
    v_mfma_f32_16x16x32_bf16 v[80:83], a[240:243], a[40:43], v[80:83]
    s_waitcnt lgkmcnt(6)
    ds_read_b64_tr_b16 a[236:237], v24 offset:20496
    ds_read_b64_tr_b16 a[238:239], v24 offset:23056
    v_mfma_f32_16x16x32_bf16 v[100:103], a[240:243], a[44:47], v[100:103]
    v_max_f32 v60, 0x358637bd, v60
    v_max_f32 v61, 0x358637bd, v61
    v_mfma_f32_16x16x32_bf16 v[84:87], a[220:223], a[40:43], v[84:87]
    s_waitcnt lgkmcnt(6)
    ds_read_b64_tr_b16 a[240:241], v24 offset:20504
    ds_read_b64_tr_b16 a[242:243], v24 offset:23064
    v_mfma_f32_16x16x32_bf16 v[104:107], a[220:223], a[44:47], v[104:107]
    v_max_f32 v62, 0x358637bd, v62
    v_max_f32 v63, 0x358637bd, v63
    v_mfma_f32_16x16x32_bf16 v[88:91], a[224:227], a[40:43], v[88:91]
    s_waitcnt lgkmcnt(6)
    ds_read_b64_tr_b16 a[220:221], v24 offset:20512
    ds_read_b64_tr_b16 a[222:223], v24 offset:23072
    v_mfma_f32_16x16x32_bf16 v[108:111], a[224:227], a[44:47], v[108:111]
    buffer_load_dwordx4 v6, s[12:15], s57 offen lds
    v_mfma_f32_16x16x32_bf16 v[72:75], a[228:231], a[48:51], v[72:75]
    s_waitcnt lgkmcnt(6)
    ds_read_b64_tr_b16 a[224:225], v24 offset:25600
    ds_read_b64_tr_b16 a[226:227], v24 offset:28160
    v_mfma_f32_16x16x32_bf16 v[92:95], a[228:231], a[52:55], v[92:95]
    v_max_f32 v64, 0x358637bd, v64
    v_max_f32 v65, 0x358637bd, v65
    v_mfma_f32_16x16x32_bf16 v[76:79], a[232:235], a[48:51], v[76:79]
    s_waitcnt lgkmcnt(6)
    ds_read_b64_tr_b16 a[228:229], v24 offset:25608
    ds_read_b64_tr_b16 a[230:231], v24 offset:28168
    v_mfma_f32_16x16x32_bf16 v[96:99], a[232:235], a[52:55], v[96:99]
    v_max_f32 v66, 0x358637bd, v66
    v_max_f32 v67, 0x358637bd, v67
    v_mfma_f32_16x16x32_bf16 v[80:83], a[236:239], a[48:51], v[80:83]
    s_waitcnt lgkmcnt(6)
    ds_read_b64_tr_b16 a[232:233], v24 offset:25616
    ds_read_b64_tr_b16 a[234:235], v24 offset:28176
    v_mfma_f32_16x16x32_bf16 v[100:103], a[236:239], a[52:55], v[100:103]
    v_max_f32 v68, 0x358637bd, v68
    v_max_f32 v69, 0x358637bd, v69
    v_mfma_f32_16x16x32_bf16 v[84:87], a[240:243], a[48:51], v[84:87]
    s_waitcnt lgkmcnt(6)
    ds_read_b64_tr_b16 a[236:237], v24 offset:25624
    ds_read_b64_tr_b16 a[238:239], v24 offset:28184
    v_mfma_f32_16x16x32_bf16 v[104:107], a[240:243], a[52:55], v[104:107]
    v_max_f32 v70, 0x358637bd, v70
    v_max_f32 v71, 0x358637bd, v71
    v_mfma_f32_16x16x32_bf16 v[88:91], a[220:223], a[48:51], v[88:91]
    s_waitcnt lgkmcnt(6)
    ds_read_b64_tr_b16 a[240:241], v24 offset:25632
    ds_read_b64_tr_b16 a[242:243], v24 offset:28192
    v_mfma_f32_16x16x32_bf16 v[108:111], a[220:223], a[52:55], v[108:111]
    v_add_f32 v152, v152, v52
    v_add_f32 v153, v153, v53
    v_mfma_f32_16x16x32_bf16 v[72:75], a[224:227], a[56:59], v[72:75]
    s_waitcnt lgkmcnt(6)
    s_waitcnt vmcnt(10)
    s_barrier
    ds_read_b64_tr_b16 a[220:221], v24 offset:30720
    ds_read_b64_tr_b16 a[222:223], v24 offset:33280
    v_mfma_f32_16x16x32_bf16 v[92:95], a[224:227], a[60:63], v[92:95]
    v_add_f32 v154, v154, v54
    v_add_f32 v155, v155, v55
    v_mfma_f32_16x16x32_bf16 v[76:79], a[228:231], a[56:59], v[76:79]
    s_waitcnt lgkmcnt(6)
    ds_read_b64_tr_b16 a[224:225], v24 offset:35840
    ds_read_b64_tr_b16 a[226:227], v24 offset:38400
    v_mfma_f32_16x16x32_bf16 v[96:99], a[228:231], a[60:63], v[96:99]
    v_add_f32 v156, v156, v56
    v_add_f32 v157, v157, v57
    v_mfma_f32_16x16x32_bf16 v[80:83], a[232:235], a[56:59], v[80:83]
    s_waitcnt lgkmcnt(6)
    ds_read_b64_tr_b16 a[228:229], v24 offset:40960
    ds_read_b64_tr_b16 a[230:231], v24 offset:43520
    v_mfma_f32_16x16x32_bf16 v[100:103], a[232:235], a[60:63], v[100:103]
    v_add_f32 v158, v158, v58
    v_add_f32 v159, v159, v59
    v_mfma_f32_16x16x32_bf16 v[84:87], a[236:239], a[56:59], v[84:87]
    s_waitcnt lgkmcnt(6)
    ds_read_b64_tr_b16 a[232:233], v24 offset:46080
    ds_read_b64_tr_b16 a[234:235], v24 offset:48640
    v_mfma_f32_16x16x32_bf16 v[104:107], a[236:239], a[60:63], v[104:107]
    s_add_u32 m0, s40, 40960
    s_add_u32 s57, s35, 0
    buffer_load_dwordx4 v2, s[12:15], s57 offen lds
    v_mfma_f32_16x16x32_bf16 v[88:91], a[240:243], a[56:59], v[88:91]
    s_waitcnt lgkmcnt(6)
    ds_read_b64_tr_b16 a[236:237], v24 offset:30728
    ds_read_b64_tr_b16 a[238:239], v24 offset:33288
    v_mfma_f32_16x16x32_bf16 v[108:111], a[240:243], a[60:63], v[108:111]
    v_add_f32 v160, v160, v60
    v_add_f32 v161, v161, v61
    v_mfma_f32_16x16x32_bf16 v[72:75], a[220:223], a[0:3], v[72:75]
    s_waitcnt lgkmcnt(6)
    ds_read_b64_tr_b16 a[240:241], v24 offset:35848
    ds_read_b64_tr_b16 a[242:243], v24 offset:38408
    v_mfma_f32_16x16x32_bf16 v[92:95], a[220:223], a[4:7], v[92:95]
    v_add_f32 v162, v162, v62
    v_add_f32 v163, v163, v63
    v_mfma_f32_16x16x32_bf16 v[72:75], a[224:227], a[8:11], v[72:75]
    s_waitcnt lgkmcnt(6)
    ds_read_b64_tr_b16 a[220:221], v24 offset:40968
    ds_read_b64_tr_b16 a[222:223], v24 offset:43528
    v_mfma_f32_16x16x32_bf16 v[92:95], a[224:227], a[12:15], v[92:95]
    buffer_load_dwordx4 v3, s[12:15], s57 offen offset:1024 lds
    v_mfma_f32_16x16x32_bf16 v[72:75], a[228:231], a[16:19], v[72:75]
    s_waitcnt lgkmcnt(6)
    ds_read_b64_tr_b16 a[224:225], v24 offset:46088
    ds_read_b64_tr_b16 a[226:227], v24 offset:48648
    v_mfma_f32_16x16x32_bf16 v[92:95], a[228:231], a[20:23], v[92:95]
    v_add_f32 v164, v164, v64
    v_add_f32 v165, v165, v65
    v_mfma_f32_16x16x32_bf16 v[72:75], a[232:235], a[24:27], v[72:75]
    s_waitcnt lgkmcnt(6)
    ds_read_b64_tr_b16 a[228:229], v24 offset:30736
    ds_read_b64_tr_b16 a[230:231], v24 offset:33296
    v_mfma_f32_16x16x32_bf16 v[92:95], a[232:235], a[28:31], v[92:95]
    v_add_f32 v166, v166, v66
    v_add_f32 v167, v167, v67
    v_mfma_f32_16x16x32_bf16 v[76:79], a[236:239], a[0:3], v[76:79]
    s_waitcnt lgkmcnt(6)
    ds_read_b64_tr_b16 a[232:233], v24 offset:35856
    ds_read_b64_tr_b16 a[234:235], v24 offset:38416
    v_mfma_f32_16x16x32_bf16 v[96:99], a[236:239], a[4:7], v[96:99]
    buffer_load_dwordx4 v4, s[12:15], s57 offen offset:2048 lds
    v_mfma_f32_16x16x32_bf16 v[76:79], a[240:243], a[8:11], v[76:79]
    s_waitcnt lgkmcnt(6)
    ds_read_b64_tr_b16 a[236:237], v24 offset:40976
    ds_read_b64_tr_b16 a[238:239], v24 offset:43536
    v_mfma_f32_16x16x32_bf16 v[96:99], a[240:243], a[12:15], v[96:99]
    v_add_f32 v168, v168, v68
    v_add_f32 v169, v169, v69
    v_mfma_f32_16x16x32_bf16 v[76:79], a[220:223], a[16:19], v[76:79]
    s_waitcnt lgkmcnt(6)
    ds_read_b64_tr_b16 a[240:241], v24 offset:46096
    ds_read_b64_tr_b16 a[242:243], v24 offset:48656
    v_mfma_f32_16x16x32_bf16 v[96:99], a[220:223], a[20:23], v[96:99]
    v_add_f32 v170, v170, v70
    v_add_f32 v171, v171, v71
    v_mfma_f32_16x16x32_bf16 v[76:79], a[224:227], a[24:27], v[76:79]
    s_waitcnt lgkmcnt(6)
    ds_read_b64_tr_b16 a[220:221], v24 offset:30744
    ds_read_b64_tr_b16 a[222:223], v24 offset:33304
    v_mfma_f32_16x16x32_bf16 v[96:99], a[224:227], a[28:31], v[96:99]
    buffer_load_dwordx4 v5, s[12:15], s57 offen offset:3072 lds
    s_add_u32 m0, s40, 45056
    v_mfma_f32_16x16x32_bf16 v[80:83], a[228:231], a[0:3], v[80:83]
    s_waitcnt lgkmcnt(6)
    ds_read_b64_tr_b16 a[224:225], v24 offset:35864
    ds_read_b64_tr_b16 a[226:227], v24 offset:38424
    v_mfma_f32_16x16x32_bf16 v[100:103], a[228:231], a[4:7], v[100:103]
    v_cvt_pk_bf16_f32 v52, v152, v153
    v_cvt_pk_bf16_f32 v53, v154, v155
    v_mfma_f32_16x16x32_bf16 v[80:83], a[232:235], a[8:11], v[80:83]
    s_waitcnt lgkmcnt(6)
    ds_read_b64_tr_b16 a[228:229], v24 offset:40984
    ds_read_b64_tr_b16 a[230:231], v24 offset:43544
    v_mfma_f32_16x16x32_bf16 v[100:103], a[232:235], a[12:15], v[100:103]
    ds_write_b64 v26, v[52:53] offset:1920
    v_mfma_f32_16x16x32_bf16 v[80:83], a[236:239], a[16:19], v[80:83]
    s_waitcnt lgkmcnt(7)
    ds_read_b64_tr_b16 a[232:233], v24 offset:46104
    ds_read_b64_tr_b16 a[234:235], v24 offset:48664
    v_mfma_f32_16x16x32_bf16 v[100:103], a[236:239], a[20:23], v[100:103]
    buffer_load_dwordx4 v6, s[12:15], s57 offen lds
    buffer_load_dword v204, v250, s[20:23], s93 offen sc1
    v_mfma_f32_16x16x32_bf16 v[80:83], a[240:243], a[24:27], v[80:83]
    s_waitcnt lgkmcnt(7)
    ds_read_b64_tr_b16 a[236:237], v24 offset:30752
    ds_read_b64_tr_b16 a[238:239], v24 offset:33312
    v_mfma_f32_16x16x32_bf16 v[100:103], a[240:243], a[28:31], v[100:103]
    v_cvt_pk_bf16_f32 v54, v156, v157
    v_cvt_pk_bf16_f32 v55, v158, v159
    v_mfma_f32_16x16x32_bf16 v[84:87], a[220:223], a[0:3], v[84:87]
    s_waitcnt lgkmcnt(7)
    ds_read_b64_tr_b16 a[240:241], v24 offset:35872
    ds_read_b64_tr_b16 a[242:243], v24 offset:38432
    v_mfma_f32_16x16x32_bf16 v[104:107], a[220:223], a[4:7], v[104:107]
    ds_write_b64 v26, v[54:55] offset:1928
    v_mfma_f32_16x16x32_bf16 v[84:87], a[224:227], a[8:11], v[84:87]
    s_waitcnt lgkmcnt(8)
    ds_read_b64_tr_b16 a[220:221], v24 offset:40992
    ds_read_b64_tr_b16 a[222:223], v24 offset:43552
    v_mfma_f32_16x16x32_bf16 v[104:107], a[224:227], a[12:15], v[104:107]
    v_cvt_pk_bf16_f32 v56, v160, v161
    v_cvt_pk_bf16_f32 v57, v162, v163
    v_mfma_f32_16x16x32_bf16 v[84:87], a[228:231], a[16:19], v[84:87]
    s_waitcnt lgkmcnt(7)
    ds_read_b64_tr_b16 a[224:225], v24 offset:46112
    ds_read_b64_tr_b16 a[226:227], v24 offset:48672
    v_mfma_f32_16x16x32_bf16 v[104:107], a[228:231], a[20:23], v[104:107]
    ds_write_b64 v26, v[56:57] offset:1936
    v_mfma_f32_16x16x32_bf16 v[84:87], a[232:235], a[24:27], v[84:87]
    s_waitcnt lgkmcnt(8)
    v_cvt_pk_bf16_f32 v58, v164, v165
    v_cvt_pk_bf16_f32 v59, v166, v167
    v_mfma_f32_16x16x32_bf16 v[104:107], a[232:235], a[28:31], v[104:107]
    ds_write_b64 v26, v[58:59] offset:1944
    v_mfma_f32_16x16x32_bf16 v[88:91], a[236:239], a[0:3], v[88:91]
    s_waitcnt lgkmcnt(7)
    v_cvt_pk_bf16_f32 v60, v168, v169
    v_cvt_pk_bf16_f32 v61, v170, v171
    v_mfma_f32_16x16x32_bf16 v[108:111], a[236:239], a[4:7], v[108:111]
    ds_write_b64 v26, v[60:61] offset:1952
    v_mfma_f32_16x16x32_bf16 v[88:91], a[240:243], a[8:11], v[88:91]
    s_waitcnt lgkmcnt(5)
    v_cvt_pk_bf16_f32 v112, v72, v73
    v_cvt_pk_bf16_f32 v113, v74, v75
    v_mfma_f32_16x16x32_bf16 v[108:111], a[240:243], a[12:15], v[108:111]
    ds_write_b64 v26, v[112:113] offset:80
    v_mfma_f32_16x16x32_bf16 v[88:91], a[220:223], a[16:19], v[88:91]
    s_waitcnt lgkmcnt(4)
    v_cvt_pk_bf16_f32 v122, v92, v93
    v_cvt_pk_bf16_f32 v123, v94, v95
    v_mfma_f32_16x16x32_bf16 v[108:111], a[220:223], a[20:23], v[108:111]
    ds_write_b64 v26, v[122:123] offset:2000
    v_mfma_f32_16x16x32_bf16 v[88:91], a[224:227], a[24:27], v[88:91]
    v_cvt_pk_bf16_f32 v114, v76, v77
    v_cvt_pk_bf16_f32 v115, v78, v79
    v_mfma_f32_16x16x32_bf16 v[108:111], a[224:227], a[28:31], v[108:111]
    ds_write_b64 v26, v[114:115] offset:88
    v_cvt_pk_bf16_f32 v124, v96, v97
    v_cvt_pk_bf16_f32 v125, v98, v99
    ds_write_b64 v26, v[124:125] offset:2008
    v_cvt_pk_bf16_f32 v116, v80, v81
    v_cvt_pk_bf16_f32 v117, v82, v83
    ds_write_b64 v26, v[116:117] offset:96
    v_cvt_pk_bf16_f32 v126, v100, v101
    v_cvt_pk_bf16_f32 v127, v102, v103
    ds_write_b64 v26, v[126:127] offset:2016
    v_cvt_pk_bf16_f32 v118, v84, v85
    v_cvt_pk_bf16_f32 v119, v86, v87
    ds_write_b64 v26, v[118:119] offset:104
    v_cvt_pk_bf16_f32 v128, v104, v105
    v_cvt_pk_bf16_f32 v129, v106, v107
    ds_write_b64 v26, v[128:129] offset:2024
    v_cvt_pk_bf16_f32 v120, v88, v89
    v_cvt_pk_bf16_f32 v121, v90, v91
    ds_write_b64 v26, v[120:121] offset:112
    v_cvt_pk_bf16_f32 v130, v108, v109
    v_cvt_pk_bf16_f32 v131, v110, v111
    ds_write_b64 v26, v[130:131] offset:2032
    s_waitcnt vmcnt(6) lgkmcnt(0)
    s_barrier
    ds_read_b64_tr_b16 v[32:33], v28 offset:80
    ds_read_b64_tr_b16 v[34:35], v28 offset:200
    ds_read_b64_tr_b16 v[40:41], v28 offset:0
    ds_read_b64_tr_b16 v[42:43], v28 offset:120
    ds_read_b64_tr_b16 v[44:45], v28 offset:32
    ds_read_b64_tr_b16 v[46:47], v28 offset:152
    ds_read_b64_tr_b16 v[36:37], v30 offset:112
    ds_read_b64_tr_b16 v[38:39], v30 offset:232
    ds_read_b64_tr_b16 v[52:53], v28 offset:15440
    ds_read_b64_tr_b16 v[54:55], v28 offset:15560
    ds_read_b64_tr_b16 v[60:61], v28 offset:15360
    ds_read_b64_tr_b16 v[62:63], v28 offset:15480
    ds_read_b64_tr_b16 v[64:65], v28 offset:15392
    ds_read_b64_tr_b16 v[66:67], v28 offset:15512
    ds_read_b64_tr_b16 v[56:57], v30 offset:15472
    s_add_u32 m0, s40, 61440
    s_add_u32 s57, s34, 0
    buffer_load_dwordx4 v2, s[12:15], s57 offen lds
    v_mov_b32 v113, 0xff
    s_waitcnt lgkmcnt(11)
    v_mfma_f32_16x16x32_bf16 v[176:179], v[32:35], v[40:43], 0
    s_waitcnt lgkmcnt(9)
    ds_read_b64_tr_b16 v[58:59], v30 offset:15592
    ds_read_b64_tr_b16 v[72:73], v28 offset:30800
    ds_read_b64_tr_b16 v[74:75], v28 offset:30920
    ds_read_b64_tr_b16 v[80:81], v28 offset:30720
    v_mfma_f32_16x16x32_bf16 v[180:183], v[32:35], v[44:47], 0
    s_waitcnt lgkmcnt(7)
    ds_read_b64_tr_b16 v[82:83], v28 offset:30840
    ds_read_b64_tr_b16 v[84:85], v28 offset:30752
    ds_read_b64_tr_b16 v[86:87], v28 offset:30872
    ds_read_b64_tr_b16 v[76:77], v30 offset:30832
    v_mfma_f32_16x16x32_bf16 v[176:179], v[52:55], v[60:63], v[176:179]
    s_waitcnt lgkmcnt(9)
    ds_read_b64_tr_b16 v[78:79], v30 offset:30952
    ds_read_b64_tr_b16 v[92:93], v28 offset:46160
    ds_read_b64_tr_b16 v[94:95], v28 offset:46280
    ds_read_b64_tr_b16 v[100:101], v28 offset:46080
    v_mfma_f32_16x16x32_bf16 v[180:183], v[52:55], v[64:67], v[180:183]
    s_waitcnt lgkmcnt(7)
    ds_read_b64_tr_b16 v[102:103], v28 offset:46200
    ds_read_b64_tr_b16 v[104:105], v28 offset:46112
    ds_read_b64_tr_b16 v[106:107], v28 offset:46232
    ds_read_b64_tr_b16 v[96:97], v30 offset:46192
    v_mfma_f32_16x16x32_bf16 v[176:179], v[72:75], v[80:83], v[176:179]
    s_waitcnt lgkmcnt(9)
    ds_read_b64_tr_b16 v[98:99], v30 offset:46312
    v_and_or_b32 v36, v36, v237, v238
    v_and_or_b32 v37, v37, v237, v238
    v_mfma_f32_16x16x32_bf16 v[180:183], v[72:75], v[84:87], v[180:183]
    s_waitcnt lgkmcnt(4)
    v_and_or_b32 v38, v38, v237, v238
    v_and_or_b32 v39, v39, v237, v238
    v_and_or_b32 v56, v56, v237, v238
    v_mfma_f32_16x16x32_bf16 v[176:179], v[92:95], v[100:103], v[176:179]
    s_waitcnt lgkmcnt(2)
    v_and_or_b32 v57, v57, v237, v238
    v_and_or_b32 v58, v58, v237, v238
    v_and_or_b32 v59, v59, v237, v238
    v_mfma_f32_16x16x32_bf16 v[180:183], v[92:95], v[104:107], v[180:183]
    s_waitcnt lgkmcnt(0)
    v_and_or_b32 v76, v76, v237, v238
    v_and_or_b32 v77, v77, v237, v238
    v_and_or_b32 v78, v78, v237, v238
    v_and_or_b32 v79, v79, v237, v238
    v_mfma_f32_16x16x32_bf16 v[188:191], v[36:39], v[40:43], 0
    v_and_or_b32 v96, v96, v237, v238
    v_and_or_b32 v97, v97, v237, v238
    v_mfma_f32_16x16x32_bf16 v[188:191], v[56:59], v[60:63], v[188:191]
    v_and_or_b32 v98, v98, v237, v238
    v_and_or_b32 v99, v99, v237, v238
    v_mfma_f32_16x16x32_bf16 v[188:191], v[76:79], v[80:83], v[188:191]
    v_bfi_b32 v176, v113, s8, v176
    v_bfi_b32 v177, v113, s9, v177
    v_mfma_f32_16x16x32_bf16 v[188:191], v[96:99], v[100:103], v[188:191]
    v_bfi_b32 v178, v113, s10, v178
    v_bfi_b32 v179, v113, s11, v179
    v_mfma_f32_16x16x32_bf16 v[192:195], v[36:39], v[44:47], 0
    buffer_store_dwordx4 v[176:179], v228, s[20:23], s68 offen offset:0 sc1
    v_mfma_f32_16x16x32_bf16 v[192:195], v[56:59], v[64:67], v[192:195]
    v_bfi_b32 v180, v113, s8, v180
    v_bfi_b32 v181, v113, s9, v181
    v_mfma_f32_16x16x32_bf16 v[192:195], v[76:79], v[84:87], v[192:195]
    v_bfi_b32 v182, v113, s10, v182
    v_bfi_b32 v183, v113, s11, v183
    v_mfma_f32_16x16x32_bf16 v[192:195], v[96:99], v[104:107], v[192:195]
    buffer_store_dwordx4 v[180:183], v14, s[20:23], s68 offen offset:1536 sc1
    ds_read_b64_tr_b16 a[228:229], v23 offset:0
    ds_read_b64_tr_b16 a[230:231], v23 offset:2560
    ds_read_b64_tr_b16 a[232:233], v23 offset:8
    ds_read_b64_tr_b16 a[234:235], v23 offset:2568
    ds_read_b64_tr_b16 a[236:237], v23 offset:16
    ds_read_b64_tr_b16 a[238:239], v23 offset:2576
    ds_read_b64_tr_b16 a[240:241], v23 offset:24
    ds_read_b64_tr_b16 a[242:243], v23 offset:2584
    ds_read_b64_tr_b16 a[220:221], v23 offset:32
    ds_read_b64_tr_b16 a[222:223], v23 offset:2592
    s_waitcnt lgkmcnt(8)
    v_mfma_f32_16x16x32_bf16 v[32:35], a[228:231], a[128:131], v[212:215]
    s_waitcnt lgkmcnt(6)
    ds_read_b64_tr_b16 a[224:225], v23 offset:5120
    ds_read_b64_tr_b16 a[226:227], v23 offset:7680
    v_mfma_f32_16x16x32_bf16 v[52:55], a[228:231], a[132:135], v[212:215]
    v_bfi_b32 v188, v113, s8, v188
    v_bfi_b32 v189, v113, s9, v189
    v_mfma_f32_16x16x32_bf16 v[36:39], a[232:235], a[128:131], v[212:215]
    s_waitcnt lgkmcnt(6)
    ds_read_b64_tr_b16 a[228:229], v23 offset:5128
    ds_read_b64_tr_b16 a[230:231], v23 offset:7688
    v_mfma_f32_16x16x32_bf16 v[56:59], a[232:235], a[132:135], v[212:215]
    buffer_load_dwordx2 v[206:207], v13, s[20:23], s91 offen sc1
    v_bfi_b32 v190, v113, s10, v190
    v_bfi_b32 v191, v113, s11, v191
    v_mfma_f32_16x16x32_bf16 v[40:43], a[236:239], a[128:131], v[212:215]
    s_waitcnt lgkmcnt(6)
    ds_read_b64_tr_b16 a[232:233], v23 offset:5136
    ds_read_b64_tr_b16 a[234:235], v23 offset:7696
    v_mfma_f32_16x16x32_bf16 v[60:63], a[236:239], a[132:135], v[212:215]
    buffer_store_dwordx4 v[188:191], v15, s[20:23], s68 offen offset:1024 sc1
    v_mfma_f32_16x16x32_bf16 v[44:47], a[240:243], a[128:131], v[212:215]
    s_waitcnt lgkmcnt(6)
    ds_read_b64_tr_b16 a[236:237], v23 offset:5144
    ds_read_b64_tr_b16 a[238:239], v23 offset:7704
    v_mfma_f32_16x16x32_bf16 v[64:67], a[240:243], a[132:135], v[212:215]
    v_bfi_b32 v192, v113, s8, v192
    v_bfi_b32 v193, v113, s9, v193
    v_mfma_f32_16x16x32_bf16 v[48:51], a[220:223], a[128:131], v[212:215]
    s_waitcnt lgkmcnt(6)
    ds_read_b64_tr_b16 a[240:241], v23 offset:5152
    ds_read_b64_tr_b16 a[242:243], v23 offset:7712
    v_mfma_f32_16x16x32_bf16 v[68:71], a[220:223], a[132:135], v[212:215]
    v_bfi_b32 v194, v113, s10, v194
    v_bfi_b32 v195, v113, s11, v195
    v_mfma_f32_16x16x32_bf16 v[32:35], a[224:227], a[136:139], v[32:35]
    s_waitcnt lgkmcnt(6)
    ds_read_b64_tr_b16 a[220:221], v23 offset:10240
    ds_read_b64_tr_b16 a[222:223], v23 offset:12800
    v_mfma_f32_16x16x32_bf16 v[52:55], a[224:227], a[140:143], v[52:55]
    buffer_store_dwordx4 v[192:195], v16, s[20:23], s68 offen offset:1792 sc1
    v_mfma_f32_16x16x32_bf16 v[36:39], a[228:231], a[136:139], v[36:39]
    s_waitcnt lgkmcnt(6)
    ds_read_b64_tr_b16 a[224:225], v23 offset:10248
    ds_read_b64_tr_b16 a[226:227], v23 offset:12808
    v_mfma_f32_16x16x32_bf16 v[56:59], a[228:231], a[140:143], v[56:59]
    v_mfma_f32_16x16x32_bf16 v[40:43], a[232:235], a[136:139], v[40:43]
    s_waitcnt lgkmcnt(6)
    ds_read_b64_tr_b16 a[228:229], v23 offset:10256
    ds_read_b64_tr_b16 a[230:231], v23 offset:12816
    v_mfma_f32_16x16x32_bf16 v[60:63], a[232:235], a[140:143], v[60:63]
    v_mfma_f32_16x16x32_bf16 v[44:47], a[236:239], a[136:139], v[44:47]
    s_waitcnt lgkmcnt(6)
    ds_read_b64_tr_b16 a[232:233], v23 offset:10264
    ds_read_b64_tr_b16 a[234:235], v23 offset:12824
    v_mfma_f32_16x16x32_bf16 v[64:67], a[236:239], a[140:143], v[64:67]
    v_mfma_f32_16x16x32_bf16 v[48:51], a[240:243], a[136:139], v[48:51]
    s_waitcnt lgkmcnt(6)
    ds_read_b64_tr_b16 a[236:237], v23 offset:10272
    ds_read_b64_tr_b16 a[238:239], v23 offset:12832
    v_mfma_f32_16x16x32_bf16 v[68:71], a[240:243], a[140:143], v[68:71]
    buffer_load_dwordx4 v3, s[12:15], s57 offen offset:1024 lds
    v_mfma_f32_16x16x32_bf16 v[32:35], a[220:223], a[144:147], v[32:35]
    s_waitcnt lgkmcnt(6)
    ds_read_b64_tr_b16 a[240:241], v23 offset:15360
    ds_read_b64_tr_b16 a[242:243], v23 offset:17920
    v_mfma_f32_16x16x32_bf16 v[52:55], a[220:223], a[148:151], v[52:55]
    v_mfma_f32_16x16x32_bf16 v[36:39], a[224:227], a[144:147], v[36:39]
    s_waitcnt lgkmcnt(6)
    ds_read_b64_tr_b16 a[220:221], v23 offset:15368
    ds_read_b64_tr_b16 a[222:223], v23 offset:17928
    v_mfma_f32_16x16x32_bf16 v[56:59], a[224:227], a[148:151], v[56:59]
    v_mfma_f32_16x16x32_bf16 v[40:43], a[228:231], a[144:147], v[40:43]
    s_waitcnt lgkmcnt(6)
    ds_read_b64_tr_b16 a[224:225], v23 offset:15376
    ds_read_b64_tr_b16 a[226:227], v23 offset:17936
    v_mfma_f32_16x16x32_bf16 v[60:63], a[228:231], a[148:151], v[60:63]
    buffer_load_dwordx4 v4, s[12:15], s57 offen offset:2048 lds
    v_mfma_f32_16x16x32_bf16 v[44:47], a[232:235], a[144:147], v[44:47]
    s_waitcnt lgkmcnt(6)
    ds_read_b64_tr_b16 a[228:229], v23 offset:15384
    ds_read_b64_tr_b16 a[230:231], v23 offset:17944
    v_mfma_f32_16x16x32_bf16 v[64:67], a[232:235], a[148:151], v[64:67]
    v_mfma_f32_16x16x32_bf16 v[48:51], a[236:239], a[144:147], v[48:51]
    s_waitcnt lgkmcnt(6)
    ds_read_b64_tr_b16 a[232:233], v23 offset:15392
    ds_read_b64_tr_b16 a[234:235], v23 offset:17952
    v_mfma_f32_16x16x32_bf16 v[68:71], a[236:239], a[148:151], v[68:71]
    v_mfma_f32_16x16x32_bf16 v[32:35], a[240:243], a[152:155], v[32:35]
    s_waitcnt lgkmcnt(6)
    ds_read_b64_tr_b16 a[236:237], v23 offset:20480
    ds_read_b64_tr_b16 a[238:239], v23 offset:23040
    v_mfma_f32_16x16x32_bf16 v[52:55], a[240:243], a[156:159], v[52:55]
    buffer_load_dwordx4 v5, s[12:15], s57 offen offset:3072 lds
    s_add_u32 m0, s40, 65536
    v_mfma_f32_16x16x32_bf16 v[36:39], a[220:223], a[152:155], v[36:39]
    s_waitcnt lgkmcnt(6)
    ds_read_b64_tr_b16 a[240:241], v23 offset:20488
    ds_read_b64_tr_b16 a[242:243], v23 offset:23048
    v_mfma_f32_16x16x32_bf16 v[56:59], a[220:223], a[156:159], v[56:59]
    v_mfma_f32_16x16x32_bf16 v[40:43], a[224:227], a[152:155], v[40:43]
    s_waitcnt lgkmcnt(6)
    ds_read_b64_tr_b16 a[220:221], v23 offset:20496
    ds_read_b64_tr_b16 a[222:223], v23 offset:23056
    v_mfma_f32_16x16x32_bf16 v[60:63], a[224:227], a[156:159], v[60:63]
    v_mfma_f32_16x16x32_bf16 v[44:47], a[228:231], a[152:155], v[44:47]
    s_waitcnt lgkmcnt(6)
    ds_read_b64_tr_b16 a[224:225], v23 offset:20504
    ds_read_b64_tr_b16 a[226:227], v23 offset:23064
    v_mfma_f32_16x16x32_bf16 v[64:67], a[228:231], a[156:159], v[64:67]
    buffer_load_dwordx4 v6, s[12:15], s57 offen lds
    v_mfma_f32_16x16x32_bf16 v[48:51], a[232:235], a[152:155], v[48:51]
    s_waitcnt lgkmcnt(6)
    ds_read_b64_tr_b16 a[228:229], v23 offset:20512
    ds_read_b64_tr_b16 a[230:231], v23 offset:23072
    v_mfma_f32_16x16x32_bf16 v[68:71], a[232:235], a[156:159], v[68:71]
L_hop3B:
    s_cbranch_execz L_hopretB
    v_mfma_f32_16x16x32_bf16 v[32:35], a[236:239], a[96:99], v[32:35]
    s_waitcnt lgkmcnt(6)
    ds_read_b64_tr_b16 a[232:233], v23 offset:25600
    ds_read_b64_tr_b16 a[234:235], v23 offset:28160
    v_mfma_f32_16x16x32_bf16 v[52:55], a[236:239], a[100:103], v[52:55]
    s_waitcnt vmcnt(11)
    s_barrier
    v_mfma_f32_16x16x32_bf16 v[36:39], a[240:243], a[96:99], v[36:39]
    s_waitcnt lgkmcnt(6)
    ds_read_b64_tr_b16 a[236:237], v23 offset:25608
    ds_read_b64_tr_b16 a[238:239], v23 offset:28168
    v_mfma_f32_16x16x32_bf16 v[56:59], a[240:243], a[100:103], v[56:59]
    s_add_u32 m0, s40, 81920
    s_add_u32 s57, s33, 0
    buffer_load_dwordx4 v2, s[12:15], s57 offen lds
    v_mfma_f32_16x16x32_bf16 v[40:43], a[220:223], a[96:99], v[40:43]
    s_waitcnt lgkmcnt(6)
    ds_read_b64_tr_b16 a[240:241], v23 offset:25616
    ds_read_b64_tr_b16 a[242:243], v23 offset:28176
    v_mfma_f32_16x16x32_bf16 v[60:63], a[220:223], a[100:103], v[60:63]
    s_waitcnt vmcnt(11)
    v_xor_b32 v205, s32, v204
    v_lshlrev_b32 v205, 4, v205
    v_mfma_f32_16x16x32_bf16 v[44:47], a[224:227], a[96:99], v[44:47]
    s_waitcnt lgkmcnt(6)
    ds_read_b64_tr_b16 a[220:221], v23 offset:25624
    ds_read_b64_tr_b16 a[222:223], v23 offset:28184
    v_mfma_f32_16x16x32_bf16 v[64:67], a[224:227], a[100:103], v[64:67]
    v_cmp_ne_u32 vcc, 0, v205
    v_mfma_f32_16x16x32_bf16 v[48:51], a[228:231], a[96:99], v[48:51]
    s_waitcnt lgkmcnt(6)
    ds_read_b64_tr_b16 a[224:225], v23 offset:25632
    ds_read_b64_tr_b16 a[226:227], v23 offset:28192
    v_mfma_f32_16x16x32_bf16 v[68:71], a[228:231], a[100:103], v[68:71]
    buffer_load_dwordx4 v3, s[12:15], s57 offen offset:1024 lds
    s_cbranch_vccnz L_xcB_retry
L_xcB_ok:
    v_cmp_ne_u32 vcc, s74, v204
    v_mfma_f32_16x16x32_bf16 v[32:35], a[232:235], a[104:107], v[32:35]
    s_waitcnt lgkmcnt(6)
    ds_read_b64_tr_b16 a[228:229], v23 offset:30720
    ds_read_b64_tr_b16 a[230:231], v23 offset:33280
    v_mfma_f32_16x16x32_bf16 v[52:55], a[232:235], a[108:111], v[52:55]
    s_mov_b32 s53, vcc_lo
    s_add_u32 s42, s20, 8388608
    s_addc_u32 s43, s21, 0
    v_mfma_f32_16x16x32_bf16 v[36:39], a[236:239], a[104:107], v[36:39]
    s_waitcnt lgkmcnt(6)
    ds_read_b64_tr_b16 a[232:233], v23 offset:30728
    ds_read_b64_tr_b16 a[234:235], v23 offset:33288
    v_mfma_f32_16x16x32_bf16 v[56:59], a[236:239], a[108:111], v[56:59]
    s_cmp_eq_u32 s53, 0
    s_cselect_b32 s28, s24, s42
    s_cselect_b32 s29, s25, s43
    v_mfma_f32_16x16x32_bf16 v[40:43], a[240:243], a[104:107], v[40:43]
    s_waitcnt lgkmcnt(6)
    ds_read_b64_tr_b16 a[236:237], v23 offset:30736
    ds_read_b64_tr_b16 a[238:239], v23 offset:33296
    v_mfma_f32_16x16x32_bf16 v[60:63], a[240:243], a[108:111], v[60:63]
    buffer_load_dwordx4 v4, s[12:15], s57 offen offset:2048 lds
    s_mov_b32 s30, 5242880
    s_mov_b32 s31, 0x20000
    v_mfma_f32_16x16x32_bf16 v[44:47], a[220:223], a[104:107], v[44:47]
    s_waitcnt lgkmcnt(6)
    ds_read_b64_tr_b16 a[240:241], v23 offset:30744
    ds_read_b64_tr_b16 a[242:243], v23 offset:33304
    v_mfma_f32_16x16x32_bf16 v[64:67], a[220:223], a[108:111], v[64:67]
    s_waitcnt vmcnt(9)
    v_xor_b32 v206, s32, v206
    v_bitop3_b32 v206, v206, v207, s32 bitop3:0xf6
    v_mfma_f32_16x16x32_bf16 v[48:51], a[224:227], a[104:107], v[48:51]
    s_waitcnt lgkmcnt(6)
    ds_read_b64_tr_b16 a[220:221], v23 offset:30752
    ds_read_b64_tr_b16 a[222:223], v23 offset:33312
    v_mfma_f32_16x16x32_bf16 v[68:71], a[224:227], a[108:111], v[68:71]
    v_cmp_ne_u32 vcc, 0, v206
    v_mfma_f32_16x16x32_bf16 v[32:35], a[228:231], a[112:115], v[32:35]
    s_waitcnt lgkmcnt(6)
    ds_read_b64_tr_b16 a[224:225], v23 offset:35840
    ds_read_b64_tr_b16 a[226:227], v23 offset:38400
    v_mfma_f32_16x16x32_bf16 v[52:55], a[228:231], a[116:119], v[52:55]
    buffer_load_dwordx4 v5, s[12:15], s57 offen offset:3072 lds
    s_add_u32 m0, s40, 86016
    v_mfma_f32_16x16x32_bf16 v[36:39], a[232:235], a[112:115], v[36:39]
    s_waitcnt lgkmcnt(6)
    ds_read_b64_tr_b16 a[228:229], v23 offset:35848
    ds_read_b64_tr_b16 a[230:231], v23 offset:38408
    v_mfma_f32_16x16x32_bf16 v[56:59], a[232:235], a[116:119], v[56:59]
    s_cbranch_vccnz L_pfB_retry
L_pfB_ok:
    v_mfma_f32_16x16x32_bf16 v[40:43], a[236:239], a[112:115], v[40:43]
    s_waitcnt lgkmcnt(6)
    ds_read_b64_tr_b16 a[232:233], v23 offset:35856
    ds_read_b64_tr_b16 a[234:235], v23 offset:38416
    v_mfma_f32_16x16x32_bf16 v[60:63], a[236:239], a[116:119], v[60:63]
    v_mfma_f32_16x16x32_bf16 v[44:47], a[240:243], a[112:115], v[44:47]
    s_waitcnt lgkmcnt(6)
    ds_read_b64_tr_b16 a[236:237], v23 offset:35864
    ds_read_b64_tr_b16 a[238:239], v23 offset:38424
    v_mfma_f32_16x16x32_bf16 v[64:67], a[240:243], a[116:119], v[64:67]
    buffer_load_dwordx4 v6, s[12:15], s57 offen lds
    v_mfma_f32_16x16x32_bf16 v[48:51], a[220:223], a[112:115], v[48:51]
    s_waitcnt lgkmcnt(6)
    ds_read_b64_tr_b16 a[240:241], v23 offset:35872
    ds_read_b64_tr_b16 a[242:243], v23 offset:38432
    v_mfma_f32_16x16x32_bf16 v[68:71], a[220:223], a[116:119], v[68:71]
    v_mfma_f32_16x16x32_bf16 v[32:35], a[224:227], a[120:123], v[32:35]
    s_waitcnt lgkmcnt(6)
    ds_read_b64_tr_b16 a[220:221], v23 offset:40960
    ds_read_b64_tr_b16 a[222:223], v23 offset:43520
    v_mfma_f32_16x16x32_bf16 v[52:55], a[224:227], a[124:127], v[52:55]
    v_mfma_f32_16x16x32_bf16 v[36:39], a[228:231], a[120:123], v[36:39]
    s_waitcnt lgkmcnt(6)
    ds_read_b64_tr_b16 a[224:225], v23 offset:40968
    ds_read_b64_tr_b16 a[226:227], v23 offset:43528
    v_mfma_f32_16x16x32_bf16 v[56:59], a[228:231], a[124:127], v[56:59]
    s_add_u32 m0, s40, 0
    s_nop 0
    buffer_load_dwordx4 v25, s[20:23], s46 offen sc1 lds
    v_mfma_f32_16x16x32_bf16 v[40:43], a[232:235], a[120:123], v[40:43]
    s_waitcnt lgkmcnt(6)
    ds_read_b64_tr_b16 a[228:229], v23 offset:40976
    ds_read_b64_tr_b16 a[230:231], v23 offset:43536
    v_mfma_f32_16x16x32_bf16 v[60:63], a[232:235], a[124:127], v[60:63]
    v_mfma_f32_16x16x32_bf16 v[44:47], a[236:239], a[120:123], v[44:47]
    s_waitcnt lgkmcnt(6)
    ds_read_b64_tr_b16 a[232:233], v23 offset:40984
    ds_read_b64_tr_b16 a[234:235], v23 offset:43544
    v_mfma_f32_16x16x32_bf16 v[64:67], a[236:239], a[124:127], v[64:67]
    v_mfma_f32_16x16x32_bf16 v[48:51], a[240:243], a[120:123], v[48:51]
    s_waitcnt lgkmcnt(6)
    ds_read_b64_tr_b16 a[236:237], v23 offset:40992
    ds_read_b64_tr_b16 a[238:239], v23 offset:43552
    v_mfma_f32_16x16x32_bf16 v[68:71], a[240:243], a[124:127], v[68:71]
    buffer_load_dwordx4 v25, s[20:23], s46 offen offset:1024 sc1 lds
    v_mfma_f32_16x16x32_bf16 v[32:35], a[220:223], a[64:67], v[32:35]
    s_waitcnt lgkmcnt(6)
    ds_read_b64_tr_b16 a[240:241], v23 offset:46080
    ds_read_b64_tr_b16 a[242:243], v23 offset:48640
    v_mfma_f32_16x16x32_bf16 v[52:55], a[220:223], a[68:71], v[52:55]
    v_mfma_f32_16x16x32_bf16 v[36:39], a[224:227], a[64:67], v[36:39]
    s_waitcnt lgkmcnt(6)
    ds_read_b64_tr_b16 a[220:221], v23 offset:46088
    ds_read_b64_tr_b16 a[222:223], v23 offset:48648
    v_mfma_f32_16x16x32_bf16 v[56:59], a[224:227], a[68:71], v[56:59]
    v_mfma_f32_16x16x32_bf16 v[40:43], a[228:231], a[64:67], v[40:43]
    s_waitcnt lgkmcnt(6)
    ds_read_b64_tr_b16 a[224:225], v23 offset:46096
    ds_read_b64_tr_b16 a[226:227], v23 offset:48656
    v_mfma_f32_16x16x32_bf16 v[60:63], a[228:231], a[68:71], v[60:63]
    buffer_load_dwordx4 v25, s[20:23], s46 offen offset:2048 sc1 lds
    v_mfma_f32_16x16x32_bf16 v[44:47], a[232:235], a[64:67], v[44:47]
    s_waitcnt lgkmcnt(6)
    ds_read_b64_tr_b16 a[228:229], v23 offset:46104
    ds_read_b64_tr_b16 a[230:231], v23 offset:48664
    v_mfma_f32_16x16x32_bf16 v[64:67], a[232:235], a[68:71], v[64:67]
    v_mfma_f32_16x16x32_bf16 v[48:51], a[236:239], a[64:67], v[48:51]
    s_waitcnt lgkmcnt(6)
    ds_read_b64_tr_b16 a[232:233], v23 offset:46112
    ds_read_b64_tr_b16 a[234:235], v23 offset:48672
    v_mfma_f32_16x16x32_bf16 v[68:71], a[236:239], a[68:71], v[68:71]
    buffer_load_dwordx4 v25, s[20:23], s46 offen offset:3072 sc1 lds
    s_add_u32 m0, s40, 4096
    s_add_u32 s46, s46, 4096
    v_mfma_f32_16x16x32_bf16 v[32:35], a[240:243], a[72:75], v[32:35]
    s_waitcnt lgkmcnt(6)
    ds_read_b64_tr_b16 a[236:237], v24 offset:0
    ds_read_b64_tr_b16 a[238:239], v24 offset:2560
    v_mfma_f32_16x16x32_bf16 v[52:55], a[240:243], a[76:79], v[52:55]
    v_mfma_f32_16x16x32_bf16 v[36:39], a[220:223], a[72:75], v[36:39]
    s_waitcnt lgkmcnt(6)
    ds_read_b64_tr_b16 a[240:241], v24 offset:8
    ds_read_b64_tr_b16 a[242:243], v24 offset:2568
    v_mfma_f32_16x16x32_bf16 v[56:59], a[220:223], a[76:79], v[56:59]
    s_add_u32 s42, s69, 0
    buffer_load_dwordx4 v[120:123], v229, s[20:23], s42 offen sc1
    v_mfma_f32_16x16x32_bf16 v[40:43], a[224:227], a[72:75], v[40:43]
    s_waitcnt lgkmcnt(6)
    ds_read_b64_tr_b16 a[220:221], v24 offset:16
    ds_read_b64_tr_b16 a[222:223], v24 offset:2576
    v_mfma_f32_16x16x32_bf16 v[60:63], a[224:227], a[76:79], v[60:63]
    s_add_u32 s42, s69, 32768
    buffer_load_dwordx4 v[124:127], v229, s[20:23], s42 offen sc1
    v_mfma_f32_16x16x32_bf16 v[44:47], a[228:231], a[72:75], v[44:47]
    s_waitcnt lgkmcnt(6)
    ds_read_b64_tr_b16 a[224:225], v24 offset:24
    ds_read_b64_tr_b16 a[226:227], v24 offset:2584
    v_mfma_f32_16x16x32_bf16 v[64:67], a[228:231], a[76:79], v[64:67]
    buffer_load_dwordx4 v25, s[20:23], s46 offen sc1 lds
    v_mfma_f32_16x16x32_bf16 v[48:51], a[232:235], a[72:75], v[48:51]
    s_waitcnt lgkmcnt(6)
    ds_read_b64_tr_b16 a[228:229], v24 offset:32
    ds_read_b64_tr_b16 a[230:231], v24 offset:2592
    v_mfma_f32_16x16x32_bf16 v[68:71], a[232:235], a[76:79], v[68:71]
    v_mfma_f32_16x16x32_bf16 v[32:35], a[236:239], a[80:83], v[32:35]
    s_waitcnt lgkmcnt(6)
    ds_read_b64_tr_b16 a[232:233], v24 offset:5120
    ds_read_b64_tr_b16 a[234:235], v24 offset:7680
    v_mfma_f32_16x16x32_bf16 v[52:55], a[236:239], a[84:87], v[52:55]
    v_mfma_f32_16x16x32_bf16 v[36:39], a[240:243], a[80:83], v[36:39]
    s_waitcnt lgkmcnt(6)
    ds_read_b64_tr_b16 a[236:237], v24 offset:5128
    ds_read_b64_tr_b16 a[238:239], v24 offset:7688
    v_mfma_f32_16x16x32_bf16 v[56:59], a[240:243], a[84:87], v[56:59]
    v_mfma_f32_16x16x32_bf16 v[40:43], a[220:223], a[80:83], v[40:43]
    s_waitcnt lgkmcnt(6)
    ds_read_b64_tr_b16 a[240:241], v24 offset:5136
    ds_read_b64_tr_b16 a[242:243], v24 offset:7696
    v_mfma_f32_16x16x32_bf16 v[60:63], a[220:223], a[84:87], v[60:63]
    v_mfma_f32_16x16x32_bf16 v[44:47], a[224:227], a[80:83], v[44:47]
    s_waitcnt lgkmcnt(6)
    ds_read_b64_tr_b16 a[220:221], v24 offset:5144
    ds_read_b64_tr_b16 a[222:223], v24 offset:7704
    v_mfma_f32_16x16x32_bf16 v[64:67], a[224:227], a[84:87], v[64:67]
    s_waitcnt vmcnt(12)
    s_barrier
    v_mfma_f32_16x16x32_bf16 v[48:51], a[228:231], a[80:83], v[48:51]
    s_waitcnt lgkmcnt(6)
    ds_read_b64_tr_b16 a[224:225], v24 offset:5152
    ds_read_b64_tr_b16 a[226:227], v24 offset:7712
    v_mfma_f32_16x16x32_bf16 v[68:71], a[228:231], a[84:87], v[68:71]
    s_add_u32 m0, s40, 20480
    s_nop 0
    buffer_load_dwordx4 v25, s[20:23], s47 offen sc1 lds
    v_mfma_f32_16x16x32_bf16 v[32:35], a[232:235], a[88:91], v[32:35]
    s_waitcnt lgkmcnt(6)
    ds_read_b64_tr_b16 a[228:229], v24 offset:10240
    ds_read_b64_tr_b16 a[230:231], v24 offset:12800
    v_mfma_f32_16x16x32_bf16 v[52:55], a[232:235], a[92:95], v[52:55]
    v_mfma_f32_16x16x32_bf16 v[36:39], a[236:239], a[88:91], v[36:39]
    s_waitcnt lgkmcnt(6)
    ds_read_b64_tr_b16 a[232:233], v24 offset:10248
    ds_read_b64_tr_b16 a[234:235], v24 offset:12808
    v_mfma_f32_16x16x32_bf16 v[56:59], a[236:239], a[92:95], v[56:59]
    buffer_load_dwordx4 v25, s[20:23], s47 offen offset:1024 sc1 lds
    v_mfma_f32_16x16x32_bf16 v[40:43], a[240:243], a[88:91], v[40:43]
    s_waitcnt lgkmcnt(6)
    ds_read_b64_tr_b16 a[236:237], v24 offset:10256
    ds_read_b64_tr_b16 a[238:239], v24 offset:12816
    v_mfma_f32_16x16x32_bf16 v[60:63], a[240:243], a[92:95], v[60:63]
    v_mfma_f32_16x16x32_bf16 v[44:47], a[220:223], a[88:91], v[44:47]
    s_waitcnt lgkmcnt(6)
    ds_read_b64_tr_b16 a[240:241], v24 offset:10264
    ds_read_b64_tr_b16 a[242:243], v24 offset:12824
    v_mfma_f32_16x16x32_bf16 v[64:67], a[220:223], a[92:95], v[64:67]
    buffer_load_dwordx4 v25, s[20:23], s47 offen offset:2048 sc1 lds
    v_mfma_f32_16x16x32_bf16 v[48:51], a[224:227], a[88:91], v[48:51]
    s_waitcnt lgkmcnt(6)
    ds_read_b64_tr_b16 a[220:221], v24 offset:10272
    ds_read_b64_tr_b16 a[222:223], v24 offset:12832
    v_mfma_f32_16x16x32_bf16 v[68:71], a[224:227], a[92:95], v[68:71]
    v_mfma_f32_16x16x32_bf16 v[32:35], a[228:231], a[32:35], v[32:35]
    s_waitcnt lgkmcnt(6)
    ds_read_b64_tr_b16 a[224:225], v24 offset:15360
    ds_read_b64_tr_b16 a[226:227], v24 offset:17920
    v_mfma_f32_16x16x32_bf16 v[52:55], a[228:231], a[36:39], v[52:55]
    buffer_load_dwordx4 v25, s[20:23], s47 offen offset:3072 sc1 lds
    s_add_u32 m0, s40, 24576
    s_add_u32 s47, s47, 4096
    v_mfma_f32_16x16x32_bf16 v[36:39], a[232:235], a[32:35], v[36:39]
    s_waitcnt lgkmcnt(6)
    ds_read_b64_tr_b16 a[228:229], v24 offset:15368
    ds_read_b64_tr_b16 a[230:231], v24 offset:17928
    v_mfma_f32_16x16x32_bf16 v[56:59], a[232:235], a[36:39], v[56:59]
    v_mfma_f32_16x16x32_bf16 v[40:43], a[236:239], a[32:35], v[40:43]
    s_waitcnt lgkmcnt(6)
    ds_read_b64_tr_b16 a[232:233], v24 offset:15376
    ds_read_b64_tr_b16 a[234:235], v24 offset:17936
    v_mfma_f32_16x16x32_bf16 v[60:63], a[236:239], a[36:39], v[60:63]
    buffer_load_dwordx4 v25, s[20:23], s47 offen sc1 lds
    v_mfma_f32_16x16x32_bf16 v[44:47], a[240:243], a[32:35], v[44:47]
    s_waitcnt lgkmcnt(6)
    ds_read_b64_tr_b16 a[236:237], v24 offset:15384
    ds_read_b64_tr_b16 a[238:239], v24 offset:17944
    v_mfma_f32_16x16x32_bf16 v[64:67], a[240:243], a[36:39], v[64:67]
    v_mfma_f32_16x16x32_bf16 v[48:51], a[220:223], a[32:35], v[48:51]
    s_waitcnt lgkmcnt(6)
    ds_read_b64_tr_b16 a[240:241], v24 offset:15392
    ds_read_b64_tr_b16 a[242:243], v24 offset:17952
    v_mfma_f32_16x16x32_bf16 v[68:71], a[220:223], a[36:39], v[68:71]
    v_mfma_f32_16x16x32_bf16 v[32:35], a[224:227], a[40:43], v[32:35]
    s_waitcnt lgkmcnt(6)
    ds_read_b64_tr_b16 a[220:221], v24 offset:20480
    ds_read_b64_tr_b16 a[222:223], v24 offset:23040
    v_mfma_f32_16x16x32_bf16 v[52:55], a[224:227], a[44:47], v[52:55]
    v_mfma_f32_16x16x32_bf16 v[36:39], a[228:231], a[40:43], v[36:39]
    s_waitcnt lgkmcnt(6)
    ds_read_b64_tr_b16 a[224:225], v24 offset:20488
    ds_read_b64_tr_b16 a[226:227], v24 offset:23048
    v_mfma_f32_16x16x32_bf16 v[56:59], a[228:231], a[44:47], v[56:59]
    s_waitcnt vmcnt(12)
    s_barrier
    v_mfma_f32_16x16x32_bf16 v[40:43], a[232:235], a[40:43], v[40:43]
    s_waitcnt lgkmcnt(6)
    ds_read_b64_tr_b16 a[228:229], v24 offset:20496
    ds_read_b64_tr_b16 a[230:231], v24 offset:23056
    v_mfma_f32_16x16x32_bf16 v[60:63], a[232:235], a[44:47], v[60:63]
    v_mfma_f32_16x16x32_bf16 v[44:47], a[236:239], a[40:43], v[44:47]
    s_waitcnt lgkmcnt(6)
    ds_read_b64_tr_b16 a[232:233], v24 offset:20504
    ds_read_b64_tr_b16 a[234:235], v24 offset:23064
    v_mfma_f32_16x16x32_bf16 v[64:67], a[236:239], a[44:47], v[64:67]
    s_add_u32 m0, s40, 40960
    s_nop 0
    buffer_load_dwordx4 v25, s[20:23], s48 offen sc1 lds
    v_mfma_f32_16x16x32_bf16 v[48:51], a[240:243], a[40:43], v[48:51]
    s_waitcnt lgkmcnt(6)
    ds_read_b64_tr_b16 a[236:237], v24 offset:20512
    ds_read_b64_tr_b16 a[238:239], v24 offset:23072
    v_mfma_f32_16x16x32_bf16 v[68:71], a[240:243], a[44:47], v[68:71]
    v_mfma_f32_16x16x32_bf16 v[32:35], a[220:223], a[48:51], v[32:35]
    s_waitcnt lgkmcnt(6)
    ds_read_b64_tr_b16 a[240:241], v24 offset:25600
    ds_read_b64_tr_b16 a[242:243], v24 offset:28160
    v_mfma_f32_16x16x32_bf16 v[52:55], a[220:223], a[52:55], v[52:55]
    buffer_load_dwordx4 v25, s[20:23], s48 offen offset:1024 sc1 lds
    v_mfma_f32_16x16x32_bf16 v[36:39], a[224:227], a[48:51], v[36:39]
    s_waitcnt lgkmcnt(6)
    ds_read_b64_tr_b16 a[220:221], v24 offset:25608
    ds_read_b64_tr_b16 a[222:223], v24 offset:28168
    v_mfma_f32_16x16x32_bf16 v[56:59], a[224:227], a[52:55], v[56:59]
    v_mfma_f32_16x16x32_bf16 v[40:43], a[228:231], a[48:51], v[40:43]
    s_waitcnt lgkmcnt(6)
    ds_read_b64_tr_b16 a[224:225], v24 offset:25616
    ds_read_b64_tr_b16 a[226:227], v24 offset:28176
    v_mfma_f32_16x16x32_bf16 v[60:63], a[228:231], a[52:55], v[60:63]
    buffer_load_dwordx4 v25, s[20:23], s48 offen offset:2048 sc1 lds
    s_waitcnt vmcnt(10)
    v_xor_b32 v120, s8, v120
    v_xor_b32 v121, s9, v121
    v_xor_b32 v122, s10, v122
    v_xor_b32 v123, s11, v123
    v_or_b32 v114, v120, v121
    v_or3_b32 v114, v114, v122, v123
    s_waitcnt vmcnt(9)
    v_xor_b32 v124, s8, v124
    v_xor_b32 v125, s9, v125
    v_xor_b32 v126, s10, v126
    v_xor_b32 v127, s11, v127
    v_or3_b32 v114, v114, v124, v125
    v_or3_b32 v114, v114, v126, v127
    v_and_b32 v114, 0xff, v114
    v_cmp_ne_u32 vcc, 0, v114
    v_add_f32 v120, v120, v124
    v_add_f32 v121, v121, v125
    v_mfma_f32_16x16x32_bf16 v[44:47], a[232:235], a[48:51], v[44:47]
    s_waitcnt lgkmcnt(6)
    ds_read_b64_tr_b16 a[228:229], v24 offset:25624
    ds_read_b64_tr_b16 a[230:231], v24 offset:28184
    v_mfma_f32_16x16x32_bf16 v[64:67], a[232:235], a[52:55], v[64:67]
    v_add_f32 v122, v122, v126
    v_add_f32 v123, v123, v127
    s_cbranch_vccnz L_h1B_retry
L_h1B_ok:
    v_permlane32_swap_b32 v120, v122
    v_permlane32_swap_b32 v121, v123
    v_add_f32 v120, v120, v122
    v_add_f32 v121, v121, v123
    v_mov_b32 v114, 0xffff
    v_mfma_f32_16x16x32_bf16 v[48:51], a[236:239], a[48:51], v[48:51]
    s_waitcnt lgkmcnt(6)
    ds_read_b64_tr_b16 a[232:233], v24 offset:25632
    ds_read_b64_tr_b16 a[234:235], v24 offset:28192
    v_mfma_f32_16x16x32_bf16 v[68:71], a[236:239], a[52:55], v[68:71]
    buffer_load_dwordx4 v25, s[20:23], s48 offen offset:3072 sc1 lds
    s_add_u32 m0, s40, 45056
    s_add_u32 s48, s48, 4096
    v_permlane16_swap_b32 v120, v121
    v_add_f32 v120, v120, v121
    s_nop 1
    v_add_f32_dpp v120, v120, v120 row_ror:8 row_mask:0xf bank_mask:0xf
    v_cvt_pk_bf16_f32 v120, v120, v120
    v_bfi_b32 v120, v114, v27, v120
    s_mov_b32 exec_lo, 0x00ff00ff
    s_mov_b32 exec_hi, 0x00ff00ff
    buffer_store_dword v120, v230, s[20:23], s70 offen sc1
    s_add_u32 s70, s70, 262144
    buffer_store_dword v120, v230, s[20:23], s70 offen sc1
    s_add_u32 s70, s70, 262144
    buffer_store_dword v120, v230, s[20:23], s70 offen sc1
    s_add_u32 s70, s70, 262144
    buffer_store_dword v120, v230, s[20:23], s70 offen sc1
    s_mov_b64 exec, -1
    v_mfma_f32_16x16x32_bf16 v[32:35], a[240:243], a[56:59], v[32:35]
    s_waitcnt lgkmcnt(6)
    ds_read_b64_tr_b16 a[236:237], v24 offset:30720
    ds_read_b64_tr_b16 a[238:239], v24 offset:33280
    v_mfma_f32_16x16x32_bf16 v[52:55], a[240:243], a[60:63], v[52:55]
    v_mfma_f32_16x16x32_bf16 v[36:39], a[220:223], a[56:59], v[36:39]
    s_waitcnt lgkmcnt(6)
    ds_read_b64_tr_b16 a[240:241], v24 offset:30728
    ds_read_b64_tr_b16 a[242:243], v24 offset:33288
    v_mfma_f32_16x16x32_bf16 v[56:59], a[220:223], a[60:63], v[56:59]
    buffer_load_dwordx4 v25, s[20:23], s48 offen sc1 lds
    v_mfma_f32_16x16x32_bf16 v[40:43], a[224:227], a[56:59], v[40:43]
    s_waitcnt lgkmcnt(6)
    ds_read_b64_tr_b16 a[220:221], v24 offset:30736
    ds_read_b64_tr_b16 a[222:223], v24 offset:33296
    v_mfma_f32_16x16x32_bf16 v[60:63], a[224:227], a[60:63], v[60:63]
    v_mfma_f32_16x16x32_bf16 v[44:47], a[228:231], a[56:59], v[44:47]
    s_waitcnt lgkmcnt(6)
    ds_read_b64_tr_b16 a[224:225], v24 offset:30744
    ds_read_b64_tr_b16 a[226:227], v24 offset:33304
    v_mfma_f32_16x16x32_bf16 v[64:67], a[228:231], a[60:63], v[64:67]
    v_mfma_f32_16x16x32_bf16 v[48:51], a[232:235], a[56:59], v[48:51]
    s_waitcnt lgkmcnt(6)
    ds_read_b64_tr_b16 a[228:229], v24 offset:30752
    ds_read_b64_tr_b16 a[230:231], v24 offset:33312
    v_mfma_f32_16x16x32_bf16 v[68:71], a[232:235], a[60:63], v[68:71]
    v_mfma_f32_16x16x32_bf16 v[32:35], a[236:239], a[0:3], v[32:35]
    s_waitcnt lgkmcnt(6)
    ds_read_b64_tr_b16 a[232:233], v24 offset:35840
    ds_read_b64_tr_b16 a[234:235], v24 offset:38400
    v_mfma_f32_16x16x32_bf16 v[52:55], a[236:239], a[4:7], v[52:55]
    s_barrier
    v_mfma_f32_16x16x32_bf16 v[36:39], a[240:243], a[0:3], v[36:39]
    s_waitcnt lgkmcnt(6)
    ds_read_b64_tr_b16 a[236:237], v24 offset:35848
    ds_read_b64_tr_b16 a[238:239], v24 offset:38408
    v_mfma_f32_16x16x32_bf16 v[56:59], a[240:243], a[4:7], v[56:59]
    v_mfma_f32_16x16x32_bf16 v[40:43], a[220:223], a[0:3], v[40:43]
    s_waitcnt lgkmcnt(6)
    ds_read_b64_tr_b16 a[240:241], v24 offset:35856
    ds_read_b64_tr_b16 a[242:243], v24 offset:38416
    v_mfma_f32_16x16x32_bf16 v[60:63], a[220:223], a[4:7], v[60:63]
    s_add_u32 m0, s40, 61440
    s_nop 0
    buffer_load_dwordx4 v25, s[20:23], s49 offen sc1 lds
    v_mfma_f32_16x16x32_bf16 v[44:47], a[224:227], a[0:3], v[44:47]
    s_waitcnt lgkmcnt(6)
    ds_read_b64_tr_b16 a[220:221], v24 offset:35864
    ds_read_b64_tr_b16 a[222:223], v24 offset:38424
    v_mfma_f32_16x16x32_bf16 v[64:67], a[224:227], a[4:7], v[64:67]
    s_mov_b32 exec_lo, 0x1fff
    s_mov_b32 exec_hi, 0x0
    buffer_load_dword v251, v253, s[28:31], s60 offen sc1
    s_mov_b64 exec, 1
    buffer_load_dword v251, v250, s[20:23], s59 offen sc1
    s_mov_b64 exec, -1
    v_mfma_f32_16x16x32_bf16 v[48:51], a[228:231], a[0:3], v[48:51]
    s_waitcnt lgkmcnt(6)
    ds_read_b64_tr_b16 a[224:225], v24 offset:35872
    ds_read_b64_tr_b16 a[226:227], v24 offset:38432
    v_mfma_f32_16x16x32_bf16 v[68:71], a[228:231], a[4:7], v[68:71]
    buffer_load_dwordx4 v25, s[20:23], s49 offen offset:1024 sc1 lds
    v_mfma_f32_16x16x32_bf16 v[32:35], a[232:235], a[8:11], v[32:35]
    s_waitcnt lgkmcnt(6)
    ds_read_b64_tr_b16 a[228:229], v24 offset:40960
    ds_read_b64_tr_b16 a[230:231], v24 offset:43520
    v_mfma_f32_16x16x32_bf16 v[52:55], a[232:235], a[12:15], v[52:55]
    v_mfma_f32_16x16x32_bf16 v[36:39], a[236:239], a[8:11], v[36:39]
    s_waitcnt lgkmcnt(6)
    ds_read_b64_tr_b16 a[232:233], v24 offset:40968
    ds_read_b64_tr_b16 a[234:235], v24 offset:43528
    v_mfma_f32_16x16x32_bf16 v[56:59], a[236:239], a[12:15], v[56:59]
    buffer_load_dwordx4 v25, s[20:23], s49 offen offset:2048 sc1 lds
    v_mfma_f32_16x16x32_bf16 v[40:43], a[240:243], a[8:11], v[40:43]
    s_waitcnt lgkmcnt(6)
    ds_read_b64_tr_b16 a[236:237], v24 offset:40976
    ds_read_b64_tr_b16 a[238:239], v24 offset:43536
    v_mfma_f32_16x16x32_bf16 v[60:63], a[240:243], a[12:15], v[60:63]
    v_mfma_f32_16x16x32_bf16 v[44:47], a[220:223], a[8:11], v[44:47]
    s_waitcnt lgkmcnt(6)
    ds_read_b64_tr_b16 a[240:241], v24 offset:40984
    ds_read_b64_tr_b16 a[242:243], v24 offset:43544
    v_mfma_f32_16x16x32_bf16 v[64:67], a[220:223], a[12:15], v[64:67]
    buffer_load_dwordx4 v25, s[20:23], s49 offen offset:3072 sc1 lds
    s_add_u32 m0, s40, 65536
    s_add_u32 s49, s49, 4096
    v_mfma_f32_16x16x32_bf16 v[48:51], a[224:227], a[8:11], v[48:51]
    s_waitcnt lgkmcnt(6)
    ds_read_b64_tr_b16 a[220:221], v24 offset:40992
    ds_read_b64_tr_b16 a[222:223], v24 offset:43552
    v_mfma_f32_16x16x32_bf16 v[68:71], a[224:227], a[12:15], v[68:71]
    v_mfma_f32_16x16x32_bf16 v[32:35], a[228:231], a[16:19], v[32:35]
    s_waitcnt lgkmcnt(6)
    ds_read_b64_tr_b16 a[224:225], v24 offset:46080
    ds_read_b64_tr_b16 a[226:227], v24 offset:48640
    v_mfma_f32_16x16x32_bf16 v[52:55], a[228:231], a[20:23], v[52:55]
    buffer_load_dwordx4 v25, s[20:23], s49 offen sc1 lds
    v_mfma_f32_16x16x32_bf16 v[36:39], a[232:235], a[16:19], v[36:39]
    s_waitcnt lgkmcnt(6)
    ds_read_b64_tr_b16 a[228:229], v24 offset:46088
    ds_read_b64_tr_b16 a[230:231], v24 offset:48648
    v_mfma_f32_16x16x32_bf16 v[56:59], a[232:235], a[20:23], v[56:59]
    v_mfma_f32_16x16x32_bf16 v[40:43], a[236:239], a[16:19], v[40:43]
    s_waitcnt lgkmcnt(6)
    ds_read_b64_tr_b16 a[232:233], v24 offset:46096
    ds_read_b64_tr_b16 a[234:235], v24 offset:48656
    v_mfma_f32_16x16x32_bf16 v[60:63], a[236:239], a[20:23], v[60:63]
    v_mfma_f32_16x16x32_bf16 v[44:47], a[240:243], a[16:19], v[44:47]
    s_waitcnt lgkmcnt(6)
    ds_read_b64_tr_b16 a[236:237], v24 offset:46104
    ds_read_b64_tr_b16 a[238:239], v24 offset:48664
    v_mfma_f32_16x16x32_bf16 v[64:67], a[240:243], a[20:23], v[64:67]
    v_mfma_f32_16x16x32_bf16 v[48:51], a[220:223], a[16:19], v[48:51]
    s_waitcnt lgkmcnt(6)
    ds_read_b64_tr_b16 a[240:241], v24 offset:46112
    ds_read_b64_tr_b16 a[242:243], v24 offset:48672
    v_mfma_f32_16x16x32_bf16 v[68:71], a[220:223], a[20:23], v[68:71]
    v_mfma_f32_16x16x32_bf16 v[32:35], a[224:227], a[24:27], v[32:35]
    s_waitcnt lgkmcnt(6)
    v_mfma_f32_16x16x32_bf16 v[52:55], a[224:227], a[28:31], v[52:55]
    v_mfma_f32_16x16x32_bf16 v[36:39], a[228:231], a[24:27], v[36:39]
    s_waitcnt lgkmcnt(4)
    v_mfma_f32_16x16x32_bf16 v[56:59], a[228:231], a[28:31], v[56:59]
    v_mfma_f32_16x16x32_bf16 v[40:43], a[232:235], a[24:27], v[40:43]
    s_waitcnt lgkmcnt(2)
    v_mfma_f32_16x16x32_bf16 v[60:63], a[232:235], a[28:31], v[60:63]
    v_mfma_f32_16x16x32_bf16 v[44:47], a[236:239], a[24:27], v[44:47]
    s_waitcnt lgkmcnt(0)
    v_mfma_f32_16x16x32_bf16 v[64:67], a[236:239], a[28:31], v[64:67]
    v_mfma_f32_16x16x32_bf16 v[48:51], a[240:243], a[24:27], v[48:51]
    v_mfma_f32_16x16x32_bf16 v[68:71], a[240:243], a[28:31], v[68:71]
    s_barrier
    v_mov_b32 v204, 0
    v_mov_b32 v205, 0
    ds_write_b64 v252, v[204:205]
    v_accvgpr_write_b32 a50, 0
    v_accvgpr_write_b32 a51, 0
    v_accvgpr_write_b32 a62, 0
    v_accvgpr_write_b32 a63, 0
    v_accvgpr_write_b32 a74, 0
    v_accvgpr_write_b32 a75, 0
    v_accvgpr_write_b32 a86, 0
    v_accvgpr_write_b32 a87, 0
    v_accvgpr_write_b32 a98, 0
    v_accvgpr_write_b32 a99, 0
    v_accvgpr_write_b32 a110, 0
    v_accvgpr_write_b32 a111, 0
    v_pk_fma_f32 v[112:113], v[32:33], s[54:55], v[30:31] op_sel:[0,0,1] op_sel_hi:[1,0,1]
    v_pk_fma_f32 v[114:115], v[34:35], s[54:55], v[30:31] op_sel:[0,0,1] op_sel_hi:[1,0,1]
    v_pk_fma_f32 v[116:117], v[36:37], s[54:55], v[30:31] op_sel:[0,0,1] op_sel_hi:[1,0,1]
    v_pk_fma_f32 v[118:119], v[38:39], s[54:55], v[30:31] op_sel:[0,0,1] op_sel_hi:[1,0,1]
    v_pk_fma_f32 v[120:121], v[40:41], s[54:55], v[30:31] op_sel:[0,0,1] op_sel_hi:[1,0,1]
    v_pk_fma_f32 v[122:123], v[42:43], s[54:55], v[30:31] op_sel:[0,0,1] op_sel_hi:[1,0,1]
    v_pk_fma_f32 v[124:125], v[44:45], s[54:55], v[30:31] op_sel:[0,0,1] op_sel_hi:[1,0,1]
    v_pk_fma_f32 v[126:127], v[46:47], s[54:55], v[30:31] op_sel:[0,0,1] op_sel_hi:[1,0,1]
    v_pk_fma_f32 v[128:129], v[48:49], s[54:55], v[30:31] op_sel:[0,0,1] op_sel_hi:[1,0,1]
    v_pk_fma_f32 v[130:131], v[50:51], s[54:55], v[30:31] op_sel:[0,0,1] op_sel_hi:[1,0,1]
    v_exp_f32 v112, v112 clamp
    v_exp_f32 v113, v113 clamp
    v_exp_f32 v114, v114 clamp
    v_exp_f32 v115, v115 clamp
    v_exp_f32 v116, v116 clamp
    v_exp_f32 v117, v117 clamp
    v_exp_f32 v118, v118 clamp
    s_add_u32 m0, s40, 81920
    s_nop 0
    buffer_load_dwordx4 v25, s[20:23], s50 offen sc1 lds
    s_nop 0
    v_exp_f32 v119, v119 clamp
    v_exp_f32 v120, v120 clamp
    v_exp_f32 v121, v121 clamp
    v_exp_f32 v122, v122 clamp
    v_exp_f32 v123, v123 clamp
    v_exp_f32 v124, v124 clamp
    v_exp_f32 v125, v125 clamp
    v_exp_f32 v126, v126 clamp
    v_exp_f32 v127, v127 clamp
    v_exp_f32 v128, v128 clamp
    v_exp_f32 v129, v129 clamp
    v_exp_f32 v130, v130 clamp
    buffer_load_dwordx4 v25, s[20:23], s50 offen offset:1024 sc1 lds
    v_exp_f32 v131, v131 clamp
    v_max_f32 v32, 0x358637bd, v32
    v_max_f32 v33, 0x358637bd, v33
    v_max_f32 v34, 0x358637bd, v34
    v_max_f32 v35, 0x358637bd, v35
    v_max_f32 v36, 0x358637bd, v36
    v_max_f32 v37, 0x358637bd, v37
    v_max_f32 v38, 0x358637bd, v38
    v_max_f32 v39, 0x358637bd, v39
    v_max_f32 v40, 0x358637bd, v40
    v_max_f32 v41, 0x358637bd, v41
    v_max_f32 v42, 0x358637bd, v42
    v_max_f32 v43, 0x358637bd, v43
    v_max_f32 v44, 0x358637bd, v44
    v_max_f32 v45, 0x358637bd, v45
    v_max_f32 v46, 0x358637bd, v46
    v_max_f32 v47, 0x358637bd, v47
    v_max_f32 v48, 0x358637bd, v48
    v_max_f32 v49, 0x358637bd, v49
    v_max_f32 v50, 0x358637bd, v50
    v_max_f32 v51, 0x358637bd, v51
    v_pk_add_f32 v[112:113], v[112:113], v[32:33]
    v_pk_add_f32 v[114:115], v[114:115], v[34:35]
    buffer_load_dwordx4 v25, s[20:23], s50 offen offset:2048 sc1 lds
    v_pk_add_f32 v[116:117], v[116:117], v[36:37]
L_hop4B:
    s_cbranch_execz L_hopretB
    v_pk_add_f32 v[118:119], v[118:119], v[38:39]
    s_nop 0
    v_pk_add_f32 v[120:121], v[120:121], v[40:41]
    v_pk_add_f32 v[122:123], v[122:123], v[42:43]
    v_pk_add_f32 v[124:125], v[124:125], v[44:45]
    v_pk_add_f32 v[126:127], v[126:127], v[46:47]
    v_pk_add_f32 v[128:129], v[128:129], v[48:49]
    v_pk_add_f32 v[130:131], v[130:131], v[50:51]
    v_cvt_pk_bf16_f32 v32, v112, v113
    v_cvt_pk_bf16_f32 v33, v114, v115
    v_cvt_pk_bf16_f32 v34, v116, v117
    v_cvt_pk_bf16_f32 v35, v118, v119
    v_cvt_pk_bf16_f32 v36, v120, v121
    v_cvt_pk_bf16_f32 v37, v122, v123
    v_cvt_pk_bf16_f32 v38, v124, v125
    v_cvt_pk_bf16_f32 v39, v126, v127
    v_cvt_pk_bf16_f32 v40, v128, v129
    v_cvt_pk_bf16_f32 v41, v130, v131
    v_mov_b32 v42, 0
    v_mov_b32 v43, 0
    v_pk_fma_f32 v[152:153], v[52:53], s[54:55], v[30:31] op_sel:[0,0,1] op_sel_hi:[1,0,1]
    v_pk_fma_f32 v[154:155], v[54:55], s[54:55], v[30:31] op_sel:[0,0,1] op_sel_hi:[1,0,1]
    v_pk_fma_f32 v[156:157], v[56:57], s[54:55], v[30:31] op_sel:[0,0,1] op_sel_hi:[1,0,1]
    v_pk_fma_f32 v[158:159], v[58:59], s[54:55], v[30:31] op_sel:[0,0,1] op_sel_hi:[1,0,1]
    buffer_load_dwordx4 v25, s[20:23], s50 offen offset:3072 sc1 lds
    s_add_u32 m0, s40, 86016
    s_add_u32 s50, s50, 4096
    v_pk_fma_f32 v[160:161], v[60:61], s[54:55], v[30:31] op_sel:[0,0,1] op_sel_hi:[1,0,1]
    v_pk_fma_f32 v[162:163], v[62:63], s[54:55], v[30:31] op_sel:[0,0,1] op_sel_hi:[1,0,1]
    v_pk_fma_f32 v[164:165], v[64:65], s[54:55], v[30:31] op_sel:[0,0,1] op_sel_hi:[1,0,1]
    v_pk_fma_f32 v[166:167], v[66:67], s[54:55], v[30:31] op_sel:[0,0,1] op_sel_hi:[1,0,1]
    v_pk_fma_f32 v[168:169], v[68:69], s[54:55], v[30:31] op_sel:[0,0,1] op_sel_hi:[1,0,1]
    v_pk_fma_f32 v[170:171], v[70:71], s[54:55], v[30:31] op_sel:[0,0,1] op_sel_hi:[1,0,1]
    v_exp_f32 v152, v152 clamp
    buffer_load_dwordx4 v[208:211], v25, s[20:23], s71 offen offset:0 sc1
    buffer_load_dwordx4 v[212:215], v231, s[20:23], s71 offen offset:0 sc1
    v_exp_f32 v153, v153 clamp
    v_exp_f32 v154, v154 clamp
    v_exp_f32 v155, v155 clamp
    v_exp_f32 v156, v156 clamp
    v_exp_f32 v157, v157 clamp
    v_exp_f32 v158, v158 clamp
    s_mov_b32 exec_lo, 0x3ffe000
    s_mov_b32 exec_hi, 0x0
    buffer_load_dword v251, v253, s[28:31], s60 offen sc1
    s_mov_b64 exec, -1
    v_exp_f32 v159, v159 clamp
    v_exp_f32 v160, v160 clamp
    buffer_load_dwordx4 v25, s[20:23], s50 offen sc1 lds
    v_exp_f32 v161, v161 clamp
    v_exp_f32 v162, v162 clamp
    v_exp_f32 v163, v163 clamp
    v_exp_f32 v164, v164 clamp
    v_exp_f32 v165, v165 clamp
    v_exp_f32 v166, v166 clamp
    v_exp_f32 v167, v167 clamp
    v_exp_f32 v168, v168 clamp
    v_exp_f32 v169, v169 clamp
    v_exp_f32 v170, v170 clamp
    v_exp_f32 v171, v171 clamp
    v_max_f32 v52, 0x358637bd, v52
    v_max_f32 v53, 0x358637bd, v53
    v_max_f32 v54, 0x358637bd, v54
    v_max_f32 v55, 0x358637bd, v55
    v_max_f32 v56, 0x358637bd, v56
    v_max_f32 v57, 0x358637bd, v57
    v_max_f32 v58, 0x358637bd, v58
    v_max_f32 v59, 0x358637bd, v59
    v_max_f32 v60, 0x358637bd, v60
    v_max_f32 v61, 0x358637bd, v61
    v_max_f32 v62, 0x358637bd, v62
    v_max_f32 v63, 0x358637bd, v63
    v_max_f32 v64, 0x358637bd, v64
    s_mov_b32 exec_lo, 0xfc000000
    s_mov_b32 exec_hi, 0xff
    buffer_load_dword v251, v253, s[28:31], s60 offen sc1
    s_mov_b64 exec, -1
    s_nop 0
    v_max_f32 v65, 0x358637bd, v65
    v_max_f32 v66, 0x358637bd, v66
    v_max_f32 v67, 0x358637bd, v67
    v_max_f32 v68, 0x358637bd, v68
    v_max_f32 v69, 0x358637bd, v69
    v_max_f32 v70, 0x358637bd, v70
    v_max_f32 v71, 0x358637bd, v71
    v_pk_add_f32 v[152:153], v[152:153], v[52:53]
    v_pk_add_f32 v[154:155], v[154:155], v[54:55]
    v_pk_add_f32 v[156:157], v[156:157], v[56:57]
    v_pk_add_f32 v[158:159], v[158:159], v[58:59]
    v_pk_add_f32 v[160:161], v[160:161], v[60:61]
    v_pk_add_f32 v[162:163], v[162:163], v[62:63]
    v_pk_add_f32 v[164:165], v[164:165], v[64:65]
    v_pk_add_f32 v[166:167], v[166:167], v[66:67]
    v_pk_add_f32 v[168:169], v[168:169], v[68:69]
    v_pk_add_f32 v[170:171], v[170:171], v[70:71]
    v_cvt_pk_bf16_f32 v52, v152, v153
    v_cvt_pk_bf16_f32 v53, v154, v155
    v_cvt_pk_bf16_f32 v54, v156, v157
    v_cvt_pk_bf16_f32 v55, v158, v159
    v_cvt_pk_bf16_f32 v56, v160, v161
    v_cvt_pk_bf16_f32 v57, v162, v163
    v_cvt_pk_bf16_f32 v58, v164, v165
    v_cvt_pk_bf16_f32 v59, v166, v167
    v_cvt_pk_bf16_f32 v60, v168, v169
    v_cvt_pk_bf16_f32 v61, v170, v171
    v_mov_b32 v62, 0
    v_mov_b32 v63, 0
    s_waitcnt vmcnt(3)
    v_perm_b32 v120, v209, v208, s75
    v_perm_b32 v121, v211, v210, s75
    ds_write_b64 v232, v[120:121]
    v_perm_b32 v122, v213, v212, s75
    v_perm_b32 v123, v215, v214, s75
    ds_write_b64 v233, v[122:123]
    v_xor_b32 v204, s32, v208
    v_bitop3_b32 v204, v204, v209, s38 bitop3:0xf6
    v_bitop3_b32 v204, v204, v210, s32 bitop3:0xf6
    v_bitop3_b32 v204, v204, v211, s38 bitop3:0xf6
    v_bitop3_b32 v204, v204, v212, s32 bitop3:0xf6
    v_bitop3_b32 v204, v204, v213, s38 bitop3:0xf6
    v_bitop3_b32 v204, v204, v214, s32 bitop3:0xf6
    v_bitop3_b32 v204, v204, v215, s38 bitop3:0xf6
    v_and_b32 v204, 0xffff, v204
    v_cmp_ne_u32 vcc, 0, v204
    s_nop 3
    s_cbranch_vccnz L_h2B_retry
L_h2B_ok:
    s_cmp_eq_u32 s53, 0
    s_waitcnt lgkmcnt(0)
    s_barrier
    s_cbranch_scc0 L_tailBs
    ds_read_b128 a[40:43], v236 offset:960
    ds_read_b128 a[44:47], v236 offset:976
    ds_read_b64 a[48:49], v236 offset:992
    ds_read_b128 a[52:55], v236 offset:0
    ds_read_b128 a[56:59], v236 offset:16
    ds_read_b64 a[60:61], v236 offset:32
    ds_read_b128 a[64:67], v236 offset:192
    ds_read_b128 a[68:71], v236 offset:208
    ds_read_b64 a[72:73], v236 offset:224
    ds_read_b128 a[76:79], v236 offset:384
    s_waitcnt lgkmcnt(9)
    v_mfma_f32_16x16x32_bf16 v[92:95], a[40:43], v[32:35], 0
    s_waitcnt lgkmcnt(8)
    ds_read_b128 a[80:83], v236 offset:400
    v_mfma_f32_16x16x32_bf16 v[92:95], a[44:47], v[36:39], v[92:95]
    s_waitcnt lgkmcnt(8)
    ds_read_b64 a[84:85], v236 offset:416
    v_mfma_f32_16x16x32_bf16 v[92:95], a[48:51], v[40:43], v[92:95]
    s_waitcnt lgkmcnt(8)
    ds_read_b128 a[88:91], v236 offset:576
    v_mfma_f32_16x16x32_bf16 v[72:75], a[52:55], v[32:35], 0
    s_waitcnt lgkmcnt(8)
    ds_read_b128 a[92:95], v236 offset:592
    v_mfma_f32_16x16x32_bf16 v[72:75], a[56:59], v[36:39], v[72:75]
    s_waitcnt lgkmcnt(8)
    ds_read_b64 a[96:97], v236 offset:608
    v_mfma_f32_16x16x32_bf16 v[72:75], a[60:63], v[40:43], v[72:75]
    s_waitcnt lgkmcnt(8)
    ds_read_b128 a[100:103], v236 offset:768
    v_mfma_f32_16x16x32_bf16 v[76:79], a[64:67], v[32:35], 0
    s_waitcnt lgkmcnt(8)
    ds_read_b128 a[104:107], v236 offset:784
    v_add_f32 v92, 0x358637bd, v92
    v_mfma_f32_16x16x32_bf16 v[76:79], a[68:71], v[36:39], v[76:79]
    s_waitcnt lgkmcnt(8)
    ds_read_b64 a[108:109], v236 offset:800
    v_rcp_f32 v92, v92
    v_mfma_f32_16x16x32_bf16 v[76:79], a[72:75], v[40:43], v[76:79]
    s_waitcnt lgkmcnt(8)
    ds_read_b128 v[148:151], v25 offset:0
    v_mfma_f32_16x16x32_bf16 v[80:83], a[76:79], v[32:35], 0
    s_waitcnt lgkmcnt(8)
    v_mul_f32 v72, v72, v92
    v_mul_f32 v73, v73, v92
    v_mul_f32 v74, v74, v92
    v_mfma_f32_16x16x32_bf16 v[80:83], a[80:83], v[36:39], v[80:83]
    s_waitcnt lgkmcnt(7)
    v_mul_f32 v75, v75, v92
    v_cvt_pk_bf16_f32 v176, v72, v73
    v_cvt_pk_bf16_f32 v177, v74, v75
    v_mfma_f32_16x16x32_bf16 v[80:83], a[84:87], v[40:43], v[80:83]
    s_waitcnt lgkmcnt(6)
    ds_read_b128 v[152:155], v25 offset:1024
    v_mfma_f32_16x16x32_bf16 v[84:87], a[88:91], v[32:35], 0
    s_waitcnt lgkmcnt(6)
    v_mul_f32 v76, v76, v92
    v_mul_f32 v77, v77, v92
    v_mul_f32 v78, v78, v92
    v_mfma_f32_16x16x32_bf16 v[84:87], a[92:95], v[36:39], v[84:87]
    s_waitcnt lgkmcnt(5)
    v_mul_f32 v79, v79, v92
    v_cvt_pk_bf16_f32 v178, v76, v77
    v_cvt_pk_bf16_f32 v179, v78, v79
    v_mfma_f32_16x16x32_bf16 v[84:87], a[96:99], v[40:43], v[84:87]
    s_waitcnt lgkmcnt(4)
    buffer_store_dwordx4 v[176:179], v7, s[28:31], s60 offen
    v_mfma_f32_16x16x32_bf16 v[116:119], a[40:43], v[52:55], 0
    v_mul_f32 v80, v80, v92
    v_mul_f32 v81, v81, v92
    v_mul_f32 v82, v82, v92
    v_mfma_f32_16x16x32_bf16 v[116:119], a[44:47], v[56:59], v[116:119]
    v_mul_f32 v83, v83, v92
    v_cvt_pk_bf16_f32 v184, v80, v81
    v_cvt_pk_bf16_f32 v185, v82, v83
    v_mfma_f32_16x16x32_bf16 v[116:119], a[48:51], v[60:63], v[116:119]
    ds_read_b128 v[156:159], v25 offset:2048
    v_mfma_f32_16x16x32_bf16 v[96:99], a[52:55], v[52:55], 0
    v_mul_f32 v84, v84, v92
    v_mul_f32 v85, v85, v92
    v_mul_f32 v86, v86, v92
    v_mfma_f32_16x16x32_bf16 v[96:99], a[56:59], v[56:59], v[96:99]
    v_mul_f32 v87, v87, v92
    v_cvt_pk_bf16_f32 v186, v84, v85
    v_cvt_pk_bf16_f32 v187, v86, v87
    v_mfma_f32_16x16x32_bf16 v[96:99], a[60:63], v[60:63], v[96:99]
    buffer_store_dwordx4 v[184:187], v8, s[28:31], s60 offen
    v_mfma_f32_16x16x32_bf16 v[100:103], a[64:67], v[52:55], 0
    v_add_f32 v116, 0x358637bd, v116
    v_rcp_f32 v116, v116
    v_mfma_f32_16x16x32_bf16 v[100:103], a[68:71], v[56:59], v[100:103]
    ds_read_b128 v[160:163], v25 offset:3072
    v_mfma_f32_16x16x32_bf16 v[100:103], a[72:75], v[60:63], v[100:103]
    ds_read_b128 v[164:167], v25 offset:4096
    v_mfma_f32_16x16x32_bf16 v[104:107], a[76:79], v[52:55], 0
    v_mul_f32 v96, v96, v116
    v_mul_f32 v97, v97, v116
    v_mul_f32 v98, v98, v116
    v_mfma_f32_16x16x32_bf16 v[104:107], a[80:83], v[56:59], v[104:107]
    v_mul_f32 v99, v99, v116
    v_cvt_pk_bf16_f32 v180, v96, v97
    v_cvt_pk_bf16_f32 v181, v98, v99
    v_mfma_f32_16x16x32_bf16 v[104:107], a[84:87], v[60:63], v[104:107]
    ds_read_b128 v[168:171], v25 offset:5120
    v_mfma_f32_16x16x32_bf16 v[108:111], a[88:91], v[52:55], 0
    v_mul_f32 v100, v100, v116
    v_mul_f32 v101, v101, v116
    v_mul_f32 v102, v102, v116
    v_mfma_f32_16x16x32_bf16 v[108:111], a[92:95], v[56:59], v[108:111]
    v_mul_f32 v103, v103, v116
    v_cvt_pk_bf16_f32 v182, v100, v101
    v_cvt_pk_bf16_f32 v183, v102, v103
    v_mfma_f32_16x16x32_bf16 v[108:111], a[96:99], v[60:63], v[108:111]
    buffer_store_dwordx4 v[180:183], v9, s[28:31], s60 offen
    v_mfma_f32_16x16x32_bf16 v[88:91], a[100:103], v[32:35], 0
    s_waitcnt lgkmcnt(7)
    v_mul_f32 v104, v104, v116
    v_mul_f32 v105, v105, v116
    v_mul_f32 v106, v106, v116
    v_mfma_f32_16x16x32_bf16 v[88:91], a[104:107], v[36:39], v[88:91]
    s_waitcnt lgkmcnt(6)
    v_mul_f32 v107, v107, v116
    v_cvt_pk_bf16_f32 v188, v104, v105
    v_cvt_pk_bf16_f32 v189, v106, v107
    v_mfma_f32_16x16x32_bf16 v[88:91], a[108:111], v[40:43], v[88:91]
    v_mfma_f32_16x16x32_bf16 v[112:115], a[100:103], v[52:55], 0
    v_mul_f32 v108, v108, v116
    v_mul_f32 v109, v109, v116
    v_mul_f32 v110, v110, v116
    v_mfma_f32_16x16x32_bf16 v[112:115], a[104:107], v[56:59], v[112:115]
    v_mul_f32 v111, v111, v116
    v_cvt_pk_bf16_f32 v190, v108, v109
    v_cvt_pk_bf16_f32 v191, v110, v111
    v_mfma_f32_16x16x32_bf16 v[112:115], a[108:111], v[60:63], v[112:115]
    s_waitcnt vmcnt(1)
    buffer_store_dword v254, v255, s[20:23], s59 offen offset:0
    buffer_store_dwordx4 v[188:191], v10, s[28:31], s60 offen
    v_mul_f32 v88, v88, v92
    v_mul_f32 v89, v89, v92
    v_mul_f32 v90, v90, v92
    v_mul_f32 v91, v91, v92
    v_cvt_pk_bf16_f32 v192, v88, v89
    v_cvt_pk_bf16_f32 v193, v90, v91
    s_waitcnt lgkmcnt(5)
    v_mfma_f32_16x16x32_bf16 v[32:35], v[148:151], v[176:179], 0
    s_waitcnt lgkmcnt(4)
    ds_read_b128 v[172:175], v25 offset:6144
    v_mfma_f32_16x16x32_bf16 v[52:55], v[148:151], v[180:183], 0
    v_mfma_f32_16x16x32_bf16 v[36:39], v[152:155], v[176:179], 0
    s_waitcnt lgkmcnt(4)
    ds_read_b128 v[148:151], v25 offset:7168
    v_mfma_f32_16x16x32_bf16 v[56:59], v[152:155], v[180:183], 0
    v_mul_f32 v112, v112, v116
    v_mul_f32 v113, v113, v116
    v_mul_f32 v114, v114, v116
    v_mfma_f32_16x16x32_bf16 v[40:43], v[156:159], v[176:179], 0
    s_waitcnt lgkmcnt(4)
    ds_read_b128 v[152:155], v25 offset:8192
    v_mfma_f32_16x16x32_bf16 v[60:63], v[156:159], v[180:183], 0
    v_mul_f32 v115, v115, v116
    v_cvt_pk_bf16_f32 v194, v112, v113
    v_cvt_pk_bf16_f32 v195, v114, v115
    v_mfma_f32_16x16x32_bf16 v[44:47], v[160:163], v[176:179], 0
    s_waitcnt lgkmcnt(4)
    ds_read_b128 v[156:159], v25 offset:9216
    v_mfma_f32_16x16x32_bf16 v[64:67], v[160:163], v[180:183], 0
    buffer_store_dwordx4 v[192:195], v11, s[28:31], s60 offen
    v_mfma_f32_16x16x32_bf16 v[48:51], v[164:167], v[176:179], 0
    s_waitcnt lgkmcnt(4)
    ds_read_b128 a[128:131], v25 offset:10240
    v_mfma_f32_16x16x32_bf16 v[68:71], v[164:167], v[180:183], 0
    buffer_load_dword v251, v250, s[20:23], s59 offen offset:0 sc1
    v_mfma_f32_16x16x32_bf16 v[32:35], v[168:171], v[184:187], v[32:35]
    s_waitcnt lgkmcnt(4)
    ds_read_b128 a[132:135], v25 offset:11264
    ds_read_b128 a[136:139], v25 offset:12288
    v_mfma_f32_16x16x32_bf16 v[52:55], v[168:171], v[188:191], v[52:55]
    v_mfma_f32_16x16x32_bf16 v[36:39], v[172:175], v[184:187], v[36:39]
    s_waitcnt lgkmcnt(5)
    ds_read_b128 a[140:143], v25 offset:13312
    ds_read_b128 a[144:147], v25 offset:14336
    v_mfma_f32_16x16x32_bf16 v[56:59], v[172:175], v[188:191], v[56:59]
    v_mfma_f32_16x16x32_bf16 v[40:43], v[148:151], v[184:187], v[40:43]
    s_waitcnt lgkmcnt(6)
    ds_read_b128 a[148:151], v25 offset:15360
    ds_read_b128 a[152:155], v25 offset:16384
    v_mfma_f32_16x16x32_bf16 v[60:63], v[148:151], v[188:191], v[60:63]
    v_mfma_f32_16x16x32_bf16 v[44:47], v[152:155], v[184:187], v[44:47]
    s_waitcnt lgkmcnt(7)
    ds_read_b128 a[156:159], v25 offset:17408
    ds_read_b128 a[160:163], v25 offset:18432
    v_mfma_f32_16x16x32_bf16 v[64:67], v[152:155], v[188:191], v[64:67]
    v_mfma_f32_16x16x32_bf16 v[48:51], v[156:159], v[184:187], v[48:51]
    s_waitcnt lgkmcnt(8)
    ds_read_b128 a[164:167], v25 offset:19456
    ds_read_b128 a[168:171], v25 offset:20480
    v_mfma_f32_16x16x32_bf16 v[68:71], v[156:159], v[188:191], v[68:71]
    s_waitcnt lgkmcnt(0)
    ds_read_b128 a[172:175], v25 offset:21504
    ds_read_b128 a[176:179], v25 offset:22528
    ds_read_b128 a[180:183], v25 offset:23552
    ds_read_b128 a[184:187], v25 offset:24576
    ds_read_b128 a[188:191], v25 offset:25600
    ds_read_b128 a[192:195], v25 offset:26624
    ds_read_b128 a[196:199], v25 offset:27648
    ds_read_b128 a[200:203], v25 offset:28672
    ds_read_b128 a[204:207], v25 offset:29696
    ds_read_b128 a[208:211], v25 offset:30720
    ds_read_b128 a[212:215], v25 offset:31744
    ds_read_b128 a[216:219], v25 offset:32768
    ds_read_b128 a[220:223], v25 offset:33792
    ds_read_b128 a[224:227], v25 offset:34816
    s_waitcnt vmcnt(1)
    buffer_store_dword v254, v255, s[20:23], s59 offen offset:32
    s_waitcnt vmcnt(1)
    v_cmp_ne_u32 vcc, s32, v251
    s_nop 3
    s_cbranch_vccnz L_f0B_retry
L_f0B_ok:
    buffer_load_dwordx4 a[16:19], v7, s[28:31], s61 offen sc1
    buffer_load_dwordx4 a[24:27], v8, s[28:31], s61 offen sc1
    buffer_load_dwordx4 a[32:35], v7, s[28:31], s62 offen sc1
    buffer_load_dwordx4 a[40:43], v8, s[28:31], s62 offen sc1
    s_barrier
    buffer_load_dword v251, v250, s[20:23], s59 offen offset:32 sc1
    buffer_load_dwordx4 a[48:51], v7, s[28:31], s63 offen sc1
    buffer_load_dwordx4 a[56:59], v8, s[28:31], s63 offen sc1
    buffer_load_dwordx4 a[64:67], v7, s[28:31], s64 offen sc1
    s_waitcnt lgkmcnt(0)
    ds_read_b128 a[228:231], v25 offset:35840
    ds_read_b128 a[232:235], v25 offset:36864
    ds_read_b128 a[236:239], v25 offset:37888
    ds_read_b128 a[240:243], v25 offset:38912
    ds_read_b128 a[244:247], v25 offset:39936
    ds_read_b128 a[248:251], v25 offset:40960
    ds_read_b128 a[252:255], v25 offset:41984
    ds_read_b128 v[72:75], v25 offset:43008
    ds_read_b128 v[76:79], v25 offset:44032
    ds_read_b128 v[80:83], v25 offset:45056
    ds_read_b128 v[84:87], v25 offset:46080
    ds_read_b128 v[88:91], v25 offset:47104
    ds_read_b128 v[92:95], v25 offset:48128
    ds_read_b128 v[96:99], v25 offset:49152
    s_waitcnt vmcnt(7)
    v_mfma_f32_16x16x32_bf16 v[32:35], a[128:131], a[16:19], v[32:35]
    v_mfma_f32_16x16x32_bf16 v[36:39], a[132:135], a[16:19], v[36:39]
    v_mfma_f32_16x16x32_bf16 v[40:43], a[136:139], a[16:19], v[40:43]
    v_mfma_f32_16x16x32_bf16 v[44:47], a[140:143], a[16:19], v[44:47]
    v_mfma_f32_16x16x32_bf16 v[48:51], a[144:147], a[16:19], v[48:51]
    s_waitcnt vmcnt(6)
    buffer_load_dwordx4 a[72:75], v8, s[28:31], s64 offen sc1
    v_mfma_f32_16x16x32_bf16 v[32:35], a[148:151], a[24:27], v[32:35]
    s_waitcnt vmcnt(4)
    v_cmp_ne_u32 vcc, s32, v251
    v_mfma_f32_16x16x32_bf16 v[36:39], a[152:155], a[24:27], v[36:39]
    v_mfma_f32_16x16x32_bf16 v[40:43], a[156:159], a[24:27], v[40:43]
    s_nop 1
    s_cbranch_vccnz L_f1B_retry
L_f1B_ok:
    v_mfma_f32_16x16x32_bf16 v[44:47], a[160:163], a[24:27], v[44:47]
    v_mfma_f32_16x16x32_bf16 v[48:51], a[164:167], a[24:27], v[48:51]
    buffer_load_dwordx4 a[80:83], v7, s[28:31], s65 offen sc1
    v_mfma_f32_16x16x32_bf16 v[32:35], a[168:171], a[32:35], v[32:35]
    v_mfma_f32_16x16x32_bf16 v[36:39], a[172:175], a[32:35], v[36:39]
    v_mfma_f32_16x16x32_bf16 v[40:43], a[176:179], a[32:35], v[40:43]
    v_mfma_f32_16x16x32_bf16 v[44:47], a[180:183], a[32:35], v[44:47]
    buffer_load_dwordx4 a[84:87], v9, s[28:31], s65 offen sc1
    v_mfma_f32_16x16x32_bf16 v[48:51], a[184:187], a[32:35], v[48:51]
    v_mfma_f32_16x16x32_bf16 v[32:35], a[188:191], a[40:43], v[32:35]
    v_mfma_f32_16x16x32_bf16 v[36:39], a[192:195], a[40:43], v[36:39]
    v_mfma_f32_16x16x32_bf16 v[40:43], a[196:199], a[40:43], v[40:43]
    v_mfma_f32_16x16x32_bf16 v[44:47], a[200:203], a[40:43], v[44:47]
    buffer_load_dwordx4 a[88:91], v8, s[28:31], s65 offen sc1
    v_mfma_f32_16x16x32_bf16 v[48:51], a[204:207], a[40:43], v[48:51]
    s_waitcnt vmcnt(6)
    v_mfma_f32_16x16x32_bf16 v[32:35], a[208:211], a[48:51], v[32:35]
    v_mfma_f32_16x16x32_bf16 v[36:39], a[212:215], a[48:51], v[36:39]
    v_mfma_f32_16x16x32_bf16 v[40:43], a[216:219], a[48:51], v[40:43]
    buffer_load_dwordx4 a[92:95], v10, s[28:31], s65 offen sc1
    v_mfma_f32_16x16x32_bf16 v[44:47], a[220:223], a[48:51], v[44:47]
    v_mfma_f32_16x16x32_bf16 v[48:51], a[224:227], a[48:51], v[48:51]
    s_waitcnt vmcnt(6) lgkmcnt(13)
    v_mfma_f32_16x16x32_bf16 v[32:35], a[228:231], a[56:59], v[32:35]
    s_waitcnt lgkmcnt(12)
    v_mfma_f32_16x16x32_bf16 v[36:39], a[232:235], a[56:59], v[36:39]
    s_waitcnt lgkmcnt(11)
    v_mfma_f32_16x16x32_bf16 v[40:43], a[236:239], a[56:59], v[40:43]
    s_waitcnt lgkmcnt(10)
    ds_read_b128 v[100:103], v25 offset:50176
    buffer_load_dwordx4 a[96:99], v7, s[28:31], s66 offen sc1
    v_mfma_f32_16x16x32_bf16 v[44:47], a[240:243], a[56:59], v[44:47]
    s_waitcnt lgkmcnt(10)
    ds_read_b128 v[160:163], v12 offset:0
    v_mfma_f32_16x16x32_bf16 v[48:51], a[244:247], a[56:59], v[48:51]
    s_waitcnt vmcnt(6) lgkmcnt(10)
    v_mfma_f32_16x16x32_bf16 v[32:35], a[248:251], a[64:67], v[32:35]
    s_waitcnt lgkmcnt(9)
    ds_read_b128 v[164:167], v12 offset:1024
    v_mfma_f32_16x16x32_bf16 v[36:39], a[252:255], a[64:67], v[36:39]
    s_waitcnt lgkmcnt(9)
    v_mfma_f32_16x16x32_bf16 v[40:43], v[72:75], a[64:67], v[40:43]
    s_waitcnt lgkmcnt(8)
    ds_read_b128 v[168:171], v12 offset:2048
    buffer_load_dwordx4 a[100:103], v9, s[28:31], s66 offen sc1
    v_mfma_f32_16x16x32_bf16 v[44:47], v[76:79], a[64:67], v[44:47]
    s_waitcnt lgkmcnt(8)
    v_mfma_f32_16x16x32_bf16 v[48:51], v[80:83], a[64:67], v[48:51]
    s_waitcnt vmcnt(6) lgkmcnt(7)
    ds_read_b128 v[172:175], v12 offset:3072
    v_mfma_f32_16x16x32_bf16 v[32:35], v[84:87], a[72:75], v[32:35]
    s_waitcnt lgkmcnt(7)
    v_mfma_f32_16x16x32_bf16 v[36:39], v[88:91], a[72:75], v[36:39]
    s_waitcnt lgkmcnt(6)
    ds_read_b128 v[148:151], v12 offset:4096
    buffer_load_dwordx4 a[104:107], v8, s[28:31], s66 offen sc1
    v_mfma_f32_16x16x32_bf16 v[40:43], v[92:95], a[72:75], v[40:43]
    s_waitcnt lgkmcnt(6)
    v_mfma_f32_16x16x32_bf16 v[44:47], v[96:99], a[72:75], v[44:47]
    s_waitcnt lgkmcnt(5)
    ds_read_b128 v[152:155], v12 offset:5120
    v_mfma_f32_16x16x32_bf16 v[48:51], v[100:103], a[72:75], v[48:51]
    s_waitcnt vmcnt(5) lgkmcnt(5)
    v_mfma_f32_16x16x32_bf16 v[32:35], v[160:163], a[80:83], v[32:35]
    s_waitcnt lgkmcnt(4)
    ds_read_b128 v[156:159], v12 offset:6144
    v_mfma_f32_16x16x32_bf16 v[52:55], v[160:163], a[84:87], v[52:55]
    buffer_load_dwordx4 a[108:111], v10, s[28:31], s66 offen sc1
    v_mfma_f32_16x16x32_bf16 v[36:39], v[164:167], a[80:83], v[36:39]
    s_waitcnt lgkmcnt(4)
    ds_read_b128 v[160:163], v12 offset:7168
    v_mfma_f32_16x16x32_bf16 v[56:59], v[164:167], a[84:87], v[56:59]
    v_mfma_f32_16x16x32_bf16 v[40:43], v[168:171], a[80:83], v[40:43]
    s_waitcnt lgkmcnt(4)
    ds_read_b128 v[164:167], v12 offset:8192
    v_mfma_f32_16x16x32_bf16 v[60:63], v[168:171], a[84:87], v[60:63]
    buffer_load_dwordx4 a[112:115], v7, s[28:31], s67 offen sc1
    v_mfma_f32_16x16x32_bf16 v[44:47], v[172:175], a[80:83], v[44:47]
    s_waitcnt lgkmcnt(4)
    ds_read_b128 v[168:171], v12 offset:9216
    v_mfma_f32_16x16x32_bf16 v[64:67], v[172:175], a[84:87], v[64:67]
    v_mfma_f32_16x16x32_bf16 v[48:51], v[148:151], a[80:83], v[48:51]
    s_waitcnt vmcnt(5) lgkmcnt(4)
    ds_read_b128 v[172:175], v12 offset:10240
    v_mfma_f32_16x16x32_bf16 v[68:71], v[148:151], a[84:87], v[68:71]
    v_mfma_f32_16x16x32_bf16 v[32:35], v[152:155], a[88:91], v[32:35]
    s_waitcnt lgkmcnt(4)
    ds_read_b128 v[148:151], v12 offset:11264
    v_mfma_f32_16x16x32_bf16 v[52:55], v[152:155], a[92:95], v[52:55]
    buffer_load_dwordx4 a[116:119], v9, s[28:31], s67 offen sc1
    v_mfma_f32_16x16x32_bf16 v[36:39], v[156:159], a[88:91], v[36:39]
    s_waitcnt lgkmcnt(4)
    ds_read_b128 v[152:155], v12 offset:12288
    v_mfma_f32_16x16x32_bf16 v[56:59], v[156:159], a[92:95], v[56:59]
    v_mfma_f32_16x16x32_bf16 v[40:43], v[160:163], a[88:91], v[40:43]
    s_waitcnt lgkmcnt(4)
    ds_read_b128 v[156:159], v12 offset:13312
    v_mfma_f32_16x16x32_bf16 v[60:63], v[160:163], a[92:95], v[60:63]
    buffer_load_dwordx4 a[120:123], v8, s[28:31], s67 offen sc1
    v_mfma_f32_16x16x32_bf16 v[44:47], v[164:167], a[88:91], v[44:47]
    s_waitcnt lgkmcnt(4)
    ds_read_b128 v[160:163], v12 offset:14336
    v_mfma_f32_16x16x32_bf16 v[64:67], v[164:167], a[92:95], v[64:67]
    v_mfma_f32_16x16x32_bf16 v[48:51], v[168:171], a[88:91], v[48:51]
    s_waitcnt vmcnt(5) lgkmcnt(4)
    ds_read_b128 v[164:167], v12 offset:15360
    v_mfma_f32_16x16x32_bf16 v[68:71], v[168:171], a[92:95], v[68:71]
    buffer_load_dwordx4 a[124:127], v10, s[28:31], s67 offen sc1
    v_mfma_f32_16x16x32_bf16 v[32:35], v[172:175], a[96:99], v[32:35]
    s_waitcnt lgkmcnt(4)
    ds_read_b128 v[168:171], v12 offset:16384
    v_mfma_f32_16x16x32_bf16 v[52:55], v[172:175], a[100:103], v[52:55]
    v_mfma_f32_16x16x32_bf16 v[36:39], v[148:151], a[96:99], v[36:39]
    s_waitcnt lgkmcnt(4)
    ds_read_b128 v[172:175], v12 offset:17408
    v_mfma_f32_16x16x32_bf16 v[56:59], v[148:151], a[100:103], v[56:59]
    v_mfma_f32_16x16x32_bf16 v[40:43], v[152:155], a[96:99], v[40:43]
    s_waitcnt lgkmcnt(4)
    ds_read_b128 v[148:151], v12 offset:18432
    v_mfma_f32_16x16x32_bf16 v[60:63], v[152:155], a[100:103], v[60:63]
    buffer_load_dwordx4 v[196:199], v11, s[28:31], s61 offen sc1
    v_mfma_f32_16x16x32_bf16 v[44:47], v[156:159], a[96:99], v[44:47]
    s_waitcnt lgkmcnt(4)
    ds_read_b128 v[152:155], v12 offset:19456
    v_mfma_f32_16x16x32_bf16 v[64:67], v[156:159], a[100:103], v[64:67]
    v_mfma_f32_16x16x32_bf16 v[48:51], v[160:163], a[96:99], v[48:51]
    s_waitcnt vmcnt(5) lgkmcnt(4)
    ds_read_b128 v[156:159], v12 offset:20480
    v_mfma_f32_16x16x32_bf16 v[68:71], v[160:163], a[100:103], v[68:71]
    buffer_load_dwordx4 v[200:203], v11, s[28:31], s62 offen sc1
    v_mfma_f32_16x16x32_bf16 v[32:35], v[164:167], a[104:107], v[32:35]
    s_waitcnt lgkmcnt(4)
    ds_read_b128 v[160:163], v12 offset:21504
    v_mfma_f32_16x16x32_bf16 v[52:55], v[164:167], a[108:111], v[52:55]
    v_mfma_f32_16x16x32_bf16 v[36:39], v[168:171], a[104:107], v[36:39]
    s_waitcnt lgkmcnt(4)
    ds_read_b128 v[164:167], v12 offset:22528
    v_mfma_f32_16x16x32_bf16 v[56:59], v[168:171], a[108:111], v[56:59]
    buffer_load_dwordx4 v[204:207], v11, s[28:31], s63 offen sc1
    v_mfma_f32_16x16x32_bf16 v[40:43], v[172:175], a[104:107], v[40:43]
    s_waitcnt lgkmcnt(4)
    ds_read_b128 v[168:171], v12 offset:23552
    v_mfma_f32_16x16x32_bf16 v[60:63], v[172:175], a[108:111], v[60:63]
    v_mfma_f32_16x16x32_bf16 v[44:47], v[148:151], a[104:107], v[44:47]
    s_waitcnt lgkmcnt(4)
    ds_read_b128 v[172:175], v12 offset:24576
    v_mfma_f32_16x16x32_bf16 v[64:67], v[148:151], a[108:111], v[64:67]
    v_mfma_f32_16x16x32_bf16 v[48:51], v[152:155], a[104:107], v[48:51]
    s_waitcnt vmcnt(5) lgkmcnt(4)
    ds_read_b128 v[148:151], v12 offset:25600
    v_mfma_f32_16x16x32_bf16 v[68:71], v[152:155], a[108:111], v[68:71]
    buffer_load_dwordx4 v[208:211], v11, s[28:31], s64 offen sc1
    v_mfma_f32_16x16x32_bf16 v[32:35], v[156:159], a[112:115], v[32:35]
    s_waitcnt lgkmcnt(4)
    ds_read_b128 v[152:155], v12 offset:26624
    v_mfma_f32_16x16x32_bf16 v[52:55], v[156:159], a[116:119], v[52:55]
    v_mfma_f32_16x16x32_bf16 v[36:39], v[160:163], a[112:115], v[36:39]
    s_waitcnt lgkmcnt(4)
    ds_read_b128 v[156:159], v12 offset:27648
    v_mfma_f32_16x16x32_bf16 v[56:59], v[160:163], a[116:119], v[56:59]
    buffer_load_dwordx4 v[212:215], v11, s[28:31], s65 offen sc1
    v_mfma_f32_16x16x32_bf16 v[40:43], v[164:167], a[112:115], v[40:43]
    s_waitcnt lgkmcnt(4)
    ds_read_b128 v[160:163], v12 offset:28672
    v_mfma_f32_16x16x32_bf16 v[60:63], v[164:167], a[116:119], v[60:63]
    v_mfma_f32_16x16x32_bf16 v[44:47], v[168:171], a[112:115], v[44:47]
    s_waitcnt lgkmcnt(4)
    ds_read_b128 v[164:167], v12 offset:29696
    v_mfma_f32_16x16x32_bf16 v[64:67], v[168:171], a[116:119], v[64:67]
    buffer_load_dwordx4 v[216:219], v11, s[28:31], s66 offen sc1
    v_mfma_f32_16x16x32_bf16 v[48:51], v[172:175], a[112:115], v[48:51]
    s_waitcnt vmcnt(6) lgkmcnt(4)
    ds_read_b128 v[168:171], v12 offset:30720
    v_mfma_f32_16x16x32_bf16 v[68:71], v[172:175], a[116:119], v[68:71]
    v_mfma_f32_16x16x32_bf16 v[32:35], v[148:151], a[120:123], v[32:35]
    s_waitcnt lgkmcnt(4)
    ds_read_b128 v[172:175], v12 offset:31744
    v_mfma_f32_16x16x32_bf16 v[52:55], v[148:151], a[124:127], v[52:55]
    buffer_load_dwordx4 v[220:223], v11, s[28:31], s67 offen sc1
    v_mfma_f32_16x16x32_bf16 v[36:39], v[152:155], a[120:123], v[36:39]
    s_waitcnt lgkmcnt(4)
    ds_read_b128 v[148:151], v12 offset:32768
    v_mfma_f32_16x16x32_bf16 v[56:59], v[152:155], a[124:127], v[56:59]
    v_mfma_f32_16x16x32_bf16 v[40:43], v[156:159], a[120:123], v[40:43]
    s_waitcnt lgkmcnt(4)
    ds_read_b128 v[152:155], v12 offset:33792
    v_mfma_f32_16x16x32_bf16 v[60:63], v[156:159], a[124:127], v[60:63]
    v_mfma_f32_16x16x32_bf16 v[44:47], v[160:163], a[120:123], v[44:47]
    s_waitcnt vmcnt(6) lgkmcnt(4)
    ds_read_b128 v[156:159], v12 offset:34816
    v_mfma_f32_16x16x32_bf16 v[64:67], v[160:163], a[124:127], v[64:67]
    v_swap_b32 v194, v196
    v_swap_b32 v195, v197
    v_mfma_f32_16x16x32_bf16 v[48:51], v[164:167], a[120:123], v[48:51]
    s_waitcnt lgkmcnt(4)
    ds_read_b128 v[160:163], v12 offset:35840
    v_mfma_f32_16x16x32_bf16 v[68:71], v[164:167], a[124:127], v[68:71]
L_hop5B:
    s_cbranch_execz L_hopretB
    buffer_load_dwordx4 a[20:23], v9, s[28:31], s61 offen sc1
    v_mfma_f32_16x16x32_bf16 v[32:35], v[168:171], v[192:195], v[32:35]
    s_waitcnt lgkmcnt(4)
    ds_read_b128 v[164:167], v12 offset:36864
    v_mfma_f32_16x16x32_bf16 v[52:55], v[168:171], v[196:199], v[52:55]
    buffer_load_dwordx4 a[28:31], v10, s[28:31], s61 offen sc1
    v_mfma_f32_16x16x32_bf16 v[36:39], v[172:175], v[192:195], v[36:39]
    s_waitcnt lgkmcnt(4)
    ds_read_b128 v[168:171], v12 offset:37888
    v_mfma_f32_16x16x32_bf16 v[56:59], v[172:175], v[196:199], v[56:59]
    v_mfma_f32_16x16x32_bf16 v[40:43], v[148:151], v[192:195], v[40:43]
    s_waitcnt lgkmcnt(4)
    ds_read_b128 v[172:175], v12 offset:38912
    v_mfma_f32_16x16x32_bf16 v[60:63], v[148:151], v[196:199], v[60:63]
    buffer_load_dwordx4 a[36:39], v9, s[28:31], s62 offen sc1
    v_mfma_f32_16x16x32_bf16 v[44:47], v[152:155], v[192:195], v[44:47]
    s_waitcnt vmcnt(7) lgkmcnt(4)
    ds_read_b128 v[148:151], v12 offset:39936
    v_mfma_f32_16x16x32_bf16 v[64:67], v[152:155], v[196:199], v[64:67]
    v_swap_b32 v202, v204
    v_swap_b32 v203, v205
    v_mfma_f32_16x16x32_bf16 v[48:51], v[156:159], v[192:195], v[48:51]
    s_waitcnt lgkmcnt(4)
    ds_read_b128 v[152:155], v12 offset:40960
    v_mfma_f32_16x16x32_bf16 v[68:71], v[156:159], v[196:199], v[68:71]
    v_mfma_f32_16x16x32_bf16 v[32:35], v[160:163], v[200:203], v[32:35]
    s_waitcnt lgkmcnt(4)
    ds_read_b128 v[156:159], v12 offset:41984
    v_mfma_f32_16x16x32_bf16 v[52:55], v[160:163], v[204:207], v[52:55]
    buffer_load_dwordx4 a[44:47], v10, s[28:31], s62 offen sc1
    v_mfma_f32_16x16x32_bf16 v[36:39], v[164:167], v[200:203], v[36:39]
    s_waitcnt lgkmcnt(4)
    ds_read_b128 v[160:163], v12 offset:43008
    v_mfma_f32_16x16x32_bf16 v[56:59], v[164:167], v[204:207], v[56:59]
    v_mfma_f32_16x16x32_bf16 v[40:43], v[168:171], v[200:203], v[40:43]
    s_waitcnt lgkmcnt(4)
    ds_read_b128 v[164:167], v12 offset:44032
    v_mfma_f32_16x16x32_bf16 v[60:63], v[168:171], v[204:207], v[60:63]
    buffer_load_dwordx4 a[52:55], v9, s[28:31], s63 offen sc1
    v_mfma_f32_16x16x32_bf16 v[44:47], v[172:175], v[200:203], v[44:47]
    s_waitcnt vmcnt(7) lgkmcnt(4)
    ds_read_b128 v[168:171], v12 offset:45056
    v_mfma_f32_16x16x32_bf16 v[64:67], v[172:175], v[204:207], v[64:67]
    v_swap_b32 v210, v212
    v_swap_b32 v211, v213
    v_mfma_f32_16x16x32_bf16 v[48:51], v[148:151], v[200:203], v[48:51]
    s_waitcnt vmcnt(5) lgkmcnt(4)
    ds_read_b128 v[172:175], v12 offset:46080
    v_mfma_f32_16x16x32_bf16 v[68:71], v[148:151], v[204:207], v[68:71]
    buffer_store_dword v254, v255, s[20:23], s59 offen offset:64
    v_mfma_f32_16x16x32_bf16 v[32:35], v[152:155], v[208:211], v[32:35]
    s_waitcnt lgkmcnt(4)
    ds_read_b128 v[148:151], v12 offset:47104
    v_mfma_f32_16x16x32_bf16 v[52:55], v[152:155], v[212:215], v[52:55]
    buffer_load_dwordx4 a[60:63], v10, s[28:31], s63 offen sc1
    v_mfma_f32_16x16x32_bf16 v[36:39], v[156:159], v[208:211], v[36:39]
    s_waitcnt lgkmcnt(4)
    ds_read_b128 v[152:155], v12 offset:48128
    v_mfma_f32_16x16x32_bf16 v[56:59], v[156:159], v[212:215], v[56:59]
    v_mfma_f32_16x16x32_bf16 v[40:43], v[160:163], v[208:211], v[40:43]
    s_waitcnt lgkmcnt(4)
    ds_read_b128 v[156:159], v12 offset:49152
    v_mfma_f32_16x16x32_bf16 v[60:63], v[160:163], v[212:215], v[60:63]
    buffer_load_dwordx4 a[68:71], v9, s[28:31], s64 offen sc1
    v_mfma_f32_16x16x32_bf16 v[44:47], v[164:167], v[208:211], v[44:47]
    s_waitcnt lgkmcnt(4)
    ds_read_b128 v[160:163], v12 offset:50176
    v_mfma_f32_16x16x32_bf16 v[64:67], v[164:167], v[212:215], v[64:67]
    v_swap_b32 v218, v220
    v_swap_b32 v219, v221
    v_mfma_f32_16x16x32_bf16 v[48:51], v[168:171], v[208:211], v[48:51]
    s_waitcnt lgkmcnt(4)
    v_mfma_f32_16x16x32_bf16 v[68:71], v[168:171], v[212:215], v[68:71]
    buffer_load_dwordx4 a[76:79], v10, s[28:31], s64 offen sc1
    v_mfma_f32_16x16x32_bf16 v[32:35], v[172:175], v[216:219], v[32:35]
    s_waitcnt lgkmcnt(3)
    v_mfma_f32_16x16x32_bf16 v[52:55], v[172:175], v[220:223], v[52:55]
    v_mfma_f32_16x16x32_bf16 v[36:39], v[148:151], v[216:219], v[36:39]
    s_waitcnt lgkmcnt(2)
    v_mfma_f32_16x16x32_bf16 v[56:59], v[148:151], v[220:223], v[56:59]
    v_mfma_f32_16x16x32_bf16 v[40:43], v[152:155], v[216:219], v[40:43]
    s_waitcnt lgkmcnt(1)
    v_mfma_f32_16x16x32_bf16 v[60:63], v[152:155], v[220:223], v[60:63]
    v_mfma_f32_16x16x32_bf16 v[44:47], v[156:159], v[216:219], v[44:47]
    s_waitcnt lgkmcnt(0)
    v_mfma_f32_16x16x32_bf16 v[64:67], v[156:159], v[220:223], v[64:67]
    v_mfma_f32_16x16x32_bf16 v[48:51], v[160:163], v[216:219], v[48:51]
    s_waitcnt vmcnt(8)
    v_mfma_f32_16x16x32_bf16 v[68:71], v[160:163], v[220:223], v[68:71]
    v_mfma_f32_16x16x32_bf16 v[52:55], a[128:131], a[20:23], v[52:55]
    buffer_load_dword v251, v250, s[20:23], s59 offen offset:64 sc1
    v_mfma_f32_16x16x32_bf16 v[56:59], a[132:135], a[20:23], v[56:59]
    v_mfma_f32_16x16x32_bf16 v[60:63], a[136:139], a[20:23], v[60:63]
    v_mfma_f32_16x16x32_bf16 v[64:67], a[140:143], a[20:23], v[64:67]
    v_cvt_pk_bf16_f32 v120, v32, v33
    v_cvt_pk_bf16_f32 v121, v34, v35
    v_mfma_f32_16x16x32_bf16 v[68:71], a[144:147], a[20:23], v[68:71]
    s_waitcnt vmcnt(8)
    ds_write_b64 v239, v[120:121] offset:0
    v_mfma_f32_16x16x32_bf16 v[52:55], a[148:151], a[28:31], v[52:55]
    v_cvt_pk_bf16_f32 v122, v36, v37
    v_cvt_pk_bf16_f32 v123, v38, v39
    v_mfma_f32_16x16x32_bf16 v[56:59], a[152:155], a[28:31], v[56:59]
    ds_write_b64 v239, v[122:123] offset:8
    v_mfma_f32_16x16x32_bf16 v[60:63], a[156:159], a[28:31], v[60:63]
    v_cvt_pk_bf16_f32 v124, v40, v41
    v_cvt_pk_bf16_f32 v125, v42, v43
    v_mfma_f32_16x16x32_bf16 v[64:67], a[160:163], a[28:31], v[64:67]
    ds_write_b64 v239, v[124:125] offset:16
    v_mfma_f32_16x16x32_bf16 v[68:71], a[164:167], a[28:31], v[68:71]
    s_waitcnt vmcnt(7)
    v_cvt_pk_bf16_f32 v126, v44, v45
    v_cvt_pk_bf16_f32 v127, v46, v47
    v_mfma_f32_16x16x32_bf16 v[52:55], a[168:171], a[36:39], v[52:55]
    ds_write_b64 v239, v[126:127] offset:24
    v_mfma_f32_16x16x32_bf16 v[56:59], a[172:175], a[36:39], v[56:59]
    v_cvt_pk_bf16_f32 v128, v48, v49
    v_cvt_pk_bf16_f32 v129, v50, v51
    v_mfma_f32_16x16x32_bf16 v[60:63], a[176:179], a[36:39], v[60:63]
    s_waitcnt vmcnt(1)
    ds_write_b64 v239, v[128:129] offset:32
    buffer_store_dword v254, v255, s[20:23], s59 offen offset:96
    v_mfma_f32_16x16x32_bf16 v[64:67], a[180:183], a[36:39], v[64:67]
    ds_read_b128 v[136:139], v240
    ds_read_b128 v[140:143], v241
    v_mfma_f32_16x16x32_bf16 v[68:71], a[184:187], a[36:39], v[68:71]
    ds_read_b128 v[144:147], v242
    v_mfma_f32_16x16x32_bf16 v[52:55], a[188:191], a[44:47], v[52:55]
    v_mfma_f32_16x16x32_bf16 v[56:59], a[192:195], a[44:47], v[56:59]
    v_mfma_f32_16x16x32_bf16 v[60:63], a[196:199], a[44:47], v[60:63]
    v_mfma_f32_16x16x32_bf16 v[64:67], a[200:203], a[44:47], v[64:67]
    v_mfma_f32_16x16x32_bf16 v[68:71], a[204:207], a[44:47], v[68:71]
    v_mfma_f32_16x16x32_bf16 v[52:55], a[208:211], a[52:55], v[52:55]
    v_mfma_f32_16x16x32_bf16 v[56:59], a[212:215], a[52:55], v[56:59]
    v_mfma_f32_16x16x32_bf16 v[60:63], a[216:219], a[52:55], v[60:63]
    s_waitcnt vmcnt(1)
    v_cmp_ne_u32 vcc, s32, v251
    v_mfma_f32_16x16x32_bf16 v[64:67], a[220:223], a[52:55], v[64:67]
    v_mfma_f32_16x16x32_bf16 v[68:71], a[224:227], a[52:55], v[68:71]
    s_nop 1
    s_cbranch_vccnz L_d0B_retry
L_d0B_ok:
    v_mfma_f32_16x16x32_bf16 v[52:55], a[228:231], a[60:63], v[52:55]
    s_waitcnt lgkmcnt(2)
    buffer_store_dwordx4 v[136:139], v245, s[24:27], s73 offen
    v_mfma_f32_16x16x32_bf16 v[52:55], a[248:251], a[68:71], v[52:55]
    v_mfma_f32_16x16x32_bf16 v[52:55], v[84:87], a[76:79], v[52:55]
    s_waitcnt lgkmcnt(1)
    buffer_store_dwordx4 v[140:143], v246, s[24:27], s73 offen
    v_mfma_f32_16x16x32_bf16 v[56:59], a[232:235], a[60:63], v[56:59]
    v_mfma_f32_16x16x32_bf16 v[56:59], a[252:255], a[68:71], v[56:59]
    s_waitcnt lgkmcnt(0)
    buffer_store_dwordx4 v[144:147], v247, s[24:27], s73 offen
    v_mfma_f32_16x16x32_bf16 v[56:59], v[88:91], a[76:79], v[56:59]
    v_mfma_f32_16x16x32_bf16 v[60:63], a[236:239], a[60:63], v[60:63]
    v_cvt_pk_bf16_f32 v120, v52, v53
    v_cvt_pk_bf16_f32 v121, v54, v55
    v_mfma_f32_16x16x32_bf16 v[60:63], v[72:75], a[68:71], v[60:63]
    ds_write_b64 v239, v[120:121] offset:0
    buffer_load_dword v251, v250, s[20:23], s59 offen offset:96 sc1
    v_mfma_f32_16x16x32_bf16 v[60:63], v[92:95], a[76:79], v[60:63]
    v_mfma_f32_16x16x32_bf16 v[64:67], a[240:243], a[60:63], v[64:67]
    v_cvt_pk_bf16_f32 v122, v56, v57
    v_cvt_pk_bf16_f32 v123, v58, v59
    v_mfma_f32_16x16x32_bf16 v[64:67], v[76:79], a[68:71], v[64:67]
    s_or_b32 s42, s4, s51
    ds_write_b64 v239, v[122:123] offset:8
    v_mfma_f32_16x16x32_bf16 v[64:67], v[96:99], a[76:79], v[64:67]
    s_cmp_lg_u32 s42, 0
    v_mfma_f32_16x16x32_bf16 v[68:71], a[244:247], a[60:63], v[68:71]
    s_cselect_b32 s42, 33554432, 0
    v_cvt_pk_bf16_f32 v124, v60, v61
    v_cvt_pk_bf16_f32 v125, v62, v63
    v_mfma_f32_16x16x32_bf16 v[68:71], v[80:83], a[68:71], v[68:71]
    ds_write_b64 v239, v[124:125] offset:16
    buffer_store_dword v254, v255, s[20:23], s42 offen offset:128 sc1
    v_mfma_f32_16x16x32_bf16 v[68:71], v[100:103], a[76:79], v[68:71]
    s_add_u32 s73, s73, 40960
    v_cvt_pk_bf16_f32 v126, v64, v65
    v_cvt_pk_bf16_f32 v127, v66, v67
    ds_write_b64 v239, v[126:127] offset:24
    s_waitcnt vmcnt(1)
    v_cmp_ne_u32 vcc, s32, v251
    s_nop 1
    v_cvt_pk_bf16_f32 v128, v68, v69
    v_cvt_pk_bf16_f32 v129, v70, v71
    ds_write_b64 v239, v[128:129] offset:32
    ds_read_b128 v[136:139], v240
    ds_read_b128 v[140:143], v241
    ds_read_b128 v[144:147], v242
    s_cbranch_vccnz L_d1B_retry
L_d1B_ok:
    s_waitcnt lgkmcnt(2)
    buffer_store_dwordx4 v[136:139], v245, s[24:27], s73 offen
    s_waitcnt lgkmcnt(1)
    buffer_store_dwordx4 v[140:143], v246, s[24:27], s73 offen
    s_waitcnt lgkmcnt(0)
    buffer_store_dwordx4 v[144:147], v247, s[24:27], s73 offen
    s_endpgm
L_xcB_retry:
    s_mov_b32 s52, 0
L_xcB_loop:
    buffer_load_dword v204, v250, s[20:23], s93 offen sc1
    s_waitcnt vmcnt(0)
    v_xor_b32 v205, s32, v204
    v_lshlrev_b32 v205, 4, v205
    v_cmp_ne_u32 vcc, 0, v205
    s_nop 3
    s_cbranch_vccz L_xcB_ok
    s_add_u32 s52, s52, 1
    s_cmp_lt_u32 s52, 100000
    s_cbranch_scc1 L_xcB_loop
    s_branch L_xcB_ok
L_pfB_retry:
    s_mov_b32 s52, 0
L_pfB_loop:
    buffer_load_dwordx2 v[206:207], v13, s[20:23], s91 offen sc1
    s_waitcnt vmcnt(0)
    v_xor_b32 v206, s32, v206
    v_bitop3_b32 v206, v206, v207, s32 bitop3:0xf6
    v_cmp_ne_u32 vcc, 0, v206
    s_nop 3
    s_cbranch_vccz L_pfB_ok
    s_add_u32 s52, s52, 1
    s_cmp_lt_u32 s52, 100000
    s_cbranch_scc1 L_pfB_loop
    s_branch L_pfB_ok
L_h1B_retry:
    s_mov_b32 s52, 0
L_h1B_loop:
    s_add_u32 s42, s69, 0
    buffer_load_dwordx4 v[120:123], v229, s[20:23], s42 offen sc1
    s_add_u32 s42, s69, 32768
    buffer_load_dwordx4 v[124:127], v229, s[20:23], s42 offen sc1
    s_waitcnt vmcnt(0)
    v_xor_b32 v120, s8, v120
    v_xor_b32 v121, s9, v121
    v_xor_b32 v122, s10, v122
    v_xor_b32 v123, s11, v123
    v_xor_b32 v124, s8, v124
    v_xor_b32 v125, s9, v125
    v_xor_b32 v126, s10, v126
    v_xor_b32 v127, s11, v127
    v_or_b32 v114, v120, v121
    v_or3_b32 v114, v114, v122, v123
    v_or3_b32 v114, v114, v124, v125
    v_or3_b32 v114, v114, v126, v127
    v_and_b32 v114, 0xff, v114
    v_cmp_ne_u32 vcc, 0, v114
    s_nop 3
    s_cbranch_vccz L_h1B_redo
    s_add_u32 s52, s52, 1
    s_cmp_lt_u32 s52, 100000
    s_cbranch_scc1 L_h1B_loop
L_h1B_redo:
    v_add_f32 v120, v120, v124
    v_add_f32 v121, v121, v125
    v_add_f32 v122, v122, v126
    v_add_f32 v123, v123, v127
    s_branch L_h1B_ok
L_h2B_retry:
    s_mov_b32 s52, 0
L_h2B_loop:
    buffer_load_dwordx4 v[208:211], v25, s[20:23], s71 offen offset:0 sc1
    buffer_load_dwordx4 v[212:215], v231, s[20:23], s71 offen offset:0 sc1
    s_waitcnt vmcnt(0)
    v_xor_b32 v204, s32, v208
    v_bitop3_b32 v204, v204, v209, s38 bitop3:0xf6
    v_bitop3_b32 v204, v204, v210, s32 bitop3:0xf6
    v_bitop3_b32 v204, v204, v211, s38 bitop3:0xf6
    v_bitop3_b32 v204, v204, v212, s32 bitop3:0xf6
    v_bitop3_b32 v204, v204, v213, s38 bitop3:0xf6
    v_bitop3_b32 v204, v204, v214, s32 bitop3:0xf6
    v_bitop3_b32 v204, v204, v215, s38 bitop3:0xf6
    v_and_b32 v204, 0xffff, v204
    v_cmp_ne_u32 vcc, 0, v204
    s_nop 3
    s_cbranch_vccz L_h2B_redo
    s_add_u32 s52, s52, 1
    s_cmp_lt_u32 s52, 100000
    s_cbranch_scc1 L_h2B_loop
L_h2B_redo:
    v_perm_b32 v120, v209, v208, s75
    v_perm_b32 v121, v211, v210, s75
    ds_write_b64 v232, v[120:121]
    v_perm_b32 v122, v213, v212, s75
    v_perm_b32 v123, v215, v214, s75
    ds_write_b64 v233, v[122:123]
    s_branch L_h2B_ok
L_f0Bs_retry:
    s_mov_b32 s52, 0
L_f0Bs_loop:
    buffer_load_dword v251, v250, s[20:23], s59 offen offset:0 sc1
    s_waitcnt vmcnt(0)
    v_cmp_ne_u32 vcc, s32, v251
    s_nop 3
    s_cbranch_vccz L_f0Bs_ok
    s_add_u32 s52, s52, 1
    s_cmp_lt_u32 s52, 100000
    s_cbranch_scc1 L_f0Bs_loop
    s_branch L_f0Bs_ok
L_f1Bs_retry:
    s_mov_b32 s52, 0
L_f1Bs_loop:
    buffer_load_dword v251, v250, s[20:23], s59 offen offset:32 sc1
    s_waitcnt vmcnt(0)
    v_cmp_ne_u32 vcc, s32, v251
    s_nop 3
    s_cbranch_vccz L_f1Bs_ok
    s_add_u32 s52, s52, 1
    s_cmp_lt_u32 s52, 100000
    s_cbranch_scc1 L_f1Bs_loop
    s_branch L_f1Bs_ok
L_d0Bs_retry:
    s_mov_b32 s52, 0
L_d0Bs_loop:
    buffer_load_dword v251, v250, s[20:23], s59 offen offset:64 sc1
    s_waitcnt vmcnt(0)
    v_cmp_ne_u32 vcc, s32, v251
    s_nop 3
    s_cbranch_vccz L_d0Bs_ok
    s_add_u32 s52, s52, 1
    s_cmp_lt_u32 s52, 100000
    s_cbranch_scc1 L_d0Bs_loop
    s_branch L_d0Bs_ok
L_d1Bs_retry:
    s_mov_b32 s52, 0
L_d1Bs_loop:
    buffer_load_dword v251, v250, s[20:23], s59 offen offset:96 sc1
    s_waitcnt vmcnt(0)
    v_cmp_ne_u32 vcc, s32, v251
    s_nop 3
    s_cbranch_vccz L_d1Bs_ok
    s_add_u32 s52, s52, 1
    s_cmp_lt_u32 s52, 100000
    s_cbranch_scc1 L_d1Bs_loop
    s_branch L_d1Bs_ok
L_tailBs:
    ds_read_b128 a[40:43], v236 offset:960
    ds_read_b128 a[44:47], v236 offset:976
    ds_read_b64 a[48:49], v236 offset:992
    ds_read_b128 a[52:55], v236 offset:0
    ds_read_b128 a[56:59], v236 offset:16
    ds_read_b64 a[60:61], v236 offset:32
    ds_read_b128 a[64:67], v236 offset:192
    ds_read_b128 a[68:71], v236 offset:208
    ds_read_b64 a[72:73], v236 offset:224
    ds_read_b128 a[76:79], v236 offset:384
    s_waitcnt lgkmcnt(9)
    v_mfma_f32_16x16x32_bf16 v[92:95], a[40:43], v[32:35], 0
    s_waitcnt lgkmcnt(8)
    ds_read_b128 a[80:83], v236 offset:400
    v_mfma_f32_16x16x32_bf16 v[92:95], a[44:47], v[36:39], v[92:95]
    s_waitcnt lgkmcnt(8)
    ds_read_b64 a[84:85], v236 offset:416
    v_mfma_f32_16x16x32_bf16 v[92:95], a[48:51], v[40:43], v[92:95]
    s_waitcnt lgkmcnt(8)
    ds_read_b128 a[88:91], v236 offset:576
    v_mfma_f32_16x16x32_bf16 v[72:75], a[52:55], v[32:35], 0
    s_waitcnt lgkmcnt(8)
    ds_read_b128 a[92:95], v236 offset:592
    v_mfma_f32_16x16x32_bf16 v[72:75], a[56:59], v[36:39], v[72:75]
    s_waitcnt lgkmcnt(8)
    ds_read_b64 a[96:97], v236 offset:608
    v_mfma_f32_16x16x32_bf16 v[72:75], a[60:63], v[40:43], v[72:75]
    s_waitcnt lgkmcnt(8)
    ds_read_b128 a[100:103], v236 offset:768
    v_mfma_f32_16x16x32_bf16 v[76:79], a[64:67], v[32:35], 0
    s_waitcnt lgkmcnt(8)
    ds_read_b128 a[104:107], v236 offset:784
    v_add_f32 v92, 0x358637bd, v92
    v_mfma_f32_16x16x32_bf16 v[76:79], a[68:71], v[36:39], v[76:79]
    s_waitcnt lgkmcnt(8)
    ds_read_b64 a[108:109], v236 offset:800
    v_rcp_f32 v92, v92
    v_mfma_f32_16x16x32_bf16 v[76:79], a[72:75], v[40:43], v[76:79]
    s_waitcnt lgkmcnt(8)
    ds_read_b128 v[148:151], v25 offset:0
    v_mfma_f32_16x16x32_bf16 v[80:83], a[76:79], v[32:35], 0
    s_waitcnt lgkmcnt(8)
    v_mul_f32 v72, v72, v92
    v_mul_f32 v73, v73, v92
    v_mul_f32 v74, v74, v92
    v_mfma_f32_16x16x32_bf16 v[80:83], a[80:83], v[36:39], v[80:83]
    s_waitcnt lgkmcnt(7)
    v_mul_f32 v75, v75, v92
    v_cvt_pk_bf16_f32 v176, v72, v73
    v_cvt_pk_bf16_f32 v177, v74, v75
    v_mfma_f32_16x16x32_bf16 v[80:83], a[84:87], v[40:43], v[80:83]
    s_waitcnt lgkmcnt(6)
    ds_read_b128 v[152:155], v25 offset:1024
    v_mfma_f32_16x16x32_bf16 v[84:87], a[88:91], v[32:35], 0
    s_waitcnt lgkmcnt(6)
    v_mul_f32 v76, v76, v92
    v_mul_f32 v77, v77, v92
    v_mul_f32 v78, v78, v92
    v_mfma_f32_16x16x32_bf16 v[84:87], a[92:95], v[36:39], v[84:87]
    s_waitcnt lgkmcnt(5)
    v_mul_f32 v79, v79, v92
    v_cvt_pk_bf16_f32 v178, v76, v77
    v_cvt_pk_bf16_f32 v179, v78, v79
    v_mfma_f32_16x16x32_bf16 v[84:87], a[96:99], v[40:43], v[84:87]
    s_waitcnt lgkmcnt(4)
    buffer_store_dwordx4 v[176:179], v7, s[28:31], s60 offen sc1
    v_mfma_f32_16x16x32_bf16 v[116:119], a[40:43], v[52:55], 0
    v_mul_f32 v80, v80, v92
    v_mul_f32 v81, v81, v92
    v_mul_f32 v82, v82, v92
    v_mfma_f32_16x16x32_bf16 v[116:119], a[44:47], v[56:59], v[116:119]
    v_mul_f32 v83, v83, v92
    v_cvt_pk_bf16_f32 v184, v80, v81
    v_cvt_pk_bf16_f32 v185, v82, v83
    v_mfma_f32_16x16x32_bf16 v[116:119], a[48:51], v[60:63], v[116:119]
    ds_read_b128 v[156:159], v25 offset:2048
    v_mfma_f32_16x16x32_bf16 v[96:99], a[52:55], v[52:55], 0
    v_mul_f32 v84, v84, v92
    v_mul_f32 v85, v85, v92
    v_mul_f32 v86, v86, v92
    v_mfma_f32_16x16x32_bf16 v[96:99], a[56:59], v[56:59], v[96:99]
    v_mul_f32 v87, v87, v92
    v_cvt_pk_bf16_f32 v186, v84, v85
    v_cvt_pk_bf16_f32 v187, v86, v87
    v_mfma_f32_16x16x32_bf16 v[96:99], a[60:63], v[60:63], v[96:99]
    buffer_store_dwordx4 v[184:187], v8, s[28:31], s60 offen sc1
    v_mfma_f32_16x16x32_bf16 v[100:103], a[64:67], v[52:55], 0
    v_add_f32 v116, 0x358637bd, v116
    v_rcp_f32 v116, v116
    v_mfma_f32_16x16x32_bf16 v[100:103], a[68:71], v[56:59], v[100:103]
    ds_read_b128 v[160:163], v25 offset:3072
    v_mfma_f32_16x16x32_bf16 v[100:103], a[72:75], v[60:63], v[100:103]
    ds_read_b128 v[164:167], v25 offset:4096
    v_mfma_f32_16x16x32_bf16 v[104:107], a[76:79], v[52:55], 0
    v_mul_f32 v96, v96, v116
    v_mul_f32 v97, v97, v116
    v_mul_f32 v98, v98, v116
    v_mfma_f32_16x16x32_bf16 v[104:107], a[80:83], v[56:59], v[104:107]
    v_mul_f32 v99, v99, v116
    v_cvt_pk_bf16_f32 v180, v96, v97
    v_cvt_pk_bf16_f32 v181, v98, v99
    v_mfma_f32_16x16x32_bf16 v[104:107], a[84:87], v[60:63], v[104:107]
    ds_read_b128 v[168:171], v25 offset:5120
    v_mfma_f32_16x16x32_bf16 v[108:111], a[88:91], v[52:55], 0
    v_mul_f32 v100, v100, v116
    v_mul_f32 v101, v101, v116
    v_mul_f32 v102, v102, v116
    v_mfma_f32_16x16x32_bf16 v[108:111], a[92:95], v[56:59], v[108:111]
    v_mul_f32 v103, v103, v116
    v_cvt_pk_bf16_f32 v182, v100, v101
    v_cvt_pk_bf16_f32 v183, v102, v103
    v_mfma_f32_16x16x32_bf16 v[108:111], a[96:99], v[60:63], v[108:111]
    buffer_store_dwordx4 v[180:183], v9, s[28:31], s60 offen sc1
    v_mfma_f32_16x16x32_bf16 v[88:91], a[100:103], v[32:35], 0
    s_waitcnt lgkmcnt(7)
    v_mul_f32 v104, v104, v116
    v_mul_f32 v105, v105, v116
    v_mul_f32 v106, v106, v116
    v_mfma_f32_16x16x32_bf16 v[88:91], a[104:107], v[36:39], v[88:91]
    s_waitcnt lgkmcnt(6)
    v_mul_f32 v107, v107, v116
    v_cvt_pk_bf16_f32 v188, v104, v105
    v_cvt_pk_bf16_f32 v189, v106, v107
    v_mfma_f32_16x16x32_bf16 v[88:91], a[108:111], v[40:43], v[88:91]
    v_mfma_f32_16x16x32_bf16 v[112:115], a[100:103], v[52:55], 0
    v_mul_f32 v108, v108, v116
    v_mul_f32 v109, v109, v116
    v_mul_f32 v110, v110, v116
    v_mfma_f32_16x16x32_bf16 v[112:115], a[104:107], v[56:59], v[112:115]
    v_mul_f32 v111, v111, v116
    v_cvt_pk_bf16_f32 v190, v108, v109
    v_cvt_pk_bf16_f32 v191, v110, v111
    v_mfma_f32_16x16x32_bf16 v[112:115], a[108:111], v[60:63], v[112:115]
    s_waitcnt vmcnt(1)
    buffer_store_dword v254, v255, s[20:23], s59 offen offset:0 sc1
    buffer_store_dwordx4 v[188:191], v10, s[28:31], s60 offen sc1
    v_mul_f32 v88, v88, v92
    v_mul_f32 v89, v89, v92
    v_mul_f32 v90, v90, v92
    v_mul_f32 v91, v91, v92
    v_cvt_pk_bf16_f32 v192, v88, v89
    v_cvt_pk_bf16_f32 v193, v90, v91
    s_waitcnt lgkmcnt(5)
    v_mfma_f32_16x16x32_bf16 v[32:35], v[148:151], v[176:179], 0
    s_waitcnt lgkmcnt(4)
    ds_read_b128 v[172:175], v25 offset:6144
    v_mfma_f32_16x16x32_bf16 v[52:55], v[148:151], v[180:183], 0
    v_mfma_f32_16x16x32_bf16 v[36:39], v[152:155], v[176:179], 0
    s_waitcnt lgkmcnt(4)
    ds_read_b128 v[148:151], v25 offset:7168
    v_mfma_f32_16x16x32_bf16 v[56:59], v[152:155], v[180:183], 0
    v_mul_f32 v112, v112, v116
    v_mul_f32 v113, v113, v116
    v_mul_f32 v114, v114, v116
    v_mfma_f32_16x16x32_bf16 v[40:43], v[156:159], v[176:179], 0
    s_waitcnt lgkmcnt(4)
    ds_read_b128 v[152:155], v25 offset:8192
    v_mfma_f32_16x16x32_bf16 v[60:63], v[156:159], v[180:183], 0
    v_mul_f32 v115, v115, v116
    v_cvt_pk_bf16_f32 v194, v112, v113
    v_cvt_pk_bf16_f32 v195, v114, v115
    v_mfma_f32_16x16x32_bf16 v[44:47], v[160:163], v[176:179], 0
    s_waitcnt lgkmcnt(4)
    ds_read_b128 v[156:159], v25 offset:9216
    v_mfma_f32_16x16x32_bf16 v[64:67], v[160:163], v[180:183], 0
    buffer_store_dwordx4 v[192:195], v11, s[28:31], s60 offen sc1
    v_mfma_f32_16x16x32_bf16 v[48:51], v[164:167], v[176:179], 0
    s_waitcnt lgkmcnt(4)
    ds_read_b128 a[128:131], v25 offset:10240
    v_mfma_f32_16x16x32_bf16 v[68:71], v[164:167], v[180:183], 0
    buffer_load_dword v251, v250, s[20:23], s59 offen offset:0 sc1
    v_mfma_f32_16x16x32_bf16 v[32:35], v[168:171], v[184:187], v[32:35]
    s_waitcnt lgkmcnt(4)
    ds_read_b128 a[132:135], v25 offset:11264
    ds_read_b128 a[136:139], v25 offset:12288
    v_mfma_f32_16x16x32_bf16 v[52:55], v[168:171], v[188:191], v[52:55]
    v_mfma_f32_16x16x32_bf16 v[36:39], v[172:175], v[184:187], v[36:39]
    s_waitcnt lgkmcnt(5)
    ds_read_b128 a[140:143], v25 offset:13312
    ds_read_b128 a[144:147], v25 offset:14336
    v_mfma_f32_16x16x32_bf16 v[56:59], v[172:175], v[188:191], v[56:59]
    v_mfma_f32_16x16x32_bf16 v[40:43], v[148:151], v[184:187], v[40:43]
    s_waitcnt lgkmcnt(6)
    ds_read_b128 a[148:151], v25 offset:15360
    ds_read_b128 a[152:155], v25 offset:16384
    v_mfma_f32_16x16x32_bf16 v[60:63], v[148:151], v[188:191], v[60:63]
    v_mfma_f32_16x16x32_bf16 v[44:47], v[152:155], v[184:187], v[44:47]
    s_waitcnt lgkmcnt(7)
    ds_read_b128 a[156:159], v25 offset:17408
    ds_read_b128 a[160:163], v25 offset:18432
    v_mfma_f32_16x16x32_bf16 v[64:67], v[152:155], v[188:191], v[64:67]
    v_mfma_f32_16x16x32_bf16 v[48:51], v[156:159], v[184:187], v[48:51]
    s_waitcnt lgkmcnt(8)
    ds_read_b128 a[164:167], v25 offset:19456
    ds_read_b128 a[168:171], v25 offset:20480
    v_mfma_f32_16x16x32_bf16 v[68:71], v[156:159], v[188:191], v[68:71]
    s_waitcnt lgkmcnt(0)
    ds_read_b128 a[172:175], v25 offset:21504
    ds_read_b128 a[176:179], v25 offset:22528
    ds_read_b128 a[180:183], v25 offset:23552
    ds_read_b128 a[184:187], v25 offset:24576
    ds_read_b128 a[188:191], v25 offset:25600
    ds_read_b128 a[192:195], v25 offset:26624
    ds_read_b128 a[196:199], v25 offset:27648
    ds_read_b128 a[200:203], v25 offset:28672
    ds_read_b128 a[204:207], v25 offset:29696
    ds_read_b128 a[208:211], v25 offset:30720
    ds_read_b128 a[212:215], v25 offset:31744
    ds_read_b128 a[216:219], v25 offset:32768
    ds_read_b128 a[220:223], v25 offset:33792
    ds_read_b128 a[224:227], v25 offset:34816
    s_waitcnt vmcnt(1)
    buffer_store_dword v254, v255, s[20:23], s59 offen offset:32 sc1
    s_waitcnt vmcnt(1)
    v_cmp_ne_u32 vcc, s32, v251
    s_nop 3
    s_cbranch_vccnz L_f0Bs_retry
L_f0Bs_ok:
    buffer_load_dwordx4 a[16:19], v7, s[28:31], s61 offen sc1
    buffer_load_dwordx4 a[24:27], v8, s[28:31], s61 offen sc1
    buffer_load_dwordx4 a[32:35], v7, s[28:31], s62 offen sc1
    buffer_load_dwordx4 a[40:43], v8, s[28:31], s62 offen sc1
    s_barrier
    buffer_load_dword v251, v250, s[20:23], s59 offen offset:32 sc1
    buffer_load_dwordx4 a[48:51], v7, s[28:31], s63 offen sc1
    buffer_load_dwordx4 a[56:59], v8, s[28:31], s63 offen sc1
    buffer_load_dwordx4 a[64:67], v7, s[28:31], s64 offen sc1
    s_waitcnt lgkmcnt(0)
    ds_read_b128 a[228:231], v25 offset:35840
    ds_read_b128 a[232:235], v25 offset:36864
    ds_read_b128 a[236:239], v25 offset:37888
    ds_read_b128 a[240:243], v25 offset:38912
    ds_read_b128 a[244:247], v25 offset:39936
    ds_read_b128 a[248:251], v25 offset:40960
    ds_read_b128 a[252:255], v25 offset:41984
    ds_read_b128 v[72:75], v25 offset:43008
    ds_read_b128 v[76:79], v25 offset:44032
    ds_read_b128 v[80:83], v25 offset:45056
    ds_read_b128 v[84:87], v25 offset:46080
    ds_read_b128 v[88:91], v25 offset:47104
    ds_read_b128 v[92:95], v25 offset:48128
    ds_read_b128 v[96:99], v25 offset:49152
    s_waitcnt vmcnt(7)
    v_mfma_f32_16x16x32_bf16 v[32:35], a[128:131], a[16:19], v[32:35]
    v_mfma_f32_16x16x32_bf16 v[36:39], a[132:135], a[16:19], v[36:39]
    v_mfma_f32_16x16x32_bf16 v[40:43], a[136:139], a[16:19], v[40:43]
    v_mfma_f32_16x16x32_bf16 v[44:47], a[140:143], a[16:19], v[44:47]
    v_mfma_f32_16x16x32_bf16 v[48:51], a[144:147], a[16:19], v[48:51]
    s_waitcnt vmcnt(6)
    buffer_load_dwordx4 a[72:75], v8, s[28:31], s64 offen sc1
    v_mfma_f32_16x16x32_bf16 v[32:35], a[148:151], a[24:27], v[32:35]
    s_waitcnt vmcnt(4)
    v_cmp_ne_u32 vcc, s32, v251
    v_mfma_f32_16x16x32_bf16 v[36:39], a[152:155], a[24:27], v[36:39]
    v_mfma_f32_16x16x32_bf16 v[40:43], a[156:159], a[24:27], v[40:43]
    s_nop 1
    s_cbranch_vccnz L_f1Bs_retry
L_f1Bs_ok:
    v_mfma_f32_16x16x32_bf16 v[44:47], a[160:163], a[24:27], v[44:47]
    v_mfma_f32_16x16x32_bf16 v[48:51], a[164:167], a[24:27], v[48:51]
    buffer_load_dwordx4 a[80:83], v7, s[28:31], s65 offen sc1
    v_mfma_f32_16x16x32_bf16 v[32:35], a[168:171], a[32:35], v[32:35]
    v_mfma_f32_16x16x32_bf16 v[36:39], a[172:175], a[32:35], v[36:39]
    v_mfma_f32_16x16x32_bf16 v[40:43], a[176:179], a[32:35], v[40:43]
    v_mfma_f32_16x16x32_bf16 v[44:47], a[180:183], a[32:35], v[44:47]
    buffer_load_dwordx4 a[84:87], v9, s[28:31], s65 offen sc1
    v_mfma_f32_16x16x32_bf16 v[48:51], a[184:187], a[32:35], v[48:51]
    v_mfma_f32_16x16x32_bf16 v[32:35], a[188:191], a[40:43], v[32:35]
    v_mfma_f32_16x16x32_bf16 v[36:39], a[192:195], a[40:43], v[36:39]
    v_mfma_f32_16x16x32_bf16 v[40:43], a[196:199], a[40:43], v[40:43]
    v_mfma_f32_16x16x32_bf16 v[44:47], a[200:203], a[40:43], v[44:47]
    buffer_load_dwordx4 a[88:91], v8, s[28:31], s65 offen sc1
    v_mfma_f32_16x16x32_bf16 v[48:51], a[204:207], a[40:43], v[48:51]
    s_waitcnt vmcnt(6)
    v_mfma_f32_16x16x32_bf16 v[32:35], a[208:211], a[48:51], v[32:35]
    v_mfma_f32_16x16x32_bf16 v[36:39], a[212:215], a[48:51], v[36:39]
    v_mfma_f32_16x16x32_bf16 v[40:43], a[216:219], a[48:51], v[40:43]
    buffer_load_dwordx4 a[92:95], v10, s[28:31], s65 offen sc1
    v_mfma_f32_16x16x32_bf16 v[44:47], a[220:223], a[48:51], v[44:47]
    v_mfma_f32_16x16x32_bf16 v[48:51], a[224:227], a[48:51], v[48:51]
    s_waitcnt vmcnt(6) lgkmcnt(13)
    v_mfma_f32_16x16x32_bf16 v[32:35], a[228:231], a[56:59], v[32:35]
    s_waitcnt lgkmcnt(12)
    v_mfma_f32_16x16x32_bf16 v[36:39], a[232:235], a[56:59], v[36:39]
    s_waitcnt lgkmcnt(11)
    v_mfma_f32_16x16x32_bf16 v[40:43], a[236:239], a[56:59], v[40:43]
    s_waitcnt lgkmcnt(10)
    ds_read_b128 v[100:103], v25 offset:50176
    buffer_load_dwordx4 a[96:99], v7, s[28:31], s66 offen sc1
    v_mfma_f32_16x16x32_bf16 v[44:47], a[240:243], a[56:59], v[44:47]
    s_waitcnt lgkmcnt(10)
    ds_read_b128 v[160:163], v12 offset:0
    v_mfma_f32_16x16x32_bf16 v[48:51], a[244:247], a[56:59], v[48:51]
    s_waitcnt vmcnt(6) lgkmcnt(10)
    v_mfma_f32_16x16x32_bf16 v[32:35], a[248:251], a[64:67], v[32:35]
    s_waitcnt lgkmcnt(9)
    ds_read_b128 v[164:167], v12 offset:1024
    v_mfma_f32_16x16x32_bf16 v[36:39], a[252:255], a[64:67], v[36:39]
    s_waitcnt lgkmcnt(9)
    v_mfma_f32_16x16x32_bf16 v[40:43], v[72:75], a[64:67], v[40:43]
    s_waitcnt lgkmcnt(8)
    ds_read_b128 v[168:171], v12 offset:2048
    buffer_load_dwordx4 a[100:103], v9, s[28:31], s66 offen sc1
    v_mfma_f32_16x16x32_bf16 v[44:47], v[76:79], a[64:67], v[44:47]
    s_waitcnt lgkmcnt(8)
    v_mfma_f32_16x16x32_bf16 v[48:51], v[80:83], a[64:67], v[48:51]
    s_waitcnt vmcnt(6) lgkmcnt(7)
    ds_read_b128 v[172:175], v12 offset:3072
    v_mfma_f32_16x16x32_bf16 v[32:35], v[84:87], a[72:75], v[32:35]
    s_waitcnt lgkmcnt(7)
    v_mfma_f32_16x16x32_bf16 v[36:39], v[88:91], a[72:75], v[36:39]
    s_waitcnt lgkmcnt(6)
    ds_read_b128 v[148:151], v12 offset:4096
    buffer_load_dwordx4 a[104:107], v8, s[28:31], s66 offen sc1
    v_mfma_f32_16x16x32_bf16 v[40:43], v[92:95], a[72:75], v[40:43]
    s_waitcnt lgkmcnt(6)
    v_mfma_f32_16x16x32_bf16 v[44:47], v[96:99], a[72:75], v[44:47]
    s_waitcnt lgkmcnt(5)
    ds_read_b128 v[152:155], v12 offset:5120
    v_mfma_f32_16x16x32_bf16 v[48:51], v[100:103], a[72:75], v[48:51]
    s_waitcnt vmcnt(5) lgkmcnt(5)
    v_mfma_f32_16x16x32_bf16 v[32:35], v[160:163], a[80:83], v[32:35]
    s_waitcnt lgkmcnt(4)
    ds_read_b128 v[156:159], v12 offset:6144
    v_mfma_f32_16x16x32_bf16 v[52:55], v[160:163], a[84:87], v[52:55]
    buffer_load_dwordx4 a[108:111], v10, s[28:31], s66 offen sc1
    v_mfma_f32_16x16x32_bf16 v[36:39], v[164:167], a[80:83], v[36:39]
    s_waitcnt lgkmcnt(4)
    ds_read_b128 v[160:163], v12 offset:7168
    v_mfma_f32_16x16x32_bf16 v[56:59], v[164:167], a[84:87], v[56:59]
    v_mfma_f32_16x16x32_bf16 v[40:43], v[168:171], a[80:83], v[40:43]
    s_waitcnt lgkmcnt(4)
    ds_read_b128 v[164:167], v12 offset:8192
    v_mfma_f32_16x16x32_bf16 v[60:63], v[168:171], a[84:87], v[60:63]
    buffer_load_dwordx4 a[112:115], v7, s[28:31], s67 offen sc1
    v_mfma_f32_16x16x32_bf16 v[44:47], v[172:175], a[80:83], v[44:47]
    s_waitcnt lgkmcnt(4)
    ds_read_b128 v[168:171], v12 offset:9216
    v_mfma_f32_16x16x32_bf16 v[64:67], v[172:175], a[84:87], v[64:67]
    v_mfma_f32_16x16x32_bf16 v[48:51], v[148:151], a[80:83], v[48:51]
    s_waitcnt vmcnt(5) lgkmcnt(4)
    ds_read_b128 v[172:175], v12 offset:10240
    v_mfma_f32_16x16x32_bf16 v[68:71], v[148:151], a[84:87], v[68:71]
    v_mfma_f32_16x16x32_bf16 v[32:35], v[152:155], a[88:91], v[32:35]
    s_waitcnt lgkmcnt(4)
    ds_read_b128 v[148:151], v12 offset:11264
    v_mfma_f32_16x16x32_bf16 v[52:55], v[152:155], a[92:95], v[52:55]
    buffer_load_dwordx4 a[116:119], v9, s[28:31], s67 offen sc1
    v_mfma_f32_16x16x32_bf16 v[36:39], v[156:159], a[88:91], v[36:39]
    s_waitcnt lgkmcnt(4)
    ds_read_b128 v[152:155], v12 offset:12288
    v_mfma_f32_16x16x32_bf16 v[56:59], v[156:159], a[92:95], v[56:59]
    v_mfma_f32_16x16x32_bf16 v[40:43], v[160:163], a[88:91], v[40:43]
    s_waitcnt lgkmcnt(4)
    ds_read_b128 v[156:159], v12 offset:13312
    v_mfma_f32_16x16x32_bf16 v[60:63], v[160:163], a[92:95], v[60:63]
    buffer_load_dwordx4 a[120:123], v8, s[28:31], s67 offen sc1
    v_mfma_f32_16x16x32_bf16 v[44:47], v[164:167], a[88:91], v[44:47]
    s_waitcnt lgkmcnt(4)
    ds_read_b128 v[160:163], v12 offset:14336
    v_mfma_f32_16x16x32_bf16 v[64:67], v[164:167], a[92:95], v[64:67]
    v_mfma_f32_16x16x32_bf16 v[48:51], v[168:171], a[88:91], v[48:51]
    s_waitcnt vmcnt(5) lgkmcnt(4)
    ds_read_b128 v[164:167], v12 offset:15360
    v_mfma_f32_16x16x32_bf16 v[68:71], v[168:171], a[92:95], v[68:71]
    buffer_load_dwordx4 a[124:127], v10, s[28:31], s67 offen sc1
    v_mfma_f32_16x16x32_bf16 v[32:35], v[172:175], a[96:99], v[32:35]
    s_waitcnt lgkmcnt(4)
    ds_read_b128 v[168:171], v12 offset:16384
    v_mfma_f32_16x16x32_bf16 v[52:55], v[172:175], a[100:103], v[52:55]
    v_mfma_f32_16x16x32_bf16 v[36:39], v[148:151], a[96:99], v[36:39]
    s_waitcnt lgkmcnt(4)
    ds_read_b128 v[172:175], v12 offset:17408
    v_mfma_f32_16x16x32_bf16 v[56:59], v[148:151], a[100:103], v[56:59]
    v_mfma_f32_16x16x32_bf16 v[40:43], v[152:155], a[96:99], v[40:43]
    s_waitcnt lgkmcnt(4)
    ds_read_b128 v[148:151], v12 offset:18432
    v_mfma_f32_16x16x32_bf16 v[60:63], v[152:155], a[100:103], v[60:63]
    buffer_load_dwordx4 v[196:199], v11, s[28:31], s61 offen sc1
    v_mfma_f32_16x16x32_bf16 v[44:47], v[156:159], a[96:99], v[44:47]
    s_waitcnt lgkmcnt(4)
    ds_read_b128 v[152:155], v12 offset:19456
    v_mfma_f32_16x16x32_bf16 v[64:67], v[156:159], a[100:103], v[64:67]
    v_mfma_f32_16x16x32_bf16 v[48:51], v[160:163], a[96:99], v[48:51]
    s_waitcnt vmcnt(5) lgkmcnt(4)
    ds_read_b128 v[156:159], v12 offset:20480
    v_mfma_f32_16x16x32_bf16 v[68:71], v[160:163], a[100:103], v[68:71]
    buffer_load_dwordx4 v[200:203], v11, s[28:31], s62 offen sc1
    v_mfma_f32_16x16x32_bf16 v[32:35], v[164:167], a[104:107], v[32:35]
    s_waitcnt lgkmcnt(4)
    ds_read_b128 v[160:163], v12 offset:21504
    v_mfma_f32_16x16x32_bf16 v[52:55], v[164:167], a[108:111], v[52:55]
    v_mfma_f32_16x16x32_bf16 v[36:39], v[168:171], a[104:107], v[36:39]
    s_waitcnt lgkmcnt(4)
    ds_read_b128 v[164:167], v12 offset:22528
    v_mfma_f32_16x16x32_bf16 v[56:59], v[168:171], a[108:111], v[56:59]
    buffer_load_dwordx4 v[204:207], v11, s[28:31], s63 offen sc1
    v_mfma_f32_16x16x32_bf16 v[40:43], v[172:175], a[104:107], v[40:43]
    s_waitcnt lgkmcnt(4)
    ds_read_b128 v[168:171], v12 offset:23552
    v_mfma_f32_16x16x32_bf16 v[60:63], v[172:175], a[108:111], v[60:63]
    v_mfma_f32_16x16x32_bf16 v[44:47], v[148:151], a[104:107], v[44:47]
    s_waitcnt lgkmcnt(4)
    ds_read_b128 v[172:175], v12 offset:24576
    v_mfma_f32_16x16x32_bf16 v[64:67], v[148:151], a[108:111], v[64:67]
    v_mfma_f32_16x16x32_bf16 v[48:51], v[152:155], a[104:107], v[48:51]
    s_waitcnt vmcnt(5) lgkmcnt(4)
    ds_read_b128 v[148:151], v12 offset:25600
    v_mfma_f32_16x16x32_bf16 v[68:71], v[152:155], a[108:111], v[68:71]
    buffer_load_dwordx4 v[208:211], v11, s[28:31], s64 offen sc1
    v_mfma_f32_16x16x32_bf16 v[32:35], v[156:159], a[112:115], v[32:35]
    s_waitcnt lgkmcnt(4)
    ds_read_b128 v[152:155], v12 offset:26624
    v_mfma_f32_16x16x32_bf16 v[52:55], v[156:159], a[116:119], v[52:55]
    v_mfma_f32_16x16x32_bf16 v[36:39], v[160:163], a[112:115], v[36:39]
    s_waitcnt lgkmcnt(4)
    ds_read_b128 v[156:159], v12 offset:27648
    v_mfma_f32_16x16x32_bf16 v[56:59], v[160:163], a[116:119], v[56:59]
    buffer_load_dwordx4 v[212:215], v11, s[28:31], s65 offen sc1
    v_mfma_f32_16x16x32_bf16 v[40:43], v[164:167], a[112:115], v[40:43]
    s_waitcnt lgkmcnt(4)
    ds_read_b128 v[160:163], v12 offset:28672
    v_mfma_f32_16x16x32_bf16 v[60:63], v[164:167], a[116:119], v[60:63]
    v_mfma_f32_16x16x32_bf16 v[44:47], v[168:171], a[112:115], v[44:47]
    s_waitcnt lgkmcnt(4)
    ds_read_b128 v[164:167], v12 offset:29696
    v_mfma_f32_16x16x32_bf16 v[64:67], v[168:171], a[116:119], v[64:67]
    buffer_load_dwordx4 v[216:219], v11, s[28:31], s66 offen sc1
    v_mfma_f32_16x16x32_bf16 v[48:51], v[172:175], a[112:115], v[48:51]
    s_waitcnt vmcnt(6) lgkmcnt(4)
    ds_read_b128 v[168:171], v12 offset:30720
    v_mfma_f32_16x16x32_bf16 v[68:71], v[172:175], a[116:119], v[68:71]
    v_mfma_f32_16x16x32_bf16 v[32:35], v[148:151], a[120:123], v[32:35]
    s_waitcnt lgkmcnt(4)
    ds_read_b128 v[172:175], v12 offset:31744
    v_mfma_f32_16x16x32_bf16 v[52:55], v[148:151], a[124:127], v[52:55]
    buffer_load_dwordx4 v[220:223], v11, s[28:31], s67 offen sc1
    v_mfma_f32_16x16x32_bf16 v[36:39], v[152:155], a[120:123], v[36:39]
    s_waitcnt lgkmcnt(4)
    ds_read_b128 v[148:151], v12 offset:32768
    v_mfma_f32_16x16x32_bf16 v[56:59], v[152:155], a[124:127], v[56:59]
    v_mfma_f32_16x16x32_bf16 v[40:43], v[156:159], a[120:123], v[40:43]
    s_waitcnt lgkmcnt(4)
    ds_read_b128 v[152:155], v12 offset:33792
    v_mfma_f32_16x16x32_bf16 v[60:63], v[156:159], a[124:127], v[60:63]
    v_mfma_f32_16x16x32_bf16 v[44:47], v[160:163], a[120:123], v[44:47]
    s_waitcnt vmcnt(6) lgkmcnt(4)
    ds_read_b128 v[156:159], v12 offset:34816
    v_mfma_f32_16x16x32_bf16 v[64:67], v[160:163], a[124:127], v[64:67]
    v_swap_b32 v194, v196
    v_swap_b32 v195, v197
    v_mfma_f32_16x16x32_bf16 v[48:51], v[164:167], a[120:123], v[48:51]
    s_waitcnt lgkmcnt(4)
    ds_read_b128 v[160:163], v12 offset:35840
    v_mfma_f32_16x16x32_bf16 v[68:71], v[164:167], a[124:127], v[68:71]
    buffer_load_dwordx4 a[20:23], v9, s[28:31], s61 offen sc1
    v_mfma_f32_16x16x32_bf16 v[32:35], v[168:171], v[192:195], v[32:35]
    s_waitcnt lgkmcnt(4)
    ds_read_b128 v[164:167], v12 offset:36864
    v_mfma_f32_16x16x32_bf16 v[52:55], v[168:171], v[196:199], v[52:55]
    buffer_load_dwordx4 a[28:31], v10, s[28:31], s61 offen sc1
    v_mfma_f32_16x16x32_bf16 v[36:39], v[172:175], v[192:195], v[36:39]
    s_waitcnt lgkmcnt(4)
    ds_read_b128 v[168:171], v12 offset:37888
    v_mfma_f32_16x16x32_bf16 v[56:59], v[172:175], v[196:199], v[56:59]
    v_mfma_f32_16x16x32_bf16 v[40:43], v[148:151], v[192:195], v[40:43]
    s_waitcnt lgkmcnt(4)
    ds_read_b128 v[172:175], v12 offset:38912
    v_mfma_f32_16x16x32_bf16 v[60:63], v[148:151], v[196:199], v[60:63]
    buffer_load_dwordx4 a[36:39], v9, s[28:31], s62 offen sc1
    v_mfma_f32_16x16x32_bf16 v[44:47], v[152:155], v[192:195], v[44:47]
    s_waitcnt vmcnt(7) lgkmcnt(4)
    ds_read_b128 v[148:151], v12 offset:39936
    v_mfma_f32_16x16x32_bf16 v[64:67], v[152:155], v[196:199], v[64:67]
    v_swap_b32 v202, v204
    v_swap_b32 v203, v205
    v_mfma_f32_16x16x32_bf16 v[48:51], v[156:159], v[192:195], v[48:51]
    s_waitcnt lgkmcnt(4)
    ds_read_b128 v[152:155], v12 offset:40960
    v_mfma_f32_16x16x32_bf16 v[68:71], v[156:159], v[196:199], v[68:71]
    v_mfma_f32_16x16x32_bf16 v[32:35], v[160:163], v[200:203], v[32:35]
    s_waitcnt lgkmcnt(4)
    ds_read_b128 v[156:159], v12 offset:41984
    v_mfma_f32_16x16x32_bf16 v[52:55], v[160:163], v[204:207], v[52:55]
    buffer_load_dwordx4 a[44:47], v10, s[28:31], s62 offen sc1
    v_mfma_f32_16x16x32_bf16 v[36:39], v[164:167], v[200:203], v[36:39]
    s_waitcnt lgkmcnt(4)
    ds_read_b128 v[160:163], v12 offset:43008
    v_mfma_f32_16x16x32_bf16 v[56:59], v[164:167], v[204:207], v[56:59]
    v_mfma_f32_16x16x32_bf16 v[40:43], v[168:171], v[200:203], v[40:43]
    s_waitcnt lgkmcnt(4)
    ds_read_b128 v[164:167], v12 offset:44032
    v_mfma_f32_16x16x32_bf16 v[60:63], v[168:171], v[204:207], v[60:63]
    buffer_load_dwordx4 a[52:55], v9, s[28:31], s63 offen sc1
    v_mfma_f32_16x16x32_bf16 v[44:47], v[172:175], v[200:203], v[44:47]
    s_waitcnt vmcnt(7) lgkmcnt(4)
    ds_read_b128 v[168:171], v12 offset:45056
    v_mfma_f32_16x16x32_bf16 v[64:67], v[172:175], v[204:207], v[64:67]
    v_swap_b32 v210, v212
    v_swap_b32 v211, v213
    v_mfma_f32_16x16x32_bf16 v[48:51], v[148:151], v[200:203], v[48:51]
    s_waitcnt vmcnt(5) lgkmcnt(4)
    ds_read_b128 v[172:175], v12 offset:46080
    v_mfma_f32_16x16x32_bf16 v[68:71], v[148:151], v[204:207], v[68:71]
    buffer_store_dword v254, v255, s[20:23], s59 offen offset:64 sc1
    v_mfma_f32_16x16x32_bf16 v[32:35], v[152:155], v[208:211], v[32:35]
    s_waitcnt lgkmcnt(4)
    ds_read_b128 v[148:151], v12 offset:47104
    v_mfma_f32_16x16x32_bf16 v[52:55], v[152:155], v[212:215], v[52:55]
    buffer_load_dwordx4 a[60:63], v10, s[28:31], s63 offen sc1
    v_mfma_f32_16x16x32_bf16 v[36:39], v[156:159], v[208:211], v[36:39]
    s_waitcnt lgkmcnt(4)
    ds_read_b128 v[152:155], v12 offset:48128
    v_mfma_f32_16x16x32_bf16 v[56:59], v[156:159], v[212:215], v[56:59]
    v_mfma_f32_16x16x32_bf16 v[40:43], v[160:163], v[208:211], v[40:43]
    s_waitcnt lgkmcnt(4)
    ds_read_b128 v[156:159], v12 offset:49152
    v_mfma_f32_16x16x32_bf16 v[60:63], v[160:163], v[212:215], v[60:63]
    buffer_load_dwordx4 a[68:71], v9, s[28:31], s64 offen sc1
    v_mfma_f32_16x16x32_bf16 v[44:47], v[164:167], v[208:211], v[44:47]
    s_waitcnt lgkmcnt(4)
    ds_read_b128 v[160:163], v12 offset:50176
    v_mfma_f32_16x16x32_bf16 v[64:67], v[164:167], v[212:215], v[64:67]
    v_swap_b32 v218, v220
    v_swap_b32 v219, v221
    v_mfma_f32_16x16x32_bf16 v[48:51], v[168:171], v[208:211], v[48:51]
    s_waitcnt lgkmcnt(4)
    v_mfma_f32_16x16x32_bf16 v[68:71], v[168:171], v[212:215], v[68:71]
    buffer_load_dwordx4 a[76:79], v10, s[28:31], s64 offen sc1
    v_mfma_f32_16x16x32_bf16 v[32:35], v[172:175], v[216:219], v[32:35]
    s_waitcnt lgkmcnt(3)
    v_mfma_f32_16x16x32_bf16 v[52:55], v[172:175], v[220:223], v[52:55]
    v_mfma_f32_16x16x32_bf16 v[36:39], v[148:151], v[216:219], v[36:39]
    s_waitcnt lgkmcnt(2)
    v_mfma_f32_16x16x32_bf16 v[56:59], v[148:151], v[220:223], v[56:59]
    v_mfma_f32_16x16x32_bf16 v[40:43], v[152:155], v[216:219], v[40:43]
    s_waitcnt lgkmcnt(1)
    v_mfma_f32_16x16x32_bf16 v[60:63], v[152:155], v[220:223], v[60:63]
    v_mfma_f32_16x16x32_bf16 v[44:47], v[156:159], v[216:219], v[44:47]
    s_waitcnt lgkmcnt(0)
    v_mfma_f32_16x16x32_bf16 v[64:67], v[156:159], v[220:223], v[64:67]
    v_mfma_f32_16x16x32_bf16 v[48:51], v[160:163], v[216:219], v[48:51]
    s_waitcnt vmcnt(8)
    v_mfma_f32_16x16x32_bf16 v[68:71], v[160:163], v[220:223], v[68:71]
    v_mfma_f32_16x16x32_bf16 v[52:55], a[128:131], a[20:23], v[52:55]
    buffer_load_dword v251, v250, s[20:23], s59 offen offset:64 sc1
    v_mfma_f32_16x16x32_bf16 v[56:59], a[132:135], a[20:23], v[56:59]
    v_mfma_f32_16x16x32_bf16 v[60:63], a[136:139], a[20:23], v[60:63]
    v_mfma_f32_16x16x32_bf16 v[64:67], a[140:143], a[20:23], v[64:67]
    v_cvt_pk_bf16_f32 v120, v32, v33
    v_cvt_pk_bf16_f32 v121, v34, v35
    v_mfma_f32_16x16x32_bf16 v[68:71], a[144:147], a[20:23], v[68:71]
    s_waitcnt vmcnt(8)
    ds_write_b64 v239, v[120:121] offset:0
    v_mfma_f32_16x16x32_bf16 v[52:55], a[148:151], a[28:31], v[52:55]
    v_cvt_pk_bf16_f32 v122, v36, v37
    v_cvt_pk_bf16_f32 v123, v38, v39
    v_mfma_f32_16x16x32_bf16 v[56:59], a[152:155], a[28:31], v[56:59]
    ds_write_b64 v239, v[122:123] offset:8
    v_mfma_f32_16x16x32_bf16 v[60:63], a[156:159], a[28:31], v[60:63]
    v_cvt_pk_bf16_f32 v124, v40, v41
    v_cvt_pk_bf16_f32 v125, v42, v43
    v_mfma_f32_16x16x32_bf16 v[64:67], a[160:163], a[28:31], v[64:67]
    ds_write_b64 v239, v[124:125] offset:16
    v_mfma_f32_16x16x32_bf16 v[68:71], a[164:167], a[28:31], v[68:71]
    s_waitcnt vmcnt(7)
    v_cvt_pk_bf16_f32 v126, v44, v45
    v_cvt_pk_bf16_f32 v127, v46, v47
    v_mfma_f32_16x16x32_bf16 v[52:55], a[168:171], a[36:39], v[52:55]
    ds_write_b64 v239, v[126:127] offset:24
    v_mfma_f32_16x16x32_bf16 v[56:59], a[172:175], a[36:39], v[56:59]
    v_cvt_pk_bf16_f32 v128, v48, v49
    v_cvt_pk_bf16_f32 v129, v50, v51
    v_mfma_f32_16x16x32_bf16 v[60:63], a[176:179], a[36:39], v[60:63]
    s_waitcnt vmcnt(1)
    ds_write_b64 v239, v[128:129] offset:32
    buffer_store_dword v254, v255, s[20:23], s59 offen offset:96 sc1
    v_mfma_f32_16x16x32_bf16 v[64:67], a[180:183], a[36:39], v[64:67]
    ds_read_b128 v[136:139], v240
    ds_read_b128 v[140:143], v241
    v_mfma_f32_16x16x32_bf16 v[68:71], a[184:187], a[36:39], v[68:71]
    ds_read_b128 v[144:147], v242
    v_mfma_f32_16x16x32_bf16 v[52:55], a[188:191], a[44:47], v[52:55]
    v_mfma_f32_16x16x32_bf16 v[56:59], a[192:195], a[44:47], v[56:59]
    v_mfma_f32_16x16x32_bf16 v[60:63], a[196:199], a[44:47], v[60:63]
    v_mfma_f32_16x16x32_bf16 v[64:67], a[200:203], a[44:47], v[64:67]
    v_mfma_f32_16x16x32_bf16 v[68:71], a[204:207], a[44:47], v[68:71]
    v_mfma_f32_16x16x32_bf16 v[52:55], a[208:211], a[52:55], v[52:55]
    v_mfma_f32_16x16x32_bf16 v[56:59], a[212:215], a[52:55], v[56:59]
    v_mfma_f32_16x16x32_bf16 v[60:63], a[216:219], a[52:55], v[60:63]
    s_waitcnt vmcnt(1)
    v_cmp_ne_u32 vcc, s32, v251
    v_mfma_f32_16x16x32_bf16 v[64:67], a[220:223], a[52:55], v[64:67]
    v_mfma_f32_16x16x32_bf16 v[68:71], a[224:227], a[52:55], v[68:71]
    s_nop 1
    s_cbranch_vccnz L_d0Bs_retry
L_d0Bs_ok:
    v_mfma_f32_16x16x32_bf16 v[52:55], a[228:231], a[60:63], v[52:55]
    s_waitcnt lgkmcnt(2)
    buffer_store_dwordx4 v[136:139], v245, s[24:27], s73 offen
    v_mfma_f32_16x16x32_bf16 v[52:55], a[248:251], a[68:71], v[52:55]
    v_mfma_f32_16x16x32_bf16 v[52:55], v[84:87], a[76:79], v[52:55]
    s_waitcnt lgkmcnt(1)
    buffer_store_dwordx4 v[140:143], v246, s[24:27], s73 offen
    v_mfma_f32_16x16x32_bf16 v[56:59], a[232:235], a[60:63], v[56:59]
    v_mfma_f32_16x16x32_bf16 v[56:59], a[252:255], a[68:71], v[56:59]
    s_waitcnt lgkmcnt(0)
    buffer_store_dwordx4 v[144:147], v247, s[24:27], s73 offen
    v_mfma_f32_16x16x32_bf16 v[56:59], v[88:91], a[76:79], v[56:59]
    v_mfma_f32_16x16x32_bf16 v[60:63], a[236:239], a[60:63], v[60:63]
    v_cvt_pk_bf16_f32 v120, v52, v53
    v_cvt_pk_bf16_f32 v121, v54, v55
    v_mfma_f32_16x16x32_bf16 v[60:63], v[72:75], a[68:71], v[60:63]
    ds_write_b64 v239, v[120:121] offset:0
    buffer_load_dword v251, v250, s[20:23], s59 offen offset:96 sc1
    v_mfma_f32_16x16x32_bf16 v[60:63], v[92:95], a[76:79], v[60:63]
    v_mfma_f32_16x16x32_bf16 v[64:67], a[240:243], a[60:63], v[64:67]
    v_cvt_pk_bf16_f32 v122, v56, v57
    v_cvt_pk_bf16_f32 v123, v58, v59
    v_mfma_f32_16x16x32_bf16 v[64:67], v[76:79], a[68:71], v[64:67]
    s_or_b32 s42, s4, s51
    ds_write_b64 v239, v[122:123] offset:8
    v_mfma_f32_16x16x32_bf16 v[64:67], v[96:99], a[76:79], v[64:67]
    s_cmp_lg_u32 s42, 0
    v_mfma_f32_16x16x32_bf16 v[68:71], a[244:247], a[60:63], v[68:71]
    s_cselect_b32 s42, 33554432, 0
    v_cvt_pk_bf16_f32 v124, v60, v61
    v_cvt_pk_bf16_f32 v125, v62, v63
    v_mfma_f32_16x16x32_bf16 v[68:71], v[80:83], a[68:71], v[68:71]
    ds_write_b64 v239, v[124:125] offset:16
    buffer_store_dword v254, v255, s[20:23], s42 offen offset:128 sc1
    v_mfma_f32_16x16x32_bf16 v[68:71], v[100:103], a[76:79], v[68:71]
    s_add_u32 s73, s73, 40960
    v_cvt_pk_bf16_f32 v126, v64, v65
    v_cvt_pk_bf16_f32 v127, v66, v67
    ds_write_b64 v239, v[126:127] offset:24
    s_waitcnt vmcnt(1)
    v_cmp_ne_u32 vcc, s32, v251
    s_nop 1
    v_cvt_pk_bf16_f32 v128, v68, v69
    v_cvt_pk_bf16_f32 v129, v70, v71
    ds_write_b64 v239, v[128:129] offset:32
    ds_read_b128 v[136:139], v240
    ds_read_b128 v[140:143], v241
    ds_read_b128 v[144:147], v242
    s_cbranch_vccnz L_d1Bs_retry
L_d1Bs_ok:
    s_waitcnt lgkmcnt(2)
    buffer_store_dwordx4 v[136:139], v245, s[24:27], s73 offen
    s_waitcnt lgkmcnt(1)
    buffer_store_dwordx4 v[140:143], v246, s[24:27], s73 offen
    s_waitcnt lgkmcnt(0)
    buffer_store_dwordx4 v[144:147], v247, s[24:27], s73 offen
    s_endpgm
L_f0B_retry:
    s_mov_b32 s52, 0
L_f0B_loop:
    buffer_load_dword v251, v250, s[20:23], s59 offen offset:0 sc1
    s_waitcnt vmcnt(0)
    v_cmp_ne_u32 vcc, s32, v251
    s_nop 3
    s_cbranch_vccz L_f0B_ok
    s_add_u32 s52, s52, 1
    s_cmp_lt_u32 s52, 100000
    s_cbranch_scc1 L_f0B_loop
    s_branch L_f0B_ok
L_f1B_retry:
    s_mov_b32 s52, 0
L_f1B_loop:
    buffer_load_dword v251, v250, s[20:23], s59 offen offset:32 sc1
    s_waitcnt vmcnt(0)
    v_cmp_ne_u32 vcc, s32, v251
    s_nop 3
    s_cbranch_vccz L_f1B_ok
    s_add_u32 s52, s52, 1
    s_cmp_lt_u32 s52, 100000
    s_cbranch_scc1 L_f1B_loop
    s_branch L_f1B_ok
L_d0B_retry:
    s_mov_b32 s52, 0
L_d0B_loop:
    buffer_load_dword v251, v250, s[20:23], s59 offen offset:64 sc1
    s_waitcnt vmcnt(0)
    v_cmp_ne_u32 vcc, s32, v251
    s_nop 3
    s_cbranch_vccz L_d0B_ok
    s_add_u32 s52, s52, 1
    s_cmp_lt_u32 s52, 100000
    s_cbranch_scc1 L_d0B_loop
    s_branch L_d0B_ok
L_d1B_retry:
    s_mov_b32 s52, 0
L_d1B_loop:
    buffer_load_dword v251, v250, s[20:23], s59 offen offset:96 sc1
    s_waitcnt vmcnt(0)
    v_cmp_ne_u32 vcc, s32, v251
    s_nop 3
    s_cbranch_vccz L_d1B_ok
    s_add_u32 s52, s52, 1
    s_cmp_lt_u32 s52, 100000
    s_cbranch_scc1 L_d1B_loop
    s_branch L_d1B_ok
.fill 2048, 4, 0xbf810000
.section .rodata,"a"
.p2align 6
.amdhsa_kernel concat_heads__linear_kernel_hedgehog__linear_attn_block__prompt_kernel
  .amdhsa_next_free_vgpr 512
  .amdhsa_next_free_sgpr 102
  .amdhsa_accum_offset 256
  .amdhsa_group_segment_fixed_size 0
  .amdhsa_kernarg_size 80
  .amdhsa_user_sgpr_count 2
  .amdhsa_user_sgpr_kernarg_segment_ptr 1
  .amdhsa_system_sgpr_workgroup_id_x 1
.end_amdhsa_kernel
```
